```python
import torch

def _softmax(x, axis=-1):
    return torch.softmax(x, dim=axis)
def _gelu(x):
    return torch.nn.functional.gelu(x, approximate="tanh")
def _silu(x):
    return torch.nn.functional.silu(x)
def _sigmoid(x):
    return torch.sigmoid(x)
def _layernorm(x, axis=-1, eps=1e-5):
    m = x.mean(dim=axis, keepdim=True)
    v = x.var(dim=axis, keepdim=True, unbiased=False)
    return (x - m) / torch.sqrt(v + eps)
def _scatter_add(tgt, idx, src, axis=0):
    return tgt.clone().index_add_(axis, idx, src)
def _segment_sum(src, seg, n):
    out = torch.zeros((n,) + src.shape[1:], dtype=src.dtype)
    return out.index_add_(0, seg, src)
def _pad(x, pw):
    flat = tuple(v for pair in reversed(pw) for v in pair)
    return torch.nn.functional.pad(x, flat)

kernel_name = 'standalone__kv_cache_quant_int4_int2_kv_with_per_channel_or_per_token_scales__prompt'

def setup_inputs():

    _w = (lambda a: (lambda t: t.to(torch.bfloat16) if t.is_floating_point() else t)(torch.as_tensor(a)))
    B = 1
    Sq = 2048
    Skv = 2048
    Hq = 32
    Hkv = 32
    Dh = 192
    bits = 3
    G = 32
    if G <= 0 or G >= Skv:
        G = max(1, Skv // 2)
    Skv = (Skv // G) * G
    ngk = Skv // G
    qmax = (1 << bits) - 1
    return {
        "q": _w((lambda *s: torch.randn(*s, dtype=torch.bfloat16) * 1.6)(B, Hq, Sq, Dh)),
        "qk": _w(torch.randint(0, qmax + 1, (B, Hkv, Skv, Dh)).to(torch.int32)),
        "qv": _w(torch.randint(0, qmax + 1, (B, Hkv, Skv, Dh)).to(torch.int32)),
        "k_scales": _w(torch.abs((lambda *s: torch.randn(*s, dtype=torch.bfloat16) * 1.6)(B, Hkv, ngk, Dh)) * 0.05 + 0.02),
        "k_zeros": _w((lambda *s: torch.randn(*s, dtype=torch.bfloat16) * 1.6)(B, Hkv, ngk, Dh) + float(qmax) / 2.0),
        "v_scales": _w(torch.abs((lambda *s: torch.randn(*s, dtype=torch.bfloat16) * 0.05)(B, Hkv, Skv, 1)) * 0.05 + 0.02),
        "v_zeros": _w((lambda *s: torch.randn(*s, dtype=torch.bfloat16) * 0.05)(B, Hkv, Skv, 1) + float(qmax) / 2.0),
    }

def reference(q, qk, qv, k_scales, k_zeros, v_scales, v_zeros):
    B, Hq, Sq, Dh = q.shape
    Hkv, Skv = qk.shape[1], qk.shape[2]
    ngk = k_scales.shape[2]
    G = Skv // ngk
    ks = (lambda x, n, axis: torch.repeat_interleave(x, n, dim=axis))(k_scales, G, axis=2)
    kz = (lambda x, n, axis: torch.repeat_interleave(x, n, dim=axis))(k_zeros, G, axis=2)
    k = ((lambda x, dt: x.to(dt))(qk, q.dtype) - kz) * ks
    v = ((lambda x, dt: x.to(dt))(qv, q.dtype) - v_zeros) * v_scales
    rep = Hq // Hkv
    if rep > 1:
        k = (lambda x, n, axis: torch.repeat_interleave(x, n, dim=axis))(k, rep, axis=1)
        v = (lambda x, n, axis: torch.repeat_interleave(x, n, dim=axis))(v, rep, axis=1)
    scale = float(Dh) ** -0.5
    logits = torch.einsum("bhqd,bhkd->bhqk", q, k) * scale
    p = _softmax(logits, axis=-1)
    o = torch.einsum("bhqk,bhkd->bhqd", p, v)
    return o
```

```asm
; @launch grid=(256,1,1) block=(256,1,1) lds=99392
.amdgcn_target "amdgcn-amd-amdhsa--gfx950"
.text
.globl standalone__kv_cache_quant_int4_int2_kv_with_per_channel_or_per_token_scales__prompt_kernel
.p2align 8
.type standalone__kv_cache_quant_int4_int2_kv_with_per_channel_or_per_token_scales__prompt_kernel,@function
standalone__kv_cache_quant_int4_int2_kv_with_per_channel_or_per_token_scales__prompt_kernel:
    s_cmp_ge_u32 s2, 256
    s_cbranch_scc1 MAIN_END
    s_load_dwordx16 s[72:87], s[0:1], 0
    s_load_dwordx4 s[88:91], s[0:1], 64
    s_memrealtime s[98:99]
    v_lshrrev_b32 v4, 6, v0
    v_and_b32 v0, 63, v0
    s_nop 0
    v_readfirstlane_b32 s16, v4
    s_and_b32 s17, s2, 7
    s_lshr_b32 s18, s2, 3
    s_lshl_b32 s17, s17, 2
    s_lshr_b32 s19, s18, 3
    s_add_u32 s17, s17, s19
    s_and_b32 s18, s18, 7
    v_lshlrev_b32 v1, 4, v0
    v_add_u32 v2, 49152, v1
    v_add_u32 v3, 4096, v1
    s_mul_i32 s22, s17, 786432
    s_mul_i32 s21, s16, 6144
    s_and_b32 s19, s16, 1
    s_mul_i32 s20, s19, 6144
    s_lshl_b32 s50, s18, 1
    s_add_u32 s50, s50, s19
    s_mul_i32 s51, s50, 11
    s_lshr_b32 s51, s51, 5
    s_mul_i32 s52, s51, 3
    s_sub_u32 s52, s50, s52
    s_lshl_b32 s19, s18, 2
    s_add_u32 s19, s19, s16
    s_mul_i32 s19, s19, 24576
    s_add_u32 s23, s22, s19
    s_add_u32 s54, s23, 6144
    s_add_u32 s55, s23, 12288
    s_add_u32 s56, s23, 18432
    v_and_b32 v15, 15, v0
    v_lshrrev_b32 v16, 4, v0
    v_mul_u32_u24 v14, 384, v15
    v_lshl_add_u32 v14, v16, 4, v14
    s_mov_b32 s61, 1037384597
    s_mov_b32 s62, 0xffff0000
    s_mov_b32 s53, 0
    s_mov_b32 s65, 0
    s_mov_b32 s57, 0
    s_lshl_b32 s70, s16, 8
    s_add_u32 s70, s70, 98304
    s_lshl_b32 s71, s22, 1
    s_lshl_b32 s66, s17, 3
    s_add_u32 s67, s22, 25165824
    s_cmp_ge_u32 s16, 2
    s_cbranch_scc1 VER_B
    v_and_b32 v17, 7, v0
    v_lshrrev_b32 v18, 3, v0
    v_and_b32 v19, 4, v17
    v_add_u32 v19, v19, v17
    v_mul_u32_u24 v4, 768, v19
    v_lshl_add_u32 v4, v18, 5, v4
    v_add_u32 v5, 12288, v4
    v_lshlrev_b32 v6, 8, v18
    v_lshl_add_u32 v6, v17, 4, v6
    v_add_u32 v7, 6144, v6
    v_lshlrev_b32 v8, 4, v18
    s_mul_i32 s58, s51, 24576
    s_lshl_b32 s19, s52, 8
    s_add_u32 s58, s58, s19
    s_mul_i32 s59, s51, 384
    s_lshl_b32 s19, s52, 7
    s_add_u32 s59, s59, s19
    s_mul_i32 s60, s51, 12288
    s_lshl_b32 s19, s52, 11
    s_add_u32 s60, s60, s19
    s_mul_i32 s68, s17, 24576
    s_waitcnt lgkmcnt(0)
    s_add_u32 s24, s74, s71
    s_addc_u32 s25, s75, 0
    s_mov_b32 s26, 1572864
    s_mov_b32 s27, 0x00020000
    s_add_u32 s28, s78, s68
    s_addc_u32 s29, s79, 0
    s_mov_b32 s30, 24576
    s_mov_b32 s31, 0x00020000
    s_add_u32 s32, s80, s68
    s_addc_u32 s33, s81, 0
    s_mov_b32 s34, 24576
    s_mov_b32 s35, 0x00020000
    s_add_u32 s36, s90, s22
    s_addc_u32 s37, s91, 0
    s_mov_b32 s38, 786432
    s_mov_b32 s39, 0x00020000
    s_cmp_lt_u32 s50, 12
    s_cselect_b32 s26, s26, 0
    s_cselect_b32 s30, s30, 0
    s_cselect_b32 s34, s34, 0
    s_cselect_b32 s38, s38, 0
    v_cmp_ne_u32 vcc, 0, v0
    v_mov_b32 v17, 4096
    s_lshl_b32 s19, s18, 2
    s_add_u32 s19, s19, s16
    s_lshl_b32 s19, s19, 2
    buffer_load_dwordx2 v[24:25], v8, s[28:31], s59 offen offset:0
    buffer_load_dwordx2 v[28:29], v8, s[32:35], s59 offen offset:0
    buffer_load_dwordx2 v[26:27], v8, s[28:31], s59 offen offset:8
    buffer_load_dwordx2 v[30:31], v8, s[32:35], s59 offen offset:8
    buffer_load_dwordx4 v[224:227], v4, s[24:27], s58 offen offset:0 nt
    buffer_load_dwordx4 v[228:231], v5, s[24:27], s58 offen offset:0 nt
    buffer_load_dwordx4 v[232:235], v4, s[24:27], s58 offen offset:3072 nt
    buffer_load_dwordx4 v[236:239], v5, s[24:27], s58 offen offset:3072 nt
    buffer_load_dwordx4 v[240:243], v4, s[24:27], s58 offen offset:16 nt
    buffer_load_dwordx4 v[244:247], v5, s[24:27], s58 offen offset:16 nt
    buffer_load_dwordx4 v[248:251], v4, s[24:27], s58 offen offset:3088 nt
    buffer_load_dwordx4 v[252:255], v5, s[24:27], s58 offen offset:3088 nt
    s_add_u32 s58, s58, 98304
    s_add_u32 s59, s59, 1536
    s_add_u32 s63, s60, 49152
    buffer_load_dwordx2 v[32:33], v8, s[28:31], s59 offen offset:0
    buffer_load_dwordx2 v[36:37], v8, s[32:35], s59 offen offset:0
    buffer_load_dwordx2 v[34:35], v8, s[28:31], s59 offen offset:8
    buffer_load_dwordx2 v[38:39], v8, s[32:35], s59 offen offset:8
    buffer_load_dwordx4 v[64:67], v4, s[24:27], s58 offen offset:0 nt
    buffer_load_dwordx4 v[68:71], v5, s[24:27], s58 offen offset:0 nt
    buffer_load_dwordx4 v[72:75], v4, s[24:27], s58 offen offset:3072 nt
    buffer_load_dwordx4 v[76:79], v5, s[24:27], s58 offen offset:3072 nt
    buffer_load_dwordx4 v[80:83], v4, s[24:27], s58 offen offset:16 nt
    buffer_load_dwordx4 v[84:87], v5, s[24:27], s58 offen offset:16 nt
    buffer_load_dwordx4 v[88:91], v4, s[24:27], s58 offen offset:3088 nt
    buffer_load_dwordx4 v[92:95], v5, s[24:27], s58 offen offset:3088 nt
    s_add_u32 s58, s58, 98304
    s_add_u32 s59, s59, 1536
    s_add_u32 s4, s72, s57
    s_addc_u32 s5, s73, 0
    s_mov_b32 s6, 25165824
    s_mov_b32 s7, 0x00020000
    v_mov_b32 v16, s19
    v_cndmask_b32 v9, v16, v17, vcc
    v_and_b32 v13, 31, v0
    v_lshlrev_b32 v13, 2, v13
    s_lshl_b32 s19, s17, 12
    s_add_u32 s19, s19, 50331648
    s_add_u32 s12, s86, s57
    s_addc_u32 s13, s87, 0
    s_mov_b32 s14, 25165824
    s_mov_b32 s15, 0x00020000
    s_add_u32 s40, s90, s19
    s_addc_u32 s41, s91, 0
    s_mov_b32 s42, 256
    s_mov_b32 s43, 0x00020000
    s_add_u32 s8, s90, s67
    s_addc_u32 s9, s91, 0
    s_mov_b32 s10, 786432
    s_mov_b32 s11, 0x00020000
    v_and_b32 v15, 15, v0
    v_lshrrev_b32 v16, 4, v0
    v_mul_u32_u24 v22, 1536, v16
    v_lshl_add_u32 v22, v15, 3, v22
    v_lshl_add_u32 v20, v15, 2, s70
    v_lshl_add_u32 v21, v16, 4, s70
    v_mov_b32 v23, 99328
    s_lshl_b32 s19, s16, 3
    v_add_u32 v17, s19, v23
    v_mov_b32 v18, s98
    v_mov_b32 v19, s99
    ds_write_b64 v17, v[18:19] offset:16
    s_waitcnt lgkmcnt(0)
    s_barrier
    ds_read_b64 v[18:19], v23 offset:16
    v_accvgpr_write_b32 a0, 0
    v_accvgpr_write_b32 a1, 0
    v_accvgpr_write_b32 a2, 0
    v_accvgpr_write_b32 a3, 0
    v_accvgpr_write_b32 a4, 0
    v_accvgpr_write_b32 a5, 0
    v_accvgpr_write_b32 a6, 0
    v_accvgpr_write_b32 a7, 0
    v_accvgpr_write_b32 a8, 0
    v_accvgpr_write_b32 a9, 0
    v_accvgpr_write_b32 a10, 0
    v_accvgpr_write_b32 a11, 0
    v_accvgpr_write_b32 a12, 0
    v_accvgpr_write_b32 a13, 0
    v_accvgpr_write_b32 a14, 0
    v_accvgpr_write_b32 a15, 0
    v_accvgpr_write_b32 a16, 0
    v_accvgpr_write_b32 a17, 0
    v_accvgpr_write_b32 a18, 0
    v_accvgpr_write_b32 a19, 0
    v_accvgpr_write_b32 a20, 0
    v_accvgpr_write_b32 a21, 0
    v_accvgpr_write_b32 a22, 0
    v_accvgpr_write_b32 a23, 0
    v_accvgpr_write_b32 a24, 0
    v_accvgpr_write_b32 a25, 0
    v_accvgpr_write_b32 a26, 0
    v_accvgpr_write_b32 a27, 0
    v_accvgpr_write_b32 a28, 0
    v_accvgpr_write_b32 a29, 0
    v_accvgpr_write_b32 a30, 0
    v_accvgpr_write_b32 a31, 0
    v_accvgpr_write_b32 a32, 0
    v_accvgpr_write_b32 a33, 0
    v_accvgpr_write_b32 a34, 0
    v_accvgpr_write_b32 a35, 0
    v_accvgpr_write_b32 a36, 0
    v_accvgpr_write_b32 a37, 0
    v_accvgpr_write_b32 a38, 0
    v_accvgpr_write_b32 a39, 0
    v_accvgpr_write_b32 a40, 0
    v_accvgpr_write_b32 a41, 0
    v_accvgpr_write_b32 a42, 0
    v_accvgpr_write_b32 a43, 0
    v_accvgpr_write_b32 a44, 0
    v_accvgpr_write_b32 a45, 0
    v_accvgpr_write_b32 a46, 0
    v_accvgpr_write_b32 a47, 0
    v_accvgpr_write_b32 a48, 0
    v_accvgpr_write_b32 a49, 0
    v_accvgpr_write_b32 a50, 0
    v_accvgpr_write_b32 a51, 0
    v_accvgpr_write_b32 a52, 0
    v_accvgpr_write_b32 a53, 0
    v_accvgpr_write_b32 a54, 0
    v_accvgpr_write_b32 a55, 0
    v_accvgpr_write_b32 a56, 0
    v_accvgpr_write_b32 a57, 0
    v_accvgpr_write_b32 a58, 0
    v_accvgpr_write_b32 a59, 0
    v_accvgpr_write_b32 a60, 0
    v_accvgpr_write_b32 a61, 0
    v_accvgpr_write_b32 a62, 0
    v_accvgpr_write_b32 a63, 0
    v_accvgpr_write_b32 a64, 0
    v_accvgpr_write_b32 a65, 0
    v_accvgpr_write_b32 a66, 0
    v_accvgpr_write_b32 a67, 0
    v_accvgpr_write_b32 a68, 0
    v_accvgpr_write_b32 a69, 0
    v_accvgpr_write_b32 a70, 0
    v_accvgpr_write_b32 a71, 0
    v_accvgpr_write_b32 a72, 0
    v_accvgpr_write_b32 a73, 0
    v_accvgpr_write_b32 a74, 0
    v_accvgpr_write_b32 a75, 0
    v_accvgpr_write_b32 a76, 0
    v_accvgpr_write_b32 a77, 0
    v_accvgpr_write_b32 a78, 0
    v_accvgpr_write_b32 a79, 0
    v_accvgpr_write_b32 a80, 0
    v_accvgpr_write_b32 a81, 0
    v_accvgpr_write_b32 a82, 0
    v_accvgpr_write_b32 a83, 0
    v_accvgpr_write_b32 a84, 0
    v_accvgpr_write_b32 a85, 0
    v_accvgpr_write_b32 a86, 0
    v_accvgpr_write_b32 a87, 0
    v_accvgpr_write_b32 a88, 0
    v_accvgpr_write_b32 a89, 0
    v_accvgpr_write_b32 a90, 0
    v_accvgpr_write_b32 a91, 0
    v_accvgpr_write_b32 a92, 0
    v_accvgpr_write_b32 a93, 0
    v_accvgpr_write_b32 a94, 0
    v_accvgpr_write_b32 a95, 0
    v_accvgpr_write_b32 a96, 0
    v_accvgpr_write_b32 a97, 0
    v_accvgpr_write_b32 a98, 0
    v_accvgpr_write_b32 a99, 0
    v_accvgpr_write_b32 a100, 0
    v_accvgpr_write_b32 a101, 0
    v_accvgpr_write_b32 a102, 0
    v_accvgpr_write_b32 a103, 0
    v_accvgpr_write_b32 a104, 0
    v_accvgpr_write_b32 a105, 0
    v_accvgpr_write_b32 a106, 0
    v_accvgpr_write_b32 a107, 0
    v_accvgpr_write_b32 a108, 0
    v_accvgpr_write_b32 a109, 0
    v_accvgpr_write_b32 a110, 0
    v_accvgpr_write_b32 a111, 0
    v_accvgpr_write_b32 a112, 0
    v_accvgpr_write_b32 a113, 0
    v_accvgpr_write_b32 a114, 0
    v_accvgpr_write_b32 a115, 0
    v_accvgpr_write_b32 a116, 0
    v_accvgpr_write_b32 a117, 0
    v_accvgpr_write_b32 a118, 0
    v_accvgpr_write_b32 a119, 0
    v_accvgpr_write_b32 a120, 0
    v_accvgpr_write_b32 a121, 0
    v_accvgpr_write_b32 a122, 0
    v_accvgpr_write_b32 a123, 0
    v_accvgpr_write_b32 a124, 0
    v_accvgpr_write_b32 a125, 0
    v_accvgpr_write_b32 a126, 0
    v_accvgpr_write_b32 a127, 0
    v_accvgpr_write_b32 a128, 0
    v_accvgpr_write_b32 a129, 0
    v_accvgpr_write_b32 a130, 0
    v_accvgpr_write_b32 a131, 0
    v_accvgpr_write_b32 a132, 0
    v_accvgpr_write_b32 a133, 0
    v_accvgpr_write_b32 a134, 0
    v_accvgpr_write_b32 a135, 0
    v_accvgpr_write_b32 a136, 0
    v_accvgpr_write_b32 a137, 0
    v_accvgpr_write_b32 a138, 0
    v_accvgpr_write_b32 a139, 0
    v_accvgpr_write_b32 a140, 0
    v_accvgpr_write_b32 a141, 0
    v_accvgpr_write_b32 a142, 0
    v_accvgpr_write_b32 a143, 0
    v_accvgpr_write_b32 a144, 0
    v_accvgpr_write_b32 a145, 0
    v_accvgpr_write_b32 a146, 0
    v_accvgpr_write_b32 a147, 0
    v_accvgpr_write_b32 a148, 0
    v_accvgpr_write_b32 a149, 0
    v_accvgpr_write_b32 a150, 0
    v_accvgpr_write_b32 a151, 0
    v_accvgpr_write_b32 a152, 0
    v_accvgpr_write_b32 a153, 0
    v_accvgpr_write_b32 a154, 0
    v_accvgpr_write_b32 a155, 0
    v_accvgpr_write_b32 a156, 0
    v_accvgpr_write_b32 a157, 0
    v_accvgpr_write_b32 a158, 0
    v_accvgpr_write_b32 a159, 0
    v_accvgpr_write_b32 a160, 0
    v_accvgpr_write_b32 a161, 0
    v_accvgpr_write_b32 a162, 0
    v_accvgpr_write_b32 a163, 0
    v_accvgpr_write_b32 a164, 0
    v_accvgpr_write_b32 a165, 0
    v_accvgpr_write_b32 a166, 0
    v_accvgpr_write_b32 a167, 0
    v_accvgpr_write_b32 a168, 0
    v_accvgpr_write_b32 a169, 0
    v_accvgpr_write_b32 a170, 0
    v_accvgpr_write_b32 a171, 0
    v_accvgpr_write_b32 a172, 0
    v_accvgpr_write_b32 a173, 0
    v_accvgpr_write_b32 a174, 0
    v_accvgpr_write_b32 a175, 0
    v_accvgpr_write_b32 a176, 0
    v_accvgpr_write_b32 a177, 0
    v_accvgpr_write_b32 a178, 0
    v_accvgpr_write_b32 a179, 0
    v_accvgpr_write_b32 a180, 0
    v_accvgpr_write_b32 a181, 0
    v_accvgpr_write_b32 a182, 0
    v_accvgpr_write_b32 a183, 0
    v_accvgpr_write_b32 a184, 0
    v_accvgpr_write_b32 a185, 0
    v_accvgpr_write_b32 a186, 0
    v_accvgpr_write_b32 a187, 0
    v_accvgpr_write_b32 a188, 0
    v_accvgpr_write_b32 a189, 0
    v_accvgpr_write_b32 a190, 0
    v_accvgpr_write_b32 a191, 0
    s_waitcnt lgkmcnt(0)
    v_readfirstlane_b32 s44, v18
    v_readfirstlane_b32 s45, v19
    v_mov_b32 v144, 0
    v_mov_b32 v145, 0
    v_mov_b32 v146, 0
    v_mov_b32 v147, 0
    v_mov_b32 v148, 0
    v_mov_b32 v149, 0
    v_mov_b32 v150, 0
    v_mov_b32 v151, 0
    buffer_load_dwordx4 v[192:195], v14, s[4:7], s23 offen offset:0 nt
    buffer_load_dwordx4 v[196:199], v14, s[4:7], s54 offen offset:0 nt
    s_waitcnt vmcnt(24)
    v_lshlrev_b32 v40, 16, v24
    v_and_b32 v41, s62, v24
    v_lshlrev_b32 v44, 16, v28
    v_and_b32 v45, s62, v28
    v_mul_f32 v40, s61, v40
    v_mul_f32 v41, s61, v41
    v_mul_f32 v44, -v44, v40
    v_mul_f32 v45, -v45, v41
    v_lshlrev_b32 v42, 16, v25
    v_and_b32 v43, s62, v25
    v_lshlrev_b32 v46, 16, v29
    v_and_b32 v47, s62, v29
    v_mul_f32 v42, s61, v42
    v_mul_f32 v43, s61, v43
    v_mul_f32 v46, -v46, v42
    v_mul_f32 v47, -v47, v43
    s_waitcnt vmcnt(22)
    v_lshlrev_b32 v48, 16, v26
    v_and_b32 v49, s62, v26
    v_lshlrev_b32 v52, 16, v30
    v_and_b32 v53, s62, v30
    v_mul_f32 v48, s61, v48
    v_mul_f32 v49, s61, v49
    v_mul_f32 v52, -v52, v48
    v_mul_f32 v53, -v53, v49
    v_lshlrev_b32 v50, 16, v27
    v_and_b32 v51, s62, v27
    v_lshlrev_b32 v54, 16, v31
    v_and_b32 v55, s62, v31
    v_mul_f32 v50, s61, v50
    v_mul_f32 v51, s61, v51
    v_mul_f32 v54, -v54, v50
    v_mul_f32 v55, -v55, v51
    s_waitcnt vmcnt(20)
    v_cvt_f32_i32 v224, v224
    v_cvt_f32_i32 v225, v225
    v_cvt_f32_i32 v226, v226
    v_cvt_f32_i32 v227, v227
    v_fma_f32 v224, v224, v40, v44
    v_fma_f32 v225, v225, v41, v45
    v_fma_f32 v226, v226, v42, v46
    v_fma_f32 v227, v227, v43, v47
    v_cvt_pk_bf16_f32 v128, v224, v225
    v_cvt_pk_bf16_f32 v129, v226, v227
    v_cvt_f32_i32 v228, v228
    v_cvt_f32_i32 v229, v229
    v_cvt_f32_i32 v230, v230
    v_cvt_f32_i32 v231, v231
    v_fma_f32 v228, v228, v40, v44
    v_fma_f32 v229, v229, v41, v45
    v_fma_f32 v230, v230, v42, v46
    v_fma_f32 v231, v231, v43, v47
    v_cvt_pk_bf16_f32 v132, v228, v229
    v_cvt_pk_bf16_f32 v133, v230, v231
    s_waitcnt vmcnt(18)
    v_cvt_f32_i32 v232, v232
    v_cvt_f32_i32 v233, v233
    v_cvt_f32_i32 v234, v234
    v_cvt_f32_i32 v235, v235
    v_fma_f32 v232, v232, v40, v44
    v_fma_f32 v233, v233, v41, v45
    v_fma_f32 v234, v234, v42, v46
    v_fma_f32 v235, v235, v43, v47
    v_cvt_pk_bf16_f32 v136, v232, v233
    v_cvt_pk_bf16_f32 v137, v234, v235
    v_cvt_f32_i32 v236, v236
    v_cvt_f32_i32 v237, v237
    v_cvt_f32_i32 v238, v238
    v_cvt_f32_i32 v239, v239
    v_fma_f32 v236, v236, v40, v44
    v_fma_f32 v237, v237, v41, v45
    v_fma_f32 v238, v238, v42, v46
    v_fma_f32 v239, v239, v43, v47
    v_cvt_pk_bf16_f32 v140, v236, v237
    v_cvt_pk_bf16_f32 v141, v238, v239
    s_waitcnt vmcnt(16)
    v_cvt_f32_i32 v240, v240
    v_cvt_f32_i32 v241, v241
    v_cvt_f32_i32 v242, v242
    v_cvt_f32_i32 v243, v243
    v_fma_f32 v240, v240, v48, v52
    v_fma_f32 v241, v241, v49, v53
    v_fma_f32 v242, v242, v50, v54
    v_fma_f32 v243, v243, v51, v55
    v_cvt_pk_bf16_f32 v130, v240, v241
    v_cvt_pk_bf16_f32 v131, v242, v243
    v_cvt_f32_i32 v244, v244
    v_cvt_f32_i32 v245, v245
    v_cvt_f32_i32 v246, v246
    v_cvt_f32_i32 v247, v247
    v_fma_f32 v244, v244, v48, v52
    v_fma_f32 v245, v245, v49, v53
    v_fma_f32 v246, v246, v50, v54
    v_fma_f32 v247, v247, v51, v55
    v_cvt_pk_bf16_f32 v134, v244, v245
    v_cvt_pk_bf16_f32 v135, v246, v247
    buffer_store_dwordx4 v[128:131], v6, s[36:39], s60 offen offset:0
    buffer_store_dwordx4 v[132:135], v6, s[36:39], s60 offen offset:128
    s_waitcnt vmcnt(16)
    v_cvt_f32_i32 v248, v248
    v_cvt_f32_i32 v249, v249
    v_cvt_f32_i32 v250, v250
    v_cvt_f32_i32 v251, v251
    v_fma_f32 v248, v248, v48, v52
    v_fma_f32 v249, v249, v49, v53
    v_fma_f32 v250, v250, v50, v54
    v_fma_f32 v251, v251, v51, v55
    v_cvt_pk_bf16_f32 v138, v248, v249
    v_cvt_pk_bf16_f32 v139, v250, v251
    v_cvt_f32_i32 v252, v252
    v_cvt_f32_i32 v253, v253
    v_cvt_f32_i32 v254, v254
    v_cvt_f32_i32 v255, v255
    v_fma_f32 v252, v252, v48, v52
    v_fma_f32 v253, v253, v49, v53
    v_fma_f32 v254, v254, v50, v54
    v_fma_f32 v255, v255, v51, v55
    v_cvt_pk_bf16_f32 v142, v252, v253
    v_cvt_pk_bf16_f32 v143, v254, v255
    buffer_store_dwordx4 v[136:139], v7, s[36:39], s60 offen offset:0
    buffer_store_dwordx4 v[140:143], v7, s[36:39], s60 offen offset:128
    s_waitcnt vmcnt(14)
    v_lshlrev_b32 v40, 16, v32
    v_and_b32 v41, s62, v32
    v_lshlrev_b32 v44, 16, v36
    v_and_b32 v45, s62, v36
    v_mul_f32 v40, s61, v40
    v_mul_f32 v41, s61, v41
    v_mul_f32 v44, -v44, v40
    v_mul_f32 v45, -v45, v41
    v_lshlrev_b32 v42, 16, v33
    v_and_b32 v43, s62, v33
    v_lshlrev_b32 v46, 16, v37
    v_and_b32 v47, s62, v37
    v_mul_f32 v42, s61, v42
    v_mul_f32 v43, s61, v43
    v_mul_f32 v46, -v46, v42
    v_mul_f32 v47, -v47, v43
    v_lshlrev_b32 v48, 16, v34
    v_and_b32 v49, s62, v34
    v_lshlrev_b32 v52, 16, v38
    v_and_b32 v53, s62, v38
    v_mul_f32 v48, s61, v48
    v_mul_f32 v49, s61, v49
    v_mul_f32 v52, -v52, v48
    v_mul_f32 v53, -v53, v49
    v_lshlrev_b32 v50, 16, v35
    v_and_b32 v51, s62, v35
    v_lshlrev_b32 v54, 16, v39
    v_and_b32 v55, s62, v39
    v_mul_f32 v50, s61, v50
    v_mul_f32 v51, s61, v51
    v_mul_f32 v54, -v54, v50
    v_mul_f32 v55, -v55, v51
    s_waitcnt vmcnt(12)
    v_cvt_f32_i32 v64, v64
    v_cvt_f32_i32 v65, v65
    v_cvt_f32_i32 v66, v66
    v_cvt_f32_i32 v67, v67
    v_fma_f32 v64, v64, v40, v44
    v_fma_f32 v65, v65, v41, v45
    v_fma_f32 v66, v66, v42, v46
    v_fma_f32 v67, v67, v43, v47
    v_cvt_pk_bf16_f32 v128, v64, v65
    v_cvt_pk_bf16_f32 v129, v66, v67
    v_cvt_f32_i32 v68, v68
    v_cvt_f32_i32 v69, v69
    v_cvt_f32_i32 v70, v70
    v_cvt_f32_i32 v71, v71
    v_fma_f32 v68, v68, v40, v44
    v_fma_f32 v69, v69, v41, v45
    v_fma_f32 v70, v70, v42, v46
    v_fma_f32 v71, v71, v43, v47
    v_cvt_pk_bf16_f32 v132, v68, v69
    v_cvt_pk_bf16_f32 v133, v70, v71
    s_waitcnt vmcnt(10)
    v_cvt_f32_i32 v72, v72
    v_cvt_f32_i32 v73, v73
    v_cvt_f32_i32 v74, v74
    v_cvt_f32_i32 v75, v75
    v_fma_f32 v72, v72, v40, v44
    v_fma_f32 v73, v73, v41, v45
    v_fma_f32 v74, v74, v42, v46
    v_fma_f32 v75, v75, v43, v47
    v_cvt_pk_bf16_f32 v136, v72, v73
    v_cvt_pk_bf16_f32 v137, v74, v75
    v_cvt_f32_i32 v76, v76
    v_cvt_f32_i32 v77, v77
    v_cvt_f32_i32 v78, v78
    v_cvt_f32_i32 v79, v79
    v_fma_f32 v76, v76, v40, v44
    v_fma_f32 v77, v77, v41, v45
    v_fma_f32 v78, v78, v42, v46
    v_fma_f32 v79, v79, v43, v47
    v_cvt_pk_bf16_f32 v140, v76, v77
    v_cvt_pk_bf16_f32 v141, v78, v79
    s_waitcnt vmcnt(8)
    v_cvt_f32_i32 v80, v80
    v_cvt_f32_i32 v81, v81
    v_cvt_f32_i32 v82, v82
    v_cvt_f32_i32 v83, v83
    v_fma_f32 v80, v80, v48, v52
    v_fma_f32 v81, v81, v49, v53
    v_fma_f32 v82, v82, v50, v54
    v_fma_f32 v83, v83, v51, v55
    v_cvt_pk_bf16_f32 v130, v80, v81
    v_cvt_pk_bf16_f32 v131, v82, v83
    v_cvt_f32_i32 v84, v84
    v_cvt_f32_i32 v85, v85
    v_cvt_f32_i32 v86, v86
    v_cvt_f32_i32 v87, v87
    v_fma_f32 v84, v84, v48, v52
    v_fma_f32 v85, v85, v49, v53
    v_fma_f32 v86, v86, v50, v54
    v_fma_f32 v87, v87, v51, v55
    v_cvt_pk_bf16_f32 v134, v84, v85
    v_cvt_pk_bf16_f32 v135, v86, v87
    buffer_store_dwordx4 v[128:131], v6, s[36:39], s63 offen offset:0
    buffer_store_dwordx4 v[132:135], v6, s[36:39], s63 offen offset:128
    s_waitcnt vmcnt(8)
    v_cvt_f32_i32 v88, v88
    v_cvt_f32_i32 v89, v89
    v_cvt_f32_i32 v90, v90
    v_cvt_f32_i32 v91, v91
    v_fma_f32 v88, v88, v48, v52
    v_fma_f32 v89, v89, v49, v53
    v_fma_f32 v90, v90, v50, v54
    v_fma_f32 v91, v91, v51, v55
    v_cvt_pk_bf16_f32 v138, v88, v89
    v_cvt_pk_bf16_f32 v139, v90, v91
    v_cvt_f32_i32 v92, v92
    v_cvt_f32_i32 v93, v93
    v_cvt_f32_i32 v94, v94
    v_cvt_f32_i32 v95, v95
    v_fma_f32 v92, v92, v48, v52
    v_fma_f32 v93, v93, v49, v53
    v_fma_f32 v94, v94, v50, v54
    v_fma_f32 v95, v95, v51, v55
    v_cvt_pk_bf16_f32 v142, v92, v93
    v_cvt_pk_bf16_f32 v143, v94, v95
    buffer_store_dwordx4 v[136:139], v7, s[36:39], s63 offen offset:0
    buffer_store_dwordx4 v[140:143], v7, s[36:39], s63 offen offset:128
    s_add_u32 s60, s60, 98304
    s_getreg_b32 s64, hwreg(HW_REG_XCC_ID, 0, 3)
    s_lshl_b32 s64, s64, 5
    s_lshl_b32 s63, s44, 8
    s_add_u32 s64, s64, 2
    s_add_u32 s64, s64, s63
    s_lshr_b64 s[44:45], s[44:45], 24
    s_mov_b32 s57, s44
    s_sub_u32 s63, s64, 524288
    v_mov_b32 v10, s64
    v_mov_b32 v11, s57
    s_lshl_b32 s19, s18, 3
    s_add_u32 s19, s19, 128
    s_cmp_eq_u32 s16, 0
    s_cselect_b32 s19, s19, 4096
    v_max_u32 v16, s19, v9
    v_lshrrev_b32 v17, 4, v13
    v_lshlrev_b32 v17, 3, v17
    s_waitcnt vmcnt(0)
    s_barrier
    buffer_store_dwordx2 v[10:11], v16, s[40:43], 0 offen
    buffer_store_dword v10, v9, s[40:43], 0 offen
    v_add_u32 v10, 1, v10
    buffer_load_dwordx4 v[200:203], v14, s[4:7], s55 offen offset:0 nt
    buffer_load_dwordx4 v[204:207], v14, s[4:7], s56 offen offset:0 nt
    buffer_load_dwordx4 v[208:211], v14, s[4:7], s23 offen offset:64 nt
    buffer_load_dwordx4 v[212:215], v14, s[4:7], s54 offen offset:64 nt
    buffer_load_dwordx4 v[216:219], v14, s[4:7], s55 offen offset:64 nt
    buffer_load_dwordx4 v[220:223], v14, s[4:7], s56 offen offset:64 nt
    buffer_load_dwordx2 v[24:25], v8, s[28:31], s59 offen offset:0
    buffer_load_dwordx2 v[28:29], v8, s[32:35], s59 offen offset:0
    buffer_load_dwordx2 v[26:27], v8, s[28:31], s59 offen offset:8
    buffer_load_dwordx2 v[30:31], v8, s[32:35], s59 offen offset:8
    buffer_load_dwordx4 v[224:227], v4, s[24:27], s58 offen offset:0 nt
    buffer_load_dwordx4 v[228:231], v5, s[24:27], s58 offen offset:0 nt
    buffer_load_dwordx4 a[192:195], v14, s[4:7], s23 offen offset:128 nt
    buffer_load_dwordx4 a[196:199], v14, s[4:7], s54 offen offset:128 nt
    buffer_load_dwordx4 a[200:203], v14, s[4:7], s55 offen offset:128 nt
    buffer_load_dwordx4 a[204:207], v14, s[4:7], s56 offen offset:128 nt
    buffer_load_dwordx4 a[208:211], v14, s[4:7], s23 offen offset:192 nt
    buffer_load_dwordx4 a[212:215], v14, s[4:7], s54 offen offset:192 nt
    buffer_load_dwordx4 a[216:219], v14, s[4:7], s55 offen offset:192 nt
    buffer_load_dwordx4 a[220:223], v14, s[4:7], s56 offen offset:192 nt
    buffer_load_dwordx4 a[224:227], v14, s[4:7], s23 offen offset:256 nt
    buffer_load_dwordx4 a[228:231], v14, s[4:7], s54 offen offset:256 nt
    buffer_load_dwordx4 a[232:235], v14, s[4:7], s55 offen offset:256 nt
    buffer_load_dwordx4 a[236:239], v14, s[4:7], s56 offen offset:256 nt
    buffer_load_dwordx4 a[240:243], v14, s[4:7], s23 offen offset:320 nt
    buffer_load_dwordx4 a[244:247], v14, s[4:7], s54 offen offset:320 nt
    buffer_load_dwordx4 a[248:251], v14, s[4:7], s55 offen offset:320 nt
    buffer_load_dwordx4 a[252:255], v14, s[4:7], s56 offen offset:320 nt
    s_mov_b32 s52, 1024
SPOLL_A:
    s_load_dwordx8 s[44:51], s[40:41], 128 glc
    s_load_dwordx8 s[64:71], s[40:41], 160 glc
    s_sub_u32 s52, s52, 1
    s_waitcnt lgkmcnt(0)
    s_sub_u32 s44, s44, s63
    s_xor_b32 s45, s45, s57
    s_sub_u32 s46, s46, s63
    s_xor_b32 s47, s47, s57
    s_sub_u32 s48, s48, s63
    s_xor_b32 s49, s49, s57
    s_sub_u32 s50, s50, s63
    s_xor_b32 s51, s51, s57
    s_sub_u32 s64, s64, s63
    s_xor_b32 s65, s65, s57
    s_sub_u32 s66, s66, s63
    s_xor_b32 s67, s67, s57
    s_sub_u32 s68, s68, s63
    s_xor_b32 s69, s69, s57
    s_sub_u32 s70, s70, s63
    s_xor_b32 s71, s71, s57
    s_or_b64 s[44:45], s[44:45], s[64:65]
    s_or_b64 s[46:47], s[46:47], s[66:67]
    s_or_b64 s[48:49], s[48:49], s[68:69]
    s_or_b64 s[50:51], s[50:51], s[70:71]
    s_or_b64 s[44:45], s[44:45], s[46:47]
    s_or_b64 s[48:49], s[48:49], s[50:51]
    s_or_b64 s[44:45], s[44:45], s[48:49]
    s_and_b32 s44, s44, 0xfff000ff
    s_or_b32 s44, s44, s45
    s_cbranch_scc0 RET_A0
    s_cmp_lg_u32 s52, 0
    s_cbranch_scc1 SPOLL_A
    s_mov_b32 s10, 0
    s_mov_b32 s53, 1
RET_A0:
    buffer_load_dword v11, v17, s[40:43], 0 offen offset:128 sc1
    buffer_load_dwordx4 v[232:235], v4, s[24:27], s58 offen offset:3072 nt
    buffer_load_dwordx4 v[236:239], v5, s[24:27], s58 offen offset:3072 nt
    buffer_load_dwordx4 v[240:243], v4, s[24:27], s58 offen offset:16 nt
    buffer_load_dwordx4 v[244:247], v5, s[24:27], s58 offen offset:16 nt
    buffer_load_dwordx4 v[248:251], v4, s[24:27], s58 offen offset:3088 nt
    buffer_load_dwordx4 v[252:255], v5, s[24:27], s58 offen offset:3088 nt
    s_waitcnt vmcnt(27)
    v_lshlrev_b32 v40, 16, v24
    v_and_b32 v41, s62, v24
    v_lshlrev_b32 v44, 16, v28
    v_and_b32 v45, s62, v28
    v_mul_f32 v40, s61, v40
    v_mul_f32 v41, s61, v41
    v_mul_f32 v44, -v44, v40
    v_mul_f32 v45, -v45, v41
    v_lshlrev_b32 v42, 16, v25
    v_and_b32 v43, s62, v25
    v_lshlrev_b32 v46, 16, v29
    v_and_b32 v47, s62, v29
    v_mul_f32 v42, s61, v42
    v_mul_f32 v43, s61, v43
    v_mul_f32 v46, -v46, v42
    v_mul_f32 v47, -v47, v43
    buffer_load_dwordx2 v[24:25], v8, s[28:31], s59 offen offset:1536
    buffer_load_dwordx2 v[28:29], v8, s[32:35], s59 offen offset:1536
    s_add_u32 s59, s59, 1536
    s_waitcnt vmcnt(25)
    v_cvt_f32_i32 v224, v224
    v_cvt_f32_i32 v225, v225
    v_cvt_f32_i32 v226, v226
    v_cvt_f32_i32 v227, v227
    v_fma_f32 v224, v224, v40, v44
    v_fma_f32 v225, v225, v41, v45
    v_fma_f32 v226, v226, v42, v46
    v_fma_f32 v227, v227, v43, v47
    v_cvt_pk_bf16_f32 v128, v224, v225
    v_cvt_pk_bf16_f32 v129, v226, v227
    v_cvt_f32_i32 v228, v228
    v_cvt_f32_i32 v229, v229
    v_cvt_f32_i32 v230, v230
    v_cvt_f32_i32 v231, v231
    v_fma_f32 v228, v228, v40, v44
    v_fma_f32 v229, v229, v41, v45
    v_fma_f32 v230, v230, v42, v46
    v_fma_f32 v231, v231, v43, v47
    v_cvt_pk_bf16_f32 v132, v228, v229
    v_cvt_pk_bf16_f32 v133, v230, v231
    s_waitcnt vmcnt(27)
    v_lshlrev_b32 v48, 16, v26
    v_and_b32 v49, s62, v26
    v_lshlrev_b32 v52, 16, v30
    v_and_b32 v53, s62, v30
    v_mul_f32 v48, s61, v48
    v_mul_f32 v49, s61, v49
    v_mul_f32 v52, -v52, v48
    v_mul_f32 v53, -v53, v49
    s_waitcnt vmcnt(9) lgkmcnt(0)
    s_barrier
    ds_read_b128 v[160:163], v2 offset:12288
    ds_read_b128 v[164:167], v2 offset:13312
    ds_read_b128 v[168:171], v2 offset:14336
    ds_read_b128 v[172:175], v2 offset:15360
    s_waitcnt vmcnt(6) lgkmcnt(0)
    v_mfma_f32_16x16x32_bf16 v[64:67], v[160:163], v[192:195], 0
    v_cvt_f32_i32 v232, v232
    v_cvt_f32_i32 v233, v233
    v_mfma_f32_16x16x32_bf16 v[72:75], v[160:163], v[196:199], 0
    ds_read_b128 v[176:179], v2 offset:16384
    ds_read_b128 v[180:183], v2 offset:17408
    v_mfma_f32_16x16x32_bf16 v[80:83], v[160:163], v[200:203], 0
    v_cvt_f32_i32 v234, v234
    v_cvt_f32_i32 v235, v235
    v_mfma_f32_16x16x32_bf16 v[88:91], v[160:163], v[204:207], 0
    ds_read_b128 v[184:187], v2 offset:18432
    ds_read_b128 v[188:191], v2 offset:19456
    v_mfma_f32_16x16x32_bf16 v[64:67], v[164:167], v[208:211], v[64:67]
    s_add_u32 m0, s21, 0
    v_fma_f32 v232, v232, v40, v44
    v_mfma_f32_16x16x32_bf16 v[72:75], v[164:167], v[212:215], v[72:75]
    buffer_load_dwordx4 v1, s[8:11], s20 offen offset:0 sc1 lds
    v_fma_f32 v233, v233, v41, v45
    v_mfma_f32_16x16x32_bf16 v[80:83], v[164:167], v[216:219], v[80:83]
    v_fma_f32 v234, v234, v42, v46
    v_fma_f32 v235, v235, v43, v47
    v_mfma_f32_16x16x32_bf16 v[88:91], v[164:167], v[220:223], v[88:91]
    v_cvt_pk_bf16_f32 v136, v232, v233
    v_cvt_pk_bf16_f32 v137, v234, v235
    v_mfma_f32_16x16x32_bf16 v[64:67], v[168:171], a[192:195], v[64:67]
    v_cvt_f32_i32 v236, v236
    v_cvt_f32_i32 v237, v237
    v_mfma_f32_16x16x32_bf16 v[72:75], v[168:171], a[196:199], v[72:75]
    buffer_load_dwordx4 v1, s[8:11], s20 offen offset:1024 sc1 lds
    v_cvt_f32_i32 v238, v238
    v_mfma_f32_16x16x32_bf16 v[80:83], v[168:171], a[200:203], v[80:83]
    v_cvt_f32_i32 v239, v239
    v_fma_f32 v236, v236, v40, v44
    v_mfma_f32_16x16x32_bf16 v[88:91], v[168:171], a[204:207], v[88:91]
    v_fma_f32 v237, v237, v41, v45
    v_fma_f32 v238, v238, v42, v46
    v_mfma_f32_16x16x32_bf16 v[64:67], v[172:175], a[208:211], v[64:67]
    v_fma_f32 v239, v239, v43, v47
    v_cvt_pk_bf16_f32 v140, v236, v237
    v_mfma_f32_16x16x32_bf16 v[72:75], v[172:175], a[212:215], v[72:75]
    buffer_load_dwordx4 v1, s[8:11], s20 offen offset:2048 sc1 lds
    v_cvt_pk_bf16_f32 v141, v238, v239
    v_mfma_f32_16x16x32_bf16 v[80:83], v[172:175], a[216:219], v[80:83]
    v_lshlrev_b32 v50, 16, v27
    v_and_b32 v51, s62, v27
    v_mfma_f32_16x16x32_bf16 v[88:91], v[172:175], a[220:223], v[88:91]
    v_lshlrev_b32 v54, 16, v31
    s_waitcnt vmcnt(30) lgkmcnt(0)
    v_mfma_f32_16x16x32_bf16 v[64:67], v[176:179], a[224:227], v[64:67]
    v_and_b32 v55, s62, v31
    v_mul_f32 v50, s61, v50
    v_mfma_f32_16x16x32_bf16 v[72:75], v[176:179], a[228:231], v[72:75]
    ds_read_b128 v[160:163], v2 offset:20480
    ds_read_b128 v[164:167], v2 offset:21504
    v_mfma_f32_16x16x32_bf16 v[80:83], v[176:179], a[232:235], v[80:83]
    buffer_load_dwordx4 v1, s[8:11], s20 offen offset:3072 sc1 lds
    v_mul_f32 v51, s61, v51
    v_mfma_f32_16x16x32_bf16 v[88:91], v[176:179], a[236:239], v[88:91]
    ds_read_b128 v[168:171], v2 offset:22528
    ds_read_b128 v[172:175], v2 offset:23552
    v_mfma_f32_16x16x32_bf16 v[64:67], v[180:183], a[240:243], v[64:67]
    s_add_u32 m0, s21, 4096
    v_mul_f32 v54, -v54, v50
    v_mfma_f32_16x16x32_bf16 v[72:75], v[180:183], a[244:247], v[72:75]
    buffer_load_dwordx4 v3, s[8:11], s20 offen offset:0 sc1 lds
    v_mul_f32 v55, -v55, v51
    v_mfma_f32_16x16x32_bf16 v[80:83], v[180:183], a[248:251], v[80:83]
    buffer_load_dwordx2 v[26:27], v8, s[28:31], s59 offen offset:8
    buffer_load_dwordx2 v[30:31], v8, s[32:35], s59 offen offset:8
    v_mfma_f32_16x16x32_bf16 v[88:91], v[180:183], a[252:255], v[88:91]
    v_mfma_f32_16x16x32_bf16 v[68:71], v[184:187], v[192:195], 0
    v_mfma_f32_16x16x32_bf16 v[76:79], v[184:187], v[196:199], 0
    buffer_load_dwordx4 v3, s[8:11], s20 offen offset:1024 sc1 lds
    v_mfma_f32_16x16x32_bf16 v[84:87], v[184:187], v[200:203], 0
    s_add_u32 s20, s20, 12288
    s_add_u32 s58, s58, 98304
    v_mfma_f32_16x16x32_bf16 v[92:95], v[184:187], v[204:207], 0
    v_mfma_f32_16x16x32_bf16 v[68:71], v[188:191], v[208:211], v[68:71]
    buffer_load_dwordx4 v[224:227], v4, s[24:27], s58 offen offset:0 nt
    v_mfma_f32_16x16x32_bf16 v[76:79], v[188:191], v[212:215], v[76:79]
    v_mfma_f32_16x16x32_bf16 v[84:87], v[188:191], v[216:219], v[84:87]
    buffer_load_dwordx4 v[228:231], v5, s[24:27], s58 offen offset:0 nt
    v_mfma_f32_16x16x32_bf16 v[92:95], v[188:191], v[220:223], v[92:95]
    s_waitcnt lgkmcnt(0)
    s_barrier
    v_mfma_f32_16x16x32_bf16 v[68:71], v[160:163], a[192:195], v[68:71]
    v_mfma_f32_16x16x32_bf16 v[76:79], v[160:163], a[196:199], v[76:79]
    ds_read_b128 v[176:179], v2 offset:36864
    ds_read_b128 v[180:183], v2 offset:37888
    v_mfma_f32_16x16x32_bf16 v[84:87], v[160:163], a[200:203], v[84:87]
    v_mfma_f32_16x16x32_bf16 v[92:95], v[160:163], a[204:207], v[92:95]
    ds_read_b128 v[184:187], v2 offset:38912
    ds_read_b128 v[188:191], v2 offset:39936
    v_mfma_f32_16x16x32_bf16 v[68:71], v[164:167], a[208:211], v[68:71]
    v_mfma_f32_16x16x32_bf16 v[76:79], v[164:167], a[212:215], v[76:79]
    v_mfma_f32_16x16x32_bf16 v[84:87], v[164:167], a[216:219], v[84:87]
    v_mfma_f32_16x16x32_bf16 v[92:95], v[164:167], a[220:223], v[92:95]
    v_mfma_f32_16x16x32_bf16 v[68:71], v[168:171], a[224:227], v[68:71]
    v_mfma_f32_16x16x32_bf16 v[76:79], v[168:171], a[228:231], v[76:79]
    v_mfma_f32_16x16x32_bf16 v[84:87], v[168:171], a[232:235], v[84:87]
    v_mfma_f32_16x16x32_bf16 v[92:95], v[168:171], a[236:239], v[92:95]
    v_mfma_f32_16x16x32_bf16 v[68:71], v[172:175], a[240:243], v[68:71]
    v_mfma_f32_16x16x32_bf16 v[76:79], v[172:175], a[244:247], v[76:79]
    v_mfma_f32_16x16x32_bf16 v[84:87], v[172:175], a[248:251], v[84:87]
    v_mfma_f32_16x16x32_bf16 v[92:95], v[172:175], a[252:255], v[92:95]
    s_waitcnt vmcnt(14) lgkmcnt(0)
    v_mfma_f32_16x16x32_bf16 v[96:99], v[176:179], v[192:195], 0
    v_exp_f32 v64, v64
    v_cvt_f32_i32 v240, v240
    v_mfma_f32_16x16x32_bf16 v[104:107], v[176:179], v[196:199], 0
    ds_read_b128 v[160:163], v2 offset:40960
    ds_read_b128 v[164:167], v2 offset:41984
    v_exp_f32 v65, v65
    v_cvt_f32_i32 v241, v241
    v_mfma_f32_16x16x32_bf16 v[112:115], v[176:179], v[200:203], 0
    buffer_load_dword v12, v13, s[40:43], 0 offen sc1
    v_exp_f32 v66, v66
    v_mfma_f32_16x16x32_bf16 v[120:123], v[176:179], v[204:207], 0
    ds_read_b128 v[168:171], v2 offset:43008
    ds_read_b128 v[172:175], v2 offset:44032
    v_add_f32 v144, v144, v64
    v_cvt_f32_i32 v242, v242
    v_mfma_f32_16x16x32_bf16 v[96:99], v[180:183], v[208:211], v[96:99]
    s_add_u32 m0, s21, 24576
    v_exp_f32 v67, v67
    v_cvt_f32_i32 v243, v243
    v_mfma_f32_16x16x32_bf16 v[104:107], v[180:183], v[212:215], v[104:107]
    buffer_load_dwordx4 v1, s[8:11], s20 offen offset:0 sc1 lds
    v_exp_f32 v68, v68
    v_mfma_f32_16x16x32_bf16 v[112:115], v[180:183], v[216:219], v[112:115]
    v_exp_f32 v69, v69
    v_add_f32 v145, v145, v65
    v_fma_f32 v240, v240, v48, v52
    v_mfma_f32_16x16x32_bf16 v[120:123], v[180:183], v[220:223], v[120:123]
    v_cvt_pk_bf16_f32 v64, v64, v65
    v_add_f32 v144, v144, v66
    v_add_f32 v145, v145, v67
    v_mfma_f32_16x16x32_bf16 v[96:99], v[184:187], a[192:195], v[96:99]
    v_exp_f32 v70, v70
    v_cvt_pk_bf16_f32 v65, v66, v67
    v_fma_f32 v241, v241, v49, v53
    v_mfma_f32_16x16x32_bf16 v[104:107], v[184:187], a[196:199], v[104:107]
    buffer_load_dwordx4 v1, s[8:11], s20 offen offset:1024 sc1 lds
    v_exp_f32 v71, v71
    v_fma_f32 v242, v242, v50, v54
    v_mfma_f32_16x16x32_bf16 v[112:115], v[184:187], a[200:203], v[112:115]
    v_add_f32 v144, v144, v68
    v_add_f32 v145, v145, v69
    v_cvt_pk_bf16_f32 v66, v68, v69
    v_mfma_f32_16x16x32_bf16 v[120:123], v[184:187], a[204:207], v[120:123]
    v_exp_f32 v72, v72
    v_add_f32 v144, v144, v70
    v_fma_f32 v243, v243, v51, v55
    v_mfma_f32_16x16x32_bf16 v[96:99], v[188:191], a[208:211], v[96:99]
    v_exp_f32 v73, v73
    v_add_f32 v145, v145, v71
    v_cvt_pk_bf16_f32 v130, v240, v241
    v_mfma_f32_16x16x32_bf16 v[104:107], v[188:191], a[212:215], v[104:107]
    buffer_load_dwordx4 v1, s[8:11], s20 offen offset:2048 sc1 lds
    v_exp_f32 v74, v74
    v_mfma_f32_16x16x32_bf16 v[112:115], v[188:191], a[216:219], v[112:115]
    v_cvt_pk_bf16_f32 v67, v70, v71
    v_add_f32 v146, v146, v72
    v_add_f32 v147, v147, v73
    v_cvt_pk_bf16_f32 v131, v242, v243
    v_mfma_f32_16x16x32_bf16 v[120:123], v[188:191], a[220:223], v[120:123]
    v_exp_f32 v75, v75
    s_waitcnt vmcnt(18) lgkmcnt(0)
    v_mfma_f32_16x16x32_bf16 v[96:99], v[160:163], a[224:227], v[96:99]
    v_exp_f32 v76, v76
    v_cvt_pk_bf16_f32 v72, v72, v73
    v_cvt_f32_i32 v244, v244
    v_mfma_f32_16x16x32_bf16 v[104:107], v[160:163], a[228:231], v[104:107]
    ds_read_b128 v[176:179], v2 offset:45056
    ds_read_b128 v[180:183], v2 offset:46080
    buffer_load_dwordx4 v1, s[8:11], s20 offen offset:3072 sc1 lds
    v_exp_f32 v77, v77
    v_cvt_f32_i32 v245, v245
    v_mfma_f32_16x16x32_bf16 v[112:115], v[160:163], a[232:235], v[112:115]
    v_add_f32 v146, v146, v74
    v_add_f32 v147, v147, v75
    v_cvt_pk_bf16_f32 v73, v74, v75
    v_mfma_f32_16x16x32_bf16 v[120:123], v[160:163], a[236:239], v[120:123]
    ds_read_b128 v[184:187], v2 offset:47104
    ds_read_b128 v[188:191], v2 offset:48128
    v_exp_f32 v78, v78
    v_cvt_f32_i32 v246, v246
    v_mfma_f32_16x16x32_bf16 v[96:99], v[164:167], a[240:243], v[96:99]
    s_add_u32 m0, s21, 28672
    v_exp_f32 v79, v79
    v_cvt_f32_i32 v247, v247
    v_mfma_f32_16x16x32_bf16 v[104:107], v[164:167], a[244:247], v[104:107]
    buffer_load_dwordx4 v3, s[8:11], s20 offen offset:0 sc1 lds
    v_add_f32 v146, v146, v76
    v_add_f32 v147, v147, v77
    v_mfma_f32_16x16x32_bf16 v[112:115], v[164:167], a[248:251], v[112:115]
    v_exp_f32 v80, v80
    v_cvt_pk_bf16_f32 v74, v76, v77
    v_fma_f32 v244, v244, v48, v52
    v_mfma_f32_16x16x32_bf16 v[120:123], v[164:167], a[252:255], v[120:123]
    v_exp_f32 v81, v81
    v_add_f32 v146, v146, v78
    v_mfma_f32_16x16x32_bf16 v[100:103], v[168:171], v[192:195], 0
    v_exp_f32 v82, v82
    v_add_f32 v147, v147, v79
    v_fma_f32 v245, v245, v49, v53
    v_mfma_f32_16x16x32_bf16 v[108:111], v[168:171], v[196:199], 0
    buffer_load_dwordx4 v3, s[8:11], s20 offen offset:1024 sc1 lds
    v_cvt_pk_bf16_f32 v75, v78, v79
    v_add_f32 v148, v148, v80
    v_fma_f32 v246, v246, v50, v54
    v_mfma_f32_16x16x32_bf16 v[116:119], v[168:171], v[200:203], 0
    s_add_u32 s20, s20, 12288
    v_exp_f32 v83, v83
    v_mfma_f32_16x16x32_bf16 v[124:127], v[168:171], v[204:207], 0
    v_exp_f32 v84, v84
    v_add_f32 v149, v149, v81
    v_fma_f32 v247, v247, v51, v55
    v_mfma_f32_16x16x32_bf16 v[100:103], v[172:175], v[208:211], v[100:103]
    buffer_load_dwordx4 v[232:235], v4, s[24:27], s58 offen offset:3072 nt
    v_exp_f32 v85, v85
    v_cvt_pk_bf16_f32 v134, v244, v245
    v_mfma_f32_16x16x32_bf16 v[108:111], v[172:175], v[212:215], v[108:111]
    v_cvt_pk_bf16_f32 v80, v80, v81
    v_add_f32 v148, v148, v82
    v_add_f32 v149, v149, v83
    v_mfma_f32_16x16x32_bf16 v[116:119], v[172:175], v[216:219], v[116:119]
    buffer_load_dwordx4 v[236:239], v5, s[24:27], s58 offen offset:3072 nt
    v_exp_f32 v86, v86
    v_cvt_pk_bf16_f32 v135, v246, v247
    v_mfma_f32_16x16x32_bf16 v[124:127], v[172:175], v[220:223], v[124:127]
    v_exp_f32 v87, v87
    s_waitcnt vmcnt(11) lgkmcnt(0)
    s_barrier
    v_mfma_f32_16x16x32_bf16 v[100:103], v[176:179], a[192:195], v[100:103]
    v_cvt_pk_bf16_f32 v81, v82, v83
    v_add_f32 v148, v148, v84
    v_add_f32 v149, v149, v85
    buffer_store_dwordx4 v[128:131], v6, s[36:39], s60 offen offset:0 sc1
    v_mfma_f32_16x16x32_bf16 v[108:111], v[176:179], a[196:199], v[108:111]
    ds_read_b128 v[160:163], v1 offset:0
    ds_read_b128 v[164:167], v1 offset:1024
    v_exp_f32 v88, v88
    buffer_store_dwordx4 v[132:135], v6, s[36:39], s60 offen offset:128 sc1
    v_mfma_f32_16x16x32_bf16 v[116:119], v[176:179], a[200:203], v[116:119]
    v_exp_f32 v89, v89
    v_cvt_pk_bf16_f32 v82, v84, v85
    v_mfma_f32_16x16x32_bf16 v[124:127], v[176:179], a[204:207], v[124:127]
    ds_read_b128 v[168:171], v1 offset:2048
    ds_read_b128 v[172:175], v1 offset:3072
    v_exp_f32 v90, v90
    v_lshlrev_b32 v40, 16, v24
    v_mfma_f32_16x16x32_bf16 v[100:103], v[180:183], a[208:211], v[100:103]
    v_add_f32 v148, v148, v86
    v_add_f32 v149, v149, v87
    v_cvt_pk_bf16_f32 v83, v86, v87
    v_and_b32 v41, s62, v24
    v_mfma_f32_16x16x32_bf16 v[108:111], v[180:183], a[212:215], v[108:111]
    v_exp_f32 v91, v91
    v_add_f32 v150, v150, v88
    v_mfma_f32_16x16x32_bf16 v[116:119], v[180:183], a[216:219], v[116:119]
    v_exp_f32 v92, v92
    v_add_f32 v151, v151, v89
    v_lshlrev_b32 v44, 16, v28
    v_mfma_f32_16x16x32_bf16 v[124:127], v[180:183], a[220:223], v[124:127]
    v_exp_f32 v93, v93
    v_cvt_pk_bf16_f32 v88, v88, v89
    v_mfma_f32_16x16x32_bf16 v[100:103], v[184:187], a[224:227], v[100:103]
    v_add_f32 v150, v150, v90
    v_add_f32 v151, v151, v91
    v_cvt_pk_bf16_f32 v89, v90, v91
    v_and_b32 v45, s62, v28
    v_mfma_f32_16x16x32_bf16 v[108:111], v[184:187], a[228:231], v[108:111]
    v_exp_f32 v94, v94
    v_add_f32 v150, v150, v92
    v_mul_f32 v40, s61, v40
    v_mfma_f32_16x16x32_bf16 v[116:119], v[184:187], a[232:235], v[116:119]
    v_exp_f32 v95, v95
    v_add_f32 v151, v151, v93
    v_mfma_f32_16x16x32_bf16 v[124:127], v[184:187], a[236:239], v[124:127]
    v_cvt_pk_bf16_f32 v90, v92, v93
    v_add_f32 v150, v150, v94
    v_add_f32 v151, v151, v95
    v_mul_f32 v41, s61, v41
    v_mfma_f32_16x16x32_bf16 v[100:103], v[188:191], a[240:243], v[100:103]
    v_cvt_pk_bf16_f32 v91, v94, v95
    v_mul_f32 v44, -v44, v40
    v_mfma_f32_16x16x32_bf16 v[108:111], v[188:191], a[244:247], v[108:111]
    v_mfma_f32_16x16x32_bf16 v[116:119], v[188:191], a[248:251], v[116:119]
    v_mul_f32 v45, -v45, v41
    v_mfma_f32_16x16x32_bf16 v[124:127], v[188:191], a[252:255], v[124:127]
    s_mov_b32 s57, 15
.p2align 6
LOOP_A:
    s_waitcnt vmcnt(10) lgkmcnt(0)
    v_mfma_f32_16x16x32_bf16 a[0:3], v[64:67], v[160:163], a[0:3]
    v_sub_u32 v12, v12, v11
    v_cmp_lt_u32 vcc, 31, v12
    v_mfma_f32_16x16x32_bf16 a[48:51], v[72:75], v[160:163], a[48:51]
    ds_read_b128 v[176:179], v1 offset:4096
    ds_read_b128 v[180:183], v1 offset:5120
    v_mfma_f32_16x16x32_bf16 a[96:99], v[80:83], v[160:163], a[96:99]
    s_cbranch_vccnz SPIN_A
RET_A:
    v_add_u32 v11, 1, v11
    v_mfma_f32_16x16x32_bf16 a[144:147], v[88:91], v[160:163], a[144:147]
    ds_read_b128 v[184:187], v1 offset:6144
    ds_read_b128 v[188:191], v1 offset:7168
    v_mfma_f32_16x16x32_bf16 a[4:7], v[64:67], v[164:167], a[4:7]
    s_add_u32 m0, s21, 49152
    v_cvt_f32_i32 v248, v248
    v_mfma_f32_16x16x32_bf16 a[52:55], v[72:75], v[164:167], a[52:55]
    buffer_load_dwordx4 v1, s[8:11], s20 offen offset:0 sc1 lds
    v_cvt_f32_i32 v249, v249
    v_mfma_f32_16x16x32_bf16 a[100:103], v[80:83], v[164:167], a[100:103]
    v_exp_f32 v96, v96
    v_mfma_f32_16x16x32_bf16 a[148:151], v[88:91], v[164:167], a[148:151]
    v_exp_f32 v97, v97
    v_mfma_f32_16x16x32_bf16 a[8:11], v[64:67], v[168:171], a[8:11]
    v_add_f32 v144, v144, v96
    v_add_f32 v145, v145, v97
    v_mfma_f32_16x16x32_bf16 a[56:59], v[72:75], v[168:171], a[56:59]
    buffer_load_dwordx4 v1, s[8:11], s20 offen offset:1024 sc1 lds
    v_cvt_pk_bf16_f32 v96, v96, v97
    v_mfma_f32_16x16x32_bf16 a[104:107], v[80:83], v[168:171], a[104:107]
    v_exp_f32 v98, v98
    v_mfma_f32_16x16x32_bf16 a[152:155], v[88:91], v[168:171], a[152:155]
    v_add_f32 v144, v144, v98
    v_cvt_f32_i32 v250, v250
    v_mfma_f32_16x16x32_bf16 a[12:15], v[64:67], v[172:175], a[12:15]
    v_exp_f32 v99, v99
    v_mfma_f32_16x16x32_bf16 a[60:63], v[72:75], v[172:175], a[60:63]
    buffer_load_dwordx4 v1, s[8:11], s20 offen offset:2048 sc1 lds
    v_add_f32 v145, v145, v99
    v_mfma_f32_16x16x32_bf16 a[108:111], v[80:83], v[172:175], a[108:111]
    v_cvt_pk_bf16_f32 v97, v98, v99
    v_cvt_f32_i32 v251, v251
    v_mfma_f32_16x16x32_bf16 a[156:159], v[88:91], v[172:175], a[156:159]
    v_fma_f32 v248, v248, v48, v52
    s_waitcnt vmcnt(25) lgkmcnt(0)
    v_mfma_f32_16x16x32_bf16 a[16:19], v[64:67], v[176:179], a[16:19]
    v_exp_f32 v100, v100
    v_mfma_f32_16x16x32_bf16 a[64:67], v[72:75], v[176:179], a[64:67]
    ds_read_b128 v[160:163], v1 offset:8192
    ds_read_b128 v[164:167], v1 offset:9216
    v_mfma_f32_16x16x32_bf16 a[112:115], v[80:83], v[176:179], a[112:115]
    buffer_load_dwordx4 v1, s[8:11], s20 offen offset:3072 sc1 lds
    v_add_f32 v144, v144, v100
    v_mfma_f32_16x16x32_bf16 a[160:163], v[88:91], v[176:179], a[160:163]
    ds_read_b128 v[168:171], v1 offset:10240
    ds_read_b128 v[172:175], v1 offset:11264
    v_mfma_f32_16x16x32_bf16 a[20:23], v[64:67], v[180:183], a[20:23]
    s_add_u32 m0, s21, 53248
    v_fma_f32 v249, v249, v49, v53
    v_mfma_f32_16x16x32_bf16 a[68:71], v[72:75], v[180:183], a[68:71]
    buffer_load_dwordx4 v3, s[8:11], s20 offen offset:0 sc1 lds
    v_fma_f32 v250, v250, v50, v54
    v_mfma_f32_16x16x32_bf16 a[116:119], v[80:83], v[180:183], a[116:119]
    v_fma_f32 v251, v251, v51, v55
    v_cvt_pk_bf16_f32 v138, v248, v249
    v_mfma_f32_16x16x32_bf16 a[164:167], v[88:91], v[180:183], a[164:167]
    v_exp_f32 v101, v101
    v_mfma_f32_16x16x32_bf16 a[24:27], v[64:67], v[184:187], a[24:27]
    v_add_f32 v145, v145, v101
    v_cvt_pk_bf16_f32 v98, v100, v101
    v_mfma_f32_16x16x32_bf16 a[72:75], v[72:75], v[184:187], a[72:75]
    buffer_load_dwordx4 v3, s[8:11], s20 offen offset:1024 sc1 lds
    v_cvt_pk_bf16_f32 v139, v250, v251
    v_mfma_f32_16x16x32_bf16 a[120:123], v[80:83], v[184:187], a[120:123]
    s_add_u32 s20, s20, 12288
    v_cvt_f32_i32 v252, v252
    v_mfma_f32_16x16x32_bf16 a[168:171], v[88:91], v[184:187], a[168:171]
    v_exp_f32 v102, v102
    v_mfma_f32_16x16x32_bf16 a[28:31], v[64:67], v[188:191], a[28:31]
    v_add_f32 v144, v144, v102
    v_cvt_f32_i32 v253, v253
    v_mfma_f32_16x16x32_bf16 a[76:79], v[72:75], v[188:191], a[76:79]
    v_exp_f32 v103, v103
    v_mfma_f32_16x16x32_bf16 a[124:127], v[80:83], v[188:191], a[124:127]
    buffer_load_dwordx4 v[240:243], v4, s[24:27], s58 offen offset:16 nt
    v_add_f32 v145, v145, v103
    v_mfma_f32_16x16x32_bf16 a[172:175], v[88:91], v[188:191], a[172:175]
    v_cvt_pk_bf16_f32 v99, v102, v103
    s_waitcnt vmcnt(29) lgkmcnt(0)
    v_mfma_f32_16x16x32_bf16 a[32:35], v[64:67], v[160:163], a[32:35]
    v_cvt_f32_i32 v254, v254
    v_cvt_f32_i32 v255, v255
    v_mfma_f32_16x16x32_bf16 a[80:83], v[72:75], v[160:163], a[80:83]
    ds_read_b128 v[176:179], v1 offset:12288
    ds_read_b128 v[180:183], v1 offset:13312
    v_mfma_f32_16x16x32_bf16 a[128:131], v[80:83], v[160:163], a[128:131]
    buffer_load_dwordx4 v[244:247], v5, s[24:27], s58 offen offset:16 nt
    v_fma_f32 v252, v252, v48, v52
    v_mfma_f32_16x16x32_bf16 a[176:179], v[88:91], v[160:163], a[176:179]
    ds_read_b128 v[184:187], v1 offset:14336
    ds_read_b128 v[188:191], v1 offset:15360
    v_mfma_f32_16x16x32_bf16 a[36:39], v[64:67], v[164:167], a[36:39]
    v_exp_f32 v104, v104
    v_mfma_f32_16x16x32_bf16 a[84:87], v[72:75], v[164:167], a[84:87]
    v_exp_f32 v105, v105
    v_mfma_f32_16x16x32_bf16 a[132:135], v[80:83], v[164:167], a[132:135]
    v_add_f32 v146, v146, v104
    v_add_f32 v147, v147, v105
    v_mfma_f32_16x16x32_bf16 a[180:183], v[88:91], v[164:167], a[180:183]
    v_exp_f32 v106, v106
    v_mfma_f32_16x16x32_bf16 a[40:43], v[64:67], v[168:171], a[40:43]
    v_cvt_pk_bf16_f32 v104, v104, v105
    v_add_f32 v146, v146, v106
    v_mfma_f32_16x16x32_bf16 a[88:91], v[72:75], v[168:171], a[88:91]
    v_exp_f32 v107, v107
    v_mfma_f32_16x16x32_bf16 a[136:139], v[80:83], v[168:171], a[136:139]
    v_add_f32 v147, v147, v107
    v_cvt_pk_bf16_f32 v105, v106, v107
    v_mfma_f32_16x16x32_bf16 a[184:187], v[88:91], v[168:171], a[184:187]
    v_exp_f32 v108, v108
    v_mfma_f32_16x16x32_bf16 a[44:47], v[64:67], v[172:175], a[44:47]
    v_add_f32 v146, v146, v108
    v_fma_f32 v253, v253, v49, v53
    v_mfma_f32_16x16x32_bf16 a[92:95], v[72:75], v[172:175], a[92:95]
    v_exp_f32 v109, v109
    v_mfma_f32_16x16x32_bf16 a[140:143], v[80:83], v[172:175], a[140:143]
    v_add_f32 v147, v147, v109
    v_cvt_pk_bf16_f32 v106, v108, v109
    v_mfma_f32_16x16x32_bf16 a[188:191], v[88:91], v[172:175], a[188:191]
    v_fma_f32 v254, v254, v50, v54
    s_waitcnt vmcnt(30) lgkmcnt(0)
    v_mfma_f32_16x16x32_bf16 v[64:67], v[176:179], v[192:195], 0
    v_exp_f32 v110, v110
    v_mfma_f32_16x16x32_bf16 v[72:75], v[176:179], v[196:199], 0
    ds_read_b128 v[160:163], v1 offset:16384
    ds_read_b128 v[164:167], v1 offset:17408
    v_mfma_f32_16x16x32_bf16 v[80:83], v[176:179], v[200:203], 0
    v_add_f32 v146, v146, v110
    v_fma_f32 v255, v255, v51, v55
    v_mfma_f32_16x16x32_bf16 v[88:91], v[176:179], v[204:207], 0
    ds_read_b128 v[168:171], v1 offset:18432
    ds_read_b128 v[172:175], v1 offset:19456
    v_mfma_f32_16x16x32_bf16 v[64:67], v[180:183], v[208:211], v[64:67]
    v_exp_f32 v111, v111
    v_mfma_f32_16x16x32_bf16 v[72:75], v[180:183], v[212:215], v[72:75]
    v_add_f32 v147, v147, v111
    v_cvt_pk_bf16_f32 v107, v110, v111
    v_mfma_f32_16x16x32_bf16 v[80:83], v[180:183], v[216:219], v[80:83]
    v_exp_f32 v112, v112
    v_mfma_f32_16x16x32_bf16 v[88:91], v[180:183], v[220:223], v[88:91]
    v_exp_f32 v113, v113
    v_mfma_f32_16x16x32_bf16 v[64:67], v[184:187], a[192:195], v[64:67]
    v_add_f32 v148, v148, v112
    v_add_f32 v149, v149, v113
    v_mfma_f32_16x16x32_bf16 v[72:75], v[184:187], a[196:199], v[72:75]
    v_exp_f32 v114, v114
    v_mfma_f32_16x16x32_bf16 v[80:83], v[184:187], a[200:203], v[80:83]
    v_cvt_pk_bf16_f32 v112, v112, v113
    v_add_f32 v148, v148, v114
    v_mfma_f32_16x16x32_bf16 v[88:91], v[184:187], a[204:207], v[88:91]
    v_exp_f32 v115, v115
    v_mfma_f32_16x16x32_bf16 v[64:67], v[188:191], a[208:211], v[64:67]
    v_add_f32 v149, v149, v115
    v_cvt_pk_bf16_f32 v113, v114, v115
    v_mfma_f32_16x16x32_bf16 v[72:75], v[188:191], a[212:215], v[72:75]
    v_exp_f32 v116, v116
    v_mfma_f32_16x16x32_bf16 v[80:83], v[188:191], a[216:219], v[80:83]
    v_add_f32 v148, v148, v116
    v_cvt_pk_bf16_f32 v142, v252, v253
    v_mfma_f32_16x16x32_bf16 v[88:91], v[188:191], a[220:223], v[88:91]
    v_cvt_pk_bf16_f32 v143, v254, v255
    s_waitcnt lgkmcnt(0)
    v_mfma_f32_16x16x32_bf16 v[64:67], v[160:163], a[224:227], v[64:67]
    v_exp_f32 v117, v117
    v_mfma_f32_16x16x32_bf16 v[72:75], v[160:163], a[228:231], v[72:75]
    ds_read_b128 v[176:179], v1 offset:20480
    ds_read_b128 v[180:183], v1 offset:21504
    v_mfma_f32_16x16x32_bf16 v[80:83], v[160:163], a[232:235], v[80:83]
    v_add_f32 v149, v149, v117
    v_cvt_pk_bf16_f32 v114, v116, v117
    v_mfma_f32_16x16x32_bf16 v[88:91], v[160:163], a[236:239], v[88:91]
    ds_read_b128 v[184:187], v1 offset:22528
    ds_read_b128 v[188:191], v1 offset:23552
    v_mfma_f32_16x16x32_bf16 v[64:67], v[164:167], a[240:243], v[64:67]
    v_exp_f32 v118, v118
    v_mfma_f32_16x16x32_bf16 v[72:75], v[164:167], a[244:247], v[72:75]
    v_add_f32 v148, v148, v118
    buffer_store_dwordx4 v[136:139], v7, s[36:39], s60 offen offset:0 sc1
    v_mfma_f32_16x16x32_bf16 v[80:83], v[164:167], a[248:251], v[80:83]
    v_exp_f32 v119, v119
    v_mfma_f32_16x16x32_bf16 v[88:91], v[164:167], a[252:255], v[88:91]
    v_add_f32 v149, v149, v119
    v_cvt_pk_bf16_f32 v115, v118, v119
    v_mfma_f32_16x16x32_bf16 v[68:71], v[168:171], v[192:195], 0
    v_exp_f32 v120, v120
    v_mfma_f32_16x16x32_bf16 v[76:79], v[168:171], v[196:199], 0
    v_exp_f32 v121, v121
    v_mfma_f32_16x16x32_bf16 v[84:87], v[168:171], v[200:203], 0
    v_add_f32 v150, v150, v120
    v_add_f32 v151, v151, v121
    v_mfma_f32_16x16x32_bf16 v[92:95], v[168:171], v[204:207], 0
    v_exp_f32 v122, v122
    v_mfma_f32_16x16x32_bf16 v[68:71], v[172:175], v[208:211], v[68:71]
    v_cvt_pk_bf16_f32 v120, v120, v121
    v_add_f32 v150, v150, v122
    v_mfma_f32_16x16x32_bf16 v[76:79], v[172:175], v[212:215], v[76:79]
    v_exp_f32 v123, v123
    v_mfma_f32_16x16x32_bf16 v[84:87], v[172:175], v[216:219], v[84:87]
    v_add_f32 v151, v151, v123
    v_cvt_pk_bf16_f32 v121, v122, v123
    v_mfma_f32_16x16x32_bf16 v[92:95], v[172:175], v[220:223], v[92:95]
    s_waitcnt vmcnt(13) lgkmcnt(0)
    s_barrier
    v_mfma_f32_16x16x32_bf16 v[68:71], v[176:179], a[192:195], v[68:71]
    v_exp_f32 v124, v124
    v_mfma_f32_16x16x32_bf16 v[76:79], v[176:179], a[196:199], v[76:79]
    ds_read_b128 v[160:163], v1 offset:24576
    ds_read_b128 v[164:167], v1 offset:25600
    v_mfma_f32_16x16x32_bf16 v[84:87], v[176:179], a[200:203], v[84:87]
    v_add_f32 v150, v150, v124
    buffer_store_dwordx4 v[140:143], v7, s[36:39], s60 offen offset:128 sc1
    v_mfma_f32_16x16x32_bf16 v[92:95], v[176:179], a[204:207], v[92:95]
    ds_read_b128 v[168:171], v1 offset:26624
    ds_read_b128 v[172:175], v1 offset:27648
    v_mfma_f32_16x16x32_bf16 v[68:71], v[180:183], a[208:211], v[68:71]
    v_exp_f32 v125, v125
    v_mfma_f32_16x16x32_bf16 v[76:79], v[180:183], a[212:215], v[76:79]
    v_add_f32 v151, v151, v125
    v_cvt_pk_bf16_f32 v122, v124, v125
    v_mfma_f32_16x16x32_bf16 v[84:87], v[180:183], a[216:219], v[84:87]
    v_exp_f32 v126, v126
    v_mfma_f32_16x16x32_bf16 v[92:95], v[180:183], a[220:223], v[92:95]
    v_add_f32 v150, v150, v126
    v_lshlrev_b32 v42, 16, v25
    v_mfma_f32_16x16x32_bf16 v[68:71], v[184:187], a[224:227], v[68:71]
    v_exp_f32 v127, v127
    v_mfma_f32_16x16x32_bf16 v[76:79], v[184:187], a[228:231], v[76:79]
    v_add_f32 v151, v151, v127
    v_cvt_pk_bf16_f32 v123, v126, v127
    v_mfma_f32_16x16x32_bf16 v[84:87], v[184:187], a[232:235], v[84:87]
    v_and_b32 v43, s62, v25
    v_lshlrev_b32 v46, 16, v29
    v_mfma_f32_16x16x32_bf16 v[92:95], v[184:187], a[236:239], v[92:95]
    v_and_b32 v47, s62, v29
    v_mul_f32 v42, s61, v42
    v_mfma_f32_16x16x32_bf16 v[68:71], v[188:191], a[240:243], v[68:71]
    v_mul_f32 v43, s61, v43
    v_mul_f32 v46, -v46, v42
    v_mfma_f32_16x16x32_bf16 v[76:79], v[188:191], a[244:247], v[76:79]
    v_mul_f32 v47, -v47, v43
    buffer_load_dwordx2 v[24:25], v8, s[28:31], s59 offen offset:1536
    v_mfma_f32_16x16x32_bf16 v[84:87], v[188:191], a[248:251], v[84:87]
    buffer_load_dwordx2 v[28:29], v8, s[32:35], s59 offen offset:1536
    s_add_u32 s59, s59, 1536
    v_mfma_f32_16x16x32_bf16 v[92:95], v[188:191], a[252:255], v[92:95]
    s_add_u32 s60, s60, 49152
    s_waitcnt vmcnt(23) lgkmcnt(0)
    v_mfma_f32_16x16x32_bf16 a[0:3], v[96:99], v[160:163], a[0:3]
    v_exp_f32 v64, v64
    v_mfma_f32_16x16x32_bf16 a[48:51], v[104:107], v[160:163], a[48:51]
    ds_read_b128 v[176:179], v1 offset:28672
    ds_read_b128 v[180:183], v1 offset:29696
    v_mfma_f32_16x16x32_bf16 a[96:99], v[112:115], v[160:163], a[96:99]
    v_exp_f32 v65, v65
    v_mfma_f32_16x16x32_bf16 a[144:147], v[120:123], v[160:163], a[144:147]
    ds_read_b128 v[184:187], v1 offset:30720
    ds_read_b128 v[188:191], v1 offset:31744
    v_mfma_f32_16x16x32_bf16 a[4:7], v[96:99], v[164:167], a[4:7]
    s_add_u32 m0, s21, 73728
    v_add_f32 v144, v144, v64
    v_mfma_f32_16x16x32_bf16 a[52:55], v[104:107], v[164:167], a[52:55]
    buffer_load_dwordx4 v1, s[8:11], s20 offen offset:0 sc1 lds
    v_add_f32 v145, v145, v65
    v_mfma_f32_16x16x32_bf16 a[100:103], v[112:115], v[164:167], a[100:103]
    v_cvt_pk_bf16_f32 v64, v64, v65
    v_cvt_f32_i32 v224, v224
    v_mfma_f32_16x16x32_bf16 a[148:151], v[120:123], v[164:167], a[148:151]
    v_exp_f32 v66, v66
    v_mfma_f32_16x16x32_bf16 a[8:11], v[96:99], v[168:171], a[8:11]
    v_add_f32 v144, v144, v66
    v_cvt_f32_i32 v225, v225
    v_mfma_f32_16x16x32_bf16 a[56:59], v[104:107], v[168:171], a[56:59]
    buffer_load_dwordx4 v1, s[8:11], s20 offen offset:1024 sc1 lds
    v_cvt_f32_i32 v226, v226
    v_mfma_f32_16x16x32_bf16 a[104:107], v[112:115], v[168:171], a[104:107]
    v_exp_f32 v67, v67
    v_mfma_f32_16x16x32_bf16 a[152:155], v[120:123], v[168:171], a[152:155]
    v_add_f32 v145, v145, v67
    v_cvt_pk_bf16_f32 v65, v66, v67
    v_mfma_f32_16x16x32_bf16 a[12:15], v[96:99], v[172:175], a[12:15]
    v_exp_f32 v68, v68
    v_mfma_f32_16x16x32_bf16 a[60:63], v[104:107], v[172:175], a[60:63]
    buffer_load_dwordx4 v1, s[8:11], s20 offen offset:2048 sc1 lds
    v_add_f32 v144, v144, v68
    v_mfma_f32_16x16x32_bf16 a[108:111], v[112:115], v[172:175], a[108:111]
    v_cvt_f32_i32 v227, v227
    v_fma_f32 v224, v224, v40, v44
    v_mfma_f32_16x16x32_bf16 a[156:159], v[120:123], v[172:175], a[156:159]
    v_fma_f32 v225, v225, v41, v45
    s_waitcnt vmcnt(26) lgkmcnt(0)
    v_mfma_f32_16x16x32_bf16 a[16:19], v[96:99], v[176:179], a[16:19]
    v_exp_f32 v69, v69
    v_mfma_f32_16x16x32_bf16 a[64:67], v[104:107], v[176:179], a[64:67]
    ds_read_b128 v[160:163], v1 offset:32768
    ds_read_b128 v[164:167], v1 offset:33792
    v_mfma_f32_16x16x32_bf16 a[112:115], v[112:115], v[176:179], a[112:115]
    buffer_load_dwordx4 v1, s[8:11], s20 offen offset:3072 sc1 lds
    v_add_f32 v145, v145, v69
    v_mfma_f32_16x16x32_bf16 a[160:163], v[120:123], v[176:179], a[160:163]
    ds_read_b128 v[168:171], v1 offset:34816
    ds_read_b128 v[172:175], v1 offset:35840
    v_mfma_f32_16x16x32_bf16 a[20:23], v[96:99], v[180:183], a[20:23]
    s_add_u32 m0, s21, 77824
    v_cvt_pk_bf16_f32 v66, v68, v69
    v_mfma_f32_16x16x32_bf16 a[68:71], v[104:107], v[180:183], a[68:71]
    buffer_load_dwordx4 v3, s[8:11], s20 offen offset:0 sc1 lds
    v_fma_f32 v226, v226, v42, v46
    v_mfma_f32_16x16x32_bf16 a[116:119], v[112:115], v[180:183], a[116:119]
    v_fma_f32 v227, v227, v43, v47
    v_cvt_pk_bf16_f32 v128, v224, v225
    v_mfma_f32_16x16x32_bf16 a[164:167], v[120:123], v[180:183], a[164:167]
    v_exp_f32 v70, v70
    v_mfma_f32_16x16x32_bf16 a[24:27], v[96:99], v[184:187], a[24:27]
    v_add_f32 v144, v144, v70
    v_cvt_pk_bf16_f32 v129, v226, v227
    v_mfma_f32_16x16x32_bf16 a[72:75], v[104:107], v[184:187], a[72:75]
    buffer_load_dwordx4 v3, s[8:11], s20 offen offset:1024 sc1 lds
    v_cvt_f32_i32 v228, v228
    v_mfma_f32_16x16x32_bf16 a[120:123], v[112:115], v[184:187], a[120:123]
    s_add_u32 s20, s20, 12288
    v_cvt_f32_i32 v229, v229
    v_mfma_f32_16x16x32_bf16 a[168:171], v[120:123], v[184:187], a[168:171]
    v_exp_f32 v71, v71
    v_mfma_f32_16x16x32_bf16 a[28:31], v[96:99], v[188:191], a[28:31]
    v_add_f32 v145, v145, v71
    v_cvt_pk_bf16_f32 v67, v70, v71
    v_mfma_f32_16x16x32_bf16 a[76:79], v[104:107], v[188:191], a[76:79]
    v_exp_f32 v72, v72
    v_mfma_f32_16x16x32_bf16 a[124:127], v[112:115], v[188:191], a[124:127]
    buffer_load_dwordx4 v[248:251], v4, s[24:27], s58 offen offset:3088 nt
    v_add_f32 v146, v146, v72
    v_mfma_f32_16x16x32_bf16 a[172:175], v[120:123], v[188:191], a[172:175]
    v_cvt_f32_i32 v230, v230
    s_waitcnt vmcnt(30) lgkmcnt(0)
    v_mfma_f32_16x16x32_bf16 a[32:35], v[96:99], v[160:163], a[32:35]
    v_cvt_f32_i32 v231, v231
    v_fma_f32 v228, v228, v40, v44
    v_mfma_f32_16x16x32_bf16 a[80:83], v[104:107], v[160:163], a[80:83]
    ds_read_b128 v[176:179], v1 offset:36864
    ds_read_b128 v[180:183], v1 offset:37888
    v_mfma_f32_16x16x32_bf16 a[128:131], v[112:115], v[160:163], a[128:131]
    buffer_load_dwordx4 v[252:255], v5, s[24:27], s58 offen offset:3088 nt
    s_add_u32 s58, s58, 98304
    v_mfma_f32_16x16x32_bf16 a[176:179], v[120:123], v[160:163], a[176:179]
    ds_read_b128 v[184:187], v1 offset:38912
    ds_read_b128 v[188:191], v1 offset:39936
    v_mfma_f32_16x16x32_bf16 a[36:39], v[96:99], v[164:167], a[36:39]
    v_exp_f32 v73, v73
    v_mfma_f32_16x16x32_bf16 a[84:87], v[104:107], v[164:167], a[84:87]
    v_add_f32 v147, v147, v73
    v_cvt_pk_bf16_f32 v72, v72, v73
    v_mfma_f32_16x16x32_bf16 a[132:135], v[112:115], v[164:167], a[132:135]
    v_exp_f32 v74, v74
    v_mfma_f32_16x16x32_bf16 a[180:183], v[120:123], v[164:167], a[180:183]
    v_exp_f32 v75, v75
    v_mfma_f32_16x16x32_bf16 a[40:43], v[96:99], v[168:171], a[40:43]
    v_add_f32 v146, v146, v74
    v_add_f32 v147, v147, v75
    v_mfma_f32_16x16x32_bf16 a[88:91], v[104:107], v[168:171], a[88:91]
    v_exp_f32 v76, v76
    v_mfma_f32_16x16x32_bf16 a[136:139], v[112:115], v[168:171], a[136:139]
    v_cvt_pk_bf16_f32 v73, v74, v75
    v_add_f32 v146, v146, v76
    v_mfma_f32_16x16x32_bf16 a[184:187], v[120:123], v[168:171], a[184:187]
    v_exp_f32 v77, v77
    v_mfma_f32_16x16x32_bf16 a[44:47], v[96:99], v[172:175], a[44:47]
    v_add_f32 v147, v147, v77
    v_cvt_pk_bf16_f32 v74, v76, v77
    v_mfma_f32_16x16x32_bf16 a[92:95], v[104:107], v[172:175], a[92:95]
    v_exp_f32 v78, v78
    v_mfma_f32_16x16x32_bf16 a[140:143], v[112:115], v[172:175], a[140:143]
    v_add_f32 v146, v146, v78
    v_fma_f32 v229, v229, v41, v45
    v_mfma_f32_16x16x32_bf16 a[188:191], v[120:123], v[172:175], a[188:191]
    v_fma_f32 v230, v230, v42, v46
    s_waitcnt vmcnt(31) lgkmcnt(0)
    v_mfma_f32_16x16x32_bf16 v[96:99], v[176:179], v[192:195], 0
    v_exp_f32 v79, v79
    v_mfma_f32_16x16x32_bf16 v[104:107], v[176:179], v[196:199], 0
    ds_read_b128 v[160:163], v1 offset:40960
    ds_read_b128 v[164:167], v1 offset:41984
    v_mfma_f32_16x16x32_bf16 v[112:115], v[176:179], v[200:203], 0
    v_add_f32 v147, v147, v79
    v_cvt_pk_bf16_f32 v75, v78, v79
    v_mfma_f32_16x16x32_bf16 v[120:123], v[176:179], v[204:207], 0
    ds_read_b128 v[168:171], v1 offset:43008
    ds_read_b128 v[172:175], v1 offset:44032
    v_mfma_f32_16x16x32_bf16 v[96:99], v[180:183], v[208:211], v[96:99]
    v_exp_f32 v80, v80
    v_mfma_f32_16x16x32_bf16 v[104:107], v[180:183], v[212:215], v[104:107]
    v_add_f32 v148, v148, v80
    v_fma_f32 v231, v231, v43, v47
    v_mfma_f32_16x16x32_bf16 v[112:115], v[180:183], v[216:219], v[112:115]
    v_exp_f32 v81, v81
    v_mfma_f32_16x16x32_bf16 v[120:123], v[180:183], v[220:223], v[120:123]
    v_add_f32 v149, v149, v81
    v_cvt_pk_bf16_f32 v80, v80, v81
    v_mfma_f32_16x16x32_bf16 v[96:99], v[184:187], a[192:195], v[96:99]
    v_exp_f32 v82, v82
    v_mfma_f32_16x16x32_bf16 v[104:107], v[184:187], a[196:199], v[104:107]
    v_add_f32 v148, v148, v82
    v_cvt_pk_bf16_f32 v132, v228, v229
    v_mfma_f32_16x16x32_bf16 v[112:115], v[184:187], a[200:203], v[112:115]
    v_exp_f32 v83, v83
    v_mfma_f32_16x16x32_bf16 v[120:123], v[184:187], a[204:207], v[120:123]
    v_add_f32 v149, v149, v83
    v_cvt_pk_bf16_f32 v81, v82, v83
    v_mfma_f32_16x16x32_bf16 v[96:99], v[188:191], a[208:211], v[96:99]
    v_exp_f32 v84, v84
    v_mfma_f32_16x16x32_bf16 v[104:107], v[188:191], a[212:215], v[104:107]
    v_add_f32 v148, v148, v84
    v_cvt_pk_bf16_f32 v133, v230, v231
    v_mfma_f32_16x16x32_bf16 v[112:115], v[188:191], a[216:219], v[112:115]
    v_exp_f32 v85, v85
    v_mfma_f32_16x16x32_bf16 v[120:123], v[188:191], a[220:223], v[120:123]
    v_add_f32 v149, v149, v85
    s_waitcnt vmcnt(31) lgkmcnt(0)
    v_mfma_f32_16x16x32_bf16 v[96:99], v[160:163], a[224:227], v[96:99]
    v_exp_f32 v86, v86
    v_mfma_f32_16x16x32_bf16 v[104:107], v[160:163], a[228:231], v[104:107]
    ds_read_b128 v[176:179], v1 offset:45056
    ds_read_b128 v[180:183], v1 offset:46080
    v_mfma_f32_16x16x32_bf16 v[112:115], v[160:163], a[232:235], v[112:115]
    v_cvt_pk_bf16_f32 v82, v84, v85
    v_add_f32 v148, v148, v86
    v_mfma_f32_16x16x32_bf16 v[120:123], v[160:163], a[236:239], v[120:123]
    ds_read_b128 v[184:187], v1 offset:47104
    ds_read_b128 v[188:191], v1 offset:48128
    v_mfma_f32_16x16x32_bf16 v[96:99], v[164:167], a[240:243], v[96:99]
    v_exp_f32 v87, v87
    v_mfma_f32_16x16x32_bf16 v[104:107], v[164:167], a[244:247], v[104:107]
    v_add_f32 v149, v149, v87
    v_cvt_pk_bf16_f32 v83, v86, v87
    v_mfma_f32_16x16x32_bf16 v[112:115], v[164:167], a[248:251], v[112:115]
    v_exp_f32 v88, v88
    v_mfma_f32_16x16x32_bf16 v[120:123], v[164:167], a[252:255], v[120:123]
    v_add_f32 v150, v150, v88
    v_lshlrev_b32 v48, 16, v26
    v_mfma_f32_16x16x32_bf16 v[100:103], v[168:171], v[192:195], 0
    v_exp_f32 v89, v89
    v_mfma_f32_16x16x32_bf16 v[108:111], v[168:171], v[196:199], 0
    v_add_f32 v151, v151, v89
    v_cvt_pk_bf16_f32 v88, v88, v89
    v_mfma_f32_16x16x32_bf16 v[116:119], v[168:171], v[200:203], 0
    v_exp_f32 v90, v90
    v_mfma_f32_16x16x32_bf16 v[124:127], v[168:171], v[204:207], 0
    v_add_f32 v150, v150, v90
    v_and_b32 v49, s62, v26
    v_mfma_f32_16x16x32_bf16 v[100:103], v[172:175], v[208:211], v[100:103]
    v_exp_f32 v91, v91
    v_mfma_f32_16x16x32_bf16 v[108:111], v[172:175], v[212:215], v[108:111]
    v_add_f32 v151, v151, v91
    v_cvt_pk_bf16_f32 v89, v90, v91
    v_mfma_f32_16x16x32_bf16 v[116:119], v[172:175], v[216:219], v[116:119]
    v_exp_f32 v92, v92
    v_mfma_f32_16x16x32_bf16 v[124:127], v[172:175], v[220:223], v[124:127]
    s_waitcnt vmcnt(10) lgkmcnt(0)
    s_barrier
    v_mfma_f32_16x16x32_bf16 v[100:103], v[176:179], a[192:195], v[100:103]
    buffer_store_dword v10, v9, s[40:43], 0 offen
    v_add_u32 v10, 1, v10
    v_mfma_f32_16x16x32_bf16 v[108:111], v[176:179], a[196:199], v[108:111]
    ds_read_b128 v[160:163], v2 offset:0
    ds_read_b128 v[164:167], v2 offset:1024
    v_mfma_f32_16x16x32_bf16 v[116:119], v[176:179], a[200:203], v[116:119]
    v_add_f32 v150, v150, v92
    v_lshlrev_b32 v52, 16, v30
    v_mfma_f32_16x16x32_bf16 v[124:127], v[176:179], a[204:207], v[124:127]
    ds_read_b128 v[168:171], v2 offset:2048
    ds_read_b128 v[172:175], v2 offset:3072
    v_mfma_f32_16x16x32_bf16 v[100:103], v[180:183], a[208:211], v[100:103]
    v_exp_f32 v93, v93
    v_mfma_f32_16x16x32_bf16 v[108:111], v[180:183], a[212:215], v[108:111]
    v_add_f32 v151, v151, v93
    v_cvt_pk_bf16_f32 v90, v92, v93
    v_mfma_f32_16x16x32_bf16 v[116:119], v[180:183], a[216:219], v[116:119]
    v_exp_f32 v94, v94
    v_mfma_f32_16x16x32_bf16 v[124:127], v[180:183], a[220:223], v[124:127]
    v_add_f32 v150, v150, v94
    v_and_b32 v53, s62, v30
    v_mfma_f32_16x16x32_bf16 v[100:103], v[184:187], a[224:227], v[100:103]
    v_exp_f32 v95, v95
    v_mfma_f32_16x16x32_bf16 v[108:111], v[184:187], a[228:231], v[108:111]
    v_add_f32 v151, v151, v95
    v_cvt_pk_bf16_f32 v91, v94, v95
    v_mfma_f32_16x16x32_bf16 v[116:119], v[184:187], a[232:235], v[116:119]
    v_mul_f32 v48, s61, v48
    v_mul_f32 v49, s61, v49
    v_mfma_f32_16x16x32_bf16 v[124:127], v[184:187], a[236:239], v[124:127]
    v_mul_f32 v52, -v52, v48
    v_mul_f32 v53, -v53, v49
    v_mfma_f32_16x16x32_bf16 v[100:103], v[188:191], a[240:243], v[100:103]
    v_mfma_f32_16x16x32_bf16 v[108:111], v[188:191], a[244:247], v[108:111]
    v_mfma_f32_16x16x32_bf16 v[116:119], v[188:191], a[248:251], v[116:119]
    v_mfma_f32_16x16x32_bf16 v[124:127], v[188:191], a[252:255], v[124:127]
    s_waitcnt vmcnt(23) lgkmcnt(0)
    v_mfma_f32_16x16x32_bf16 a[0:3], v[64:67], v[160:163], a[0:3]
    v_exp_f32 v96, v96
    v_mfma_f32_16x16x32_bf16 a[48:51], v[72:75], v[160:163], a[48:51]
    ds_read_b128 v[176:179], v2 offset:4096
    ds_read_b128 v[180:183], v2 offset:5120
    v_mfma_f32_16x16x32_bf16 a[96:99], v[80:83], v[160:163], a[96:99]
    v_exp_f32 v97, v97
    v_mfma_f32_16x16x32_bf16 a[144:147], v[88:91], v[160:163], a[144:147]
    ds_read_b128 v[184:187], v2 offset:6144
    ds_read_b128 v[188:191], v2 offset:7168
    v_mfma_f32_16x16x32_bf16 a[4:7], v[64:67], v[164:167], a[4:7]
    s_add_u32 m0, s21, 0
    v_add_f32 v144, v144, v96
    v_mfma_f32_16x16x32_bf16 a[52:55], v[72:75], v[164:167], a[52:55]
    buffer_load_dwordx4 v1, s[8:11], s20 offen offset:0 sc1 lds
    v_add_f32 v145, v145, v97
    v_mfma_f32_16x16x32_bf16 a[100:103], v[80:83], v[164:167], a[100:103]
    v_cvt_pk_bf16_f32 v96, v96, v97
    v_cvt_f32_i32 v232, v232
    v_mfma_f32_16x16x32_bf16 a[148:151], v[88:91], v[164:167], a[148:151]
    v_exp_f32 v98, v98
    v_mfma_f32_16x16x32_bf16 a[8:11], v[64:67], v[168:171], a[8:11]
    v_add_f32 v144, v144, v98
    v_cvt_f32_i32 v233, v233
    v_mfma_f32_16x16x32_bf16 a[56:59], v[72:75], v[168:171], a[56:59]
    buffer_load_dwordx4 v1, s[8:11], s20 offen offset:1024 sc1 lds
    v_cvt_f32_i32 v234, v234
    v_mfma_f32_16x16x32_bf16 a[104:107], v[80:83], v[168:171], a[104:107]
    v_exp_f32 v99, v99
    v_mfma_f32_16x16x32_bf16 a[152:155], v[88:91], v[168:171], a[152:155]
    v_add_f32 v145, v145, v99
    v_cvt_pk_bf16_f32 v97, v98, v99
    v_mfma_f32_16x16x32_bf16 a[12:15], v[64:67], v[172:175], a[12:15]
    v_exp_f32 v100, v100
    v_mfma_f32_16x16x32_bf16 a[60:63], v[72:75], v[172:175], a[60:63]
    buffer_load_dwordx4 v1, s[8:11], s20 offen offset:2048 sc1 lds
    v_add_f32 v144, v144, v100
    v_mfma_f32_16x16x32_bf16 a[108:111], v[80:83], v[172:175], a[108:111]
    v_cvt_f32_i32 v235, v235
    v_fma_f32 v232, v232, v40, v44
    v_mfma_f32_16x16x32_bf16 a[156:159], v[88:91], v[172:175], a[156:159]
    v_fma_f32 v233, v233, v41, v45
    s_waitcnt vmcnt(26) lgkmcnt(0)
    v_mfma_f32_16x16x32_bf16 a[16:19], v[64:67], v[176:179], a[16:19]
    v_exp_f32 v101, v101
    v_mfma_f32_16x16x32_bf16 a[64:67], v[72:75], v[176:179], a[64:67]
    ds_read_b128 v[160:163], v2 offset:8192
    ds_read_b128 v[164:167], v2 offset:9216
    v_mfma_f32_16x16x32_bf16 a[112:115], v[80:83], v[176:179], a[112:115]
    buffer_load_dwordx4 v1, s[8:11], s20 offen offset:3072 sc1 lds
    v_add_f32 v145, v145, v101
    v_mfma_f32_16x16x32_bf16 a[160:163], v[88:91], v[176:179], a[160:163]
    ds_read_b128 v[168:171], v2 offset:10240
    ds_read_b128 v[172:175], v2 offset:11264
    v_mfma_f32_16x16x32_bf16 a[20:23], v[64:67], v[180:183], a[20:23]
    s_add_u32 m0, s21, 4096
    v_cvt_pk_bf16_f32 v98, v100, v101
    v_mfma_f32_16x16x32_bf16 a[68:71], v[72:75], v[180:183], a[68:71]
    buffer_load_dwordx4 v3, s[8:11], s20 offen offset:0 sc1 lds
    v_fma_f32 v234, v234, v42, v46
    v_mfma_f32_16x16x32_bf16 a[116:119], v[80:83], v[180:183], a[116:119]
    v_fma_f32 v235, v235, v43, v47
    v_cvt_pk_bf16_f32 v136, v232, v233
    v_mfma_f32_16x16x32_bf16 a[164:167], v[88:91], v[180:183], a[164:167]
    v_exp_f32 v102, v102
    v_mfma_f32_16x16x32_bf16 a[24:27], v[64:67], v[184:187], a[24:27]
    v_add_f32 v144, v144, v102
    v_cvt_pk_bf16_f32 v137, v234, v235
    v_mfma_f32_16x16x32_bf16 a[72:75], v[72:75], v[184:187], a[72:75]
    buffer_load_dwordx4 v3, s[8:11], s20 offen offset:1024 sc1 lds
    v_cvt_f32_i32 v236, v236
    v_mfma_f32_16x16x32_bf16 a[120:123], v[80:83], v[184:187], a[120:123]
    s_add_u32 s20, s20, 12288
    v_cvt_f32_i32 v237, v237
    v_mfma_f32_16x16x32_bf16 a[168:171], v[88:91], v[184:187], a[168:171]
    v_exp_f32 v103, v103
    v_mfma_f32_16x16x32_bf16 a[28:31], v[64:67], v[188:191], a[28:31]
    v_add_f32 v145, v145, v103
    v_cvt_pk_bf16_f32 v99, v102, v103
    v_mfma_f32_16x16x32_bf16 a[76:79], v[72:75], v[188:191], a[76:79]
    v_exp_f32 v104, v104
    v_mfma_f32_16x16x32_bf16 a[124:127], v[80:83], v[188:191], a[124:127]
    buffer_load_dwordx4 v[224:227], v4, s[24:27], s58 offen offset:0 nt
    v_add_f32 v146, v146, v104
    v_mfma_f32_16x16x32_bf16 a[172:175], v[88:91], v[188:191], a[172:175]
    v_cvt_f32_i32 v238, v238
    s_waitcnt vmcnt(30) lgkmcnt(0)
    v_mfma_f32_16x16x32_bf16 a[32:35], v[64:67], v[160:163], a[32:35]
    v_cvt_f32_i32 v239, v239
    v_fma_f32 v236, v236, v40, v44
    v_mfma_f32_16x16x32_bf16 a[80:83], v[72:75], v[160:163], a[80:83]
    ds_read_b128 v[176:179], v2 offset:12288
    ds_read_b128 v[180:183], v2 offset:13312
    v_mfma_f32_16x16x32_bf16 a[128:131], v[80:83], v[160:163], a[128:131]
    buffer_load_dwordx4 v[228:231], v5, s[24:27], s58 offen offset:0 nt
    v_fma_f32 v237, v237, v41, v45
    v_mfma_f32_16x16x32_bf16 a[176:179], v[88:91], v[160:163], a[176:179]
    ds_read_b128 v[184:187], v2 offset:14336
    ds_read_b128 v[188:191], v2 offset:15360
    v_mfma_f32_16x16x32_bf16 a[36:39], v[64:67], v[164:167], a[36:39]
    v_exp_f32 v105, v105
    v_mfma_f32_16x16x32_bf16 a[84:87], v[72:75], v[164:167], a[84:87]
    v_add_f32 v147, v147, v105
    v_cvt_pk_bf16_f32 v104, v104, v105
    v_mfma_f32_16x16x32_bf16 a[132:135], v[80:83], v[164:167], a[132:135]
    v_exp_f32 v106, v106
    v_mfma_f32_16x16x32_bf16 a[180:183], v[88:91], v[164:167], a[180:183]
    v_add_f32 v146, v146, v106
    v_fma_f32 v238, v238, v42, v46
    v_mfma_f32_16x16x32_bf16 a[40:43], v[64:67], v[168:171], a[40:43]
    v_exp_f32 v107, v107
    v_mfma_f32_16x16x32_bf16 a[88:91], v[72:75], v[168:171], a[88:91]
    v_add_f32 v147, v147, v107
    v_cvt_pk_bf16_f32 v105, v106, v107
    v_mfma_f32_16x16x32_bf16 a[136:139], v[80:83], v[168:171], a[136:139]
    v_exp_f32 v108, v108
    v_mfma_f32_16x16x32_bf16 a[184:187], v[88:91], v[168:171], a[184:187]
    v_add_f32 v146, v146, v108
    v_fma_f32 v239, v239, v43, v47
    v_mfma_f32_16x16x32_bf16 a[44:47], v[64:67], v[172:175], a[44:47]
    v_exp_f32 v109, v109
    v_mfma_f32_16x16x32_bf16 a[92:95], v[72:75], v[172:175], a[92:95]
    v_add_f32 v147, v147, v109
    v_cvt_pk_bf16_f32 v106, v108, v109
    v_mfma_f32_16x16x32_bf16 a[140:143], v[80:83], v[172:175], a[140:143]
    v_exp_f32 v110, v110
    v_mfma_f32_16x16x32_bf16 a[188:191], v[88:91], v[172:175], a[188:191]
    v_add_f32 v146, v146, v110
    s_waitcnt vmcnt(31) lgkmcnt(0)
    v_mfma_f32_16x16x32_bf16 v[64:67], v[176:179], v[192:195], 0
    v_cvt_pk_bf16_f32 v140, v236, v237
    v_cvt_pk_bf16_f32 v141, v238, v239
    v_mfma_f32_16x16x32_bf16 v[72:75], v[176:179], v[196:199], 0
    ds_read_b128 v[160:163], v2 offset:16384
    ds_read_b128 v[164:167], v2 offset:17408
    v_mfma_f32_16x16x32_bf16 v[80:83], v[176:179], v[200:203], 0
    v_exp_f32 v111, v111
    v_mfma_f32_16x16x32_bf16 v[88:91], v[176:179], v[204:207], 0
    ds_read_b128 v[168:171], v2 offset:18432
    ds_read_b128 v[172:175], v2 offset:19456
    v_mfma_f32_16x16x32_bf16 v[64:67], v[180:183], v[208:211], v[64:67]
    v_add_f32 v147, v147, v111
    v_cvt_pk_bf16_f32 v107, v110, v111
    v_mfma_f32_16x16x32_bf16 v[72:75], v[180:183], v[212:215], v[72:75]
    v_exp_f32 v112, v112
    v_mfma_f32_16x16x32_bf16 v[80:83], v[180:183], v[216:219], v[80:83]
    v_exp_f32 v113, v113
    v_mfma_f32_16x16x32_bf16 v[88:91], v[180:183], v[220:223], v[88:91]
    v_add_f32 v148, v148, v112
    v_add_f32 v149, v149, v113
    v_mfma_f32_16x16x32_bf16 v[64:67], v[184:187], a[192:195], v[64:67]
    v_exp_f32 v114, v114
    v_mfma_f32_16x16x32_bf16 v[72:75], v[184:187], a[196:199], v[72:75]
    v_cvt_pk_bf16_f32 v112, v112, v113
    v_add_f32 v148, v148, v114
    v_mfma_f32_16x16x32_bf16 v[80:83], v[184:187], a[200:203], v[80:83]
    v_exp_f32 v115, v115
    v_mfma_f32_16x16x32_bf16 v[88:91], v[184:187], a[204:207], v[88:91]
    v_add_f32 v149, v149, v115
    v_cvt_pk_bf16_f32 v113, v114, v115
    v_mfma_f32_16x16x32_bf16 v[64:67], v[188:191], a[208:211], v[64:67]
    v_exp_f32 v116, v116
    v_mfma_f32_16x16x32_bf16 v[72:75], v[188:191], a[212:215], v[72:75]
    v_add_f32 v148, v148, v116
    v_lshlrev_b32 v50, 16, v27
    v_mfma_f32_16x16x32_bf16 v[80:83], v[188:191], a[216:219], v[80:83]
    v_exp_f32 v117, v117
    v_mfma_f32_16x16x32_bf16 v[88:91], v[188:191], a[220:223], v[88:91]
    v_add_f32 v149, v149, v117
    s_waitcnt vmcnt(40) lgkmcnt(0)
    v_mfma_f32_16x16x32_bf16 v[64:67], v[160:163], a[224:227], v[64:67]
    v_cvt_pk_bf16_f32 v114, v116, v117
    v_and_b32 v51, s62, v27
    v_mfma_f32_16x16x32_bf16 v[72:75], v[160:163], a[228:231], v[72:75]
    ds_read_b128 v[176:179], v2 offset:20480
    ds_read_b128 v[180:183], v2 offset:21504
    v_mfma_f32_16x16x32_bf16 v[80:83], v[160:163], a[232:235], v[80:83]
    v_exp_f32 v118, v118
    v_mfma_f32_16x16x32_bf16 v[88:91], v[160:163], a[236:239], v[88:91]
    ds_read_b128 v[184:187], v2 offset:22528
    ds_read_b128 v[188:191], v2 offset:23552
    v_mfma_f32_16x16x32_bf16 v[64:67], v[164:167], a[240:243], v[64:67]
    v_add_f32 v148, v148, v118
    v_lshlrev_b32 v54, 16, v31
    v_mfma_f32_16x16x32_bf16 v[72:75], v[164:167], a[244:247], v[72:75]
    v_exp_f32 v119, v119
    v_mfma_f32_16x16x32_bf16 v[80:83], v[164:167], a[248:251], v[80:83]
    v_add_f32 v149, v149, v119
    v_cvt_pk_bf16_f32 v115, v118, v119
    v_mfma_f32_16x16x32_bf16 v[88:91], v[164:167], a[252:255], v[88:91]
    v_exp_f32 v120, v120
    v_mfma_f32_16x16x32_bf16 v[68:71], v[168:171], v[192:195], 0
    v_add_f32 v150, v150, v120
    v_and_b32 v55, s62, v31
    v_mfma_f32_16x16x32_bf16 v[76:79], v[168:171], v[196:199], 0
    v_exp_f32 v121, v121
    v_mfma_f32_16x16x32_bf16 v[84:87], v[168:171], v[200:203], 0
    v_add_f32 v151, v151, v121
    v_cvt_pk_bf16_f32 v120, v120, v121
    v_mfma_f32_16x16x32_bf16 v[92:95], v[168:171], v[204:207], 0
    v_exp_f32 v122, v122
    v_mfma_f32_16x16x32_bf16 v[68:71], v[172:175], v[208:211], v[68:71]
    v_add_f32 v150, v150, v122
    v_mul_f32 v50, s61, v50
    v_mfma_f32_16x16x32_bf16 v[76:79], v[172:175], v[212:215], v[76:79]
    v_exp_f32 v123, v123
    v_mfma_f32_16x16x32_bf16 v[84:87], v[172:175], v[216:219], v[84:87]
    v_add_f32 v151, v151, v123
    v_cvt_pk_bf16_f32 v121, v122, v123
    v_mfma_f32_16x16x32_bf16 v[92:95], v[172:175], v[220:223], v[92:95]
    s_waitcnt vmcnt(11) lgkmcnt(0)
    s_barrier
    v_mfma_f32_16x16x32_bf16 v[68:71], v[176:179], a[192:195], v[68:71]
    v_exp_f32 v124, v124
    v_mfma_f32_16x16x32_bf16 v[76:79], v[176:179], a[196:199], v[76:79]
    ds_read_b128 v[160:163], v2 offset:24576
    ds_read_b128 v[164:167], v2 offset:25600
    v_mfma_f32_16x16x32_bf16 v[84:87], v[176:179], a[200:203], v[84:87]
    v_add_f32 v150, v150, v124
    v_mul_f32 v51, s61, v51
    v_mfma_f32_16x16x32_bf16 v[92:95], v[176:179], a[204:207], v[92:95]
    ds_read_b128 v[168:171], v2 offset:26624
    ds_read_b128 v[172:175], v2 offset:27648
    v_mfma_f32_16x16x32_bf16 v[68:71], v[180:183], a[208:211], v[68:71]
    v_exp_f32 v125, v125
    v_mfma_f32_16x16x32_bf16 v[76:79], v[180:183], a[212:215], v[76:79]
    v_add_f32 v151, v151, v125
    v_cvt_pk_bf16_f32 v122, v124, v125
    v_mfma_f32_16x16x32_bf16 v[84:87], v[180:183], a[216:219], v[84:87]
    v_exp_f32 v126, v126
    v_mfma_f32_16x16x32_bf16 v[92:95], v[180:183], a[220:223], v[92:95]
    v_add_f32 v150, v150, v126
    v_mul_f32 v54, -v54, v50
    v_mfma_f32_16x16x32_bf16 v[68:71], v[184:187], a[224:227], v[68:71]
    v_exp_f32 v127, v127
    v_mfma_f32_16x16x32_bf16 v[76:79], v[184:187], a[228:231], v[76:79]
    v_add_f32 v151, v151, v127
    v_cvt_pk_bf16_f32 v123, v126, v127
    v_mfma_f32_16x16x32_bf16 v[84:87], v[184:187], a[232:235], v[84:87]
    v_mul_f32 v55, -v55, v51
    buffer_load_dwordx2 v[26:27], v8, s[28:31], s59 offen offset:8
    v_mfma_f32_16x16x32_bf16 v[92:95], v[184:187], a[236:239], v[92:95]
    buffer_load_dwordx2 v[30:31], v8, s[32:35], s59 offen offset:8
    v_mfma_f32_16x16x32_bf16 v[68:71], v[188:191], a[240:243], v[68:71]
    v_mfma_f32_16x16x32_bf16 v[76:79], v[188:191], a[244:247], v[76:79]
    v_mfma_f32_16x16x32_bf16 v[84:87], v[188:191], a[248:251], v[84:87]
    v_mfma_f32_16x16x32_bf16 v[92:95], v[188:191], a[252:255], v[92:95]
    s_waitcnt vmcnt(23) lgkmcnt(0)
    v_mfma_f32_16x16x32_bf16 a[0:3], v[96:99], v[160:163], a[0:3]
    v_exp_f32 v64, v64
    v_mfma_f32_16x16x32_bf16 a[48:51], v[104:107], v[160:163], a[48:51]
    ds_read_b128 v[176:179], v2 offset:28672
    ds_read_b128 v[180:183], v2 offset:29696
    v_mfma_f32_16x16x32_bf16 a[96:99], v[112:115], v[160:163], a[96:99]
    buffer_load_dword v12, v13, s[40:43], 0 offen sc1
    v_add_f32 v144, v144, v64
    v_mfma_f32_16x16x32_bf16 a[144:147], v[120:123], v[160:163], a[144:147]
    ds_read_b128 v[184:187], v2 offset:30720
    ds_read_b128 v[188:191], v2 offset:31744
    v_mfma_f32_16x16x32_bf16 a[4:7], v[96:99], v[164:167], a[4:7]
    s_add_u32 m0, s21, 24576
    v_cvt_f32_i32 v240, v240
    v_mfma_f32_16x16x32_bf16 a[52:55], v[104:107], v[164:167], a[52:55]
    buffer_load_dwordx4 v1, s[8:11], s20 offen offset:0 sc1 lds
    v_cvt_f32_i32 v241, v241
    v_mfma_f32_16x16x32_bf16 a[100:103], v[112:115], v[164:167], a[100:103]
    v_exp_f32 v65, v65
    v_mfma_f32_16x16x32_bf16 a[148:151], v[120:123], v[164:167], a[148:151]
    v_add_f32 v145, v145, v65
    v_cvt_pk_bf16_f32 v64, v64, v65
    v_mfma_f32_16x16x32_bf16 a[8:11], v[96:99], v[168:171], a[8:11]
    v_exp_f32 v66, v66
    v_mfma_f32_16x16x32_bf16 a[56:59], v[104:107], v[168:171], a[56:59]
    buffer_load_dwordx4 v1, s[8:11], s20 offen offset:1024 sc1 lds
    v_add_f32 v144, v144, v66
    v_mfma_f32_16x16x32_bf16 a[104:107], v[112:115], v[168:171], a[104:107]
    v_cvt_f32_i32 v242, v242
    v_cvt_f32_i32 v243, v243
    v_mfma_f32_16x16x32_bf16 a[152:155], v[120:123], v[168:171], a[152:155]
    v_exp_f32 v67, v67
    v_mfma_f32_16x16x32_bf16 a[12:15], v[96:99], v[172:175], a[12:15]
    v_add_f32 v145, v145, v67
    v_cvt_pk_bf16_f32 v65, v66, v67
    v_mfma_f32_16x16x32_bf16 a[60:63], v[104:107], v[172:175], a[60:63]
    buffer_load_dwordx4 v1, s[8:11], s20 offen offset:2048 sc1 lds
    v_fma_f32 v240, v240, v48, v52
    v_mfma_f32_16x16x32_bf16 a[108:111], v[112:115], v[172:175], a[108:111]
    v_exp_f32 v68, v68
    v_mfma_f32_16x16x32_bf16 a[156:159], v[120:123], v[172:175], a[156:159]
    v_add_f32 v144, v144, v68
    s_waitcnt vmcnt(27) lgkmcnt(0)
    v_mfma_f32_16x16x32_bf16 a[16:19], v[96:99], v[176:179], a[16:19]
    v_fma_f32 v241, v241, v49, v53
    v_fma_f32 v242, v242, v50, v54
    v_mfma_f32_16x16x32_bf16 a[64:67], v[104:107], v[176:179], a[64:67]
    ds_read_b128 v[160:163], v2 offset:32768
    ds_read_b128 v[164:167], v2 offset:33792
    v_mfma_f32_16x16x32_bf16 a[112:115], v[112:115], v[176:179], a[112:115]
    buffer_load_dwordx4 v1, s[8:11], s20 offen offset:3072 sc1 lds
    v_fma_f32 v243, v243, v51, v55
    v_mfma_f32_16x16x32_bf16 a[160:163], v[120:123], v[176:179], a[160:163]
    ds_read_b128 v[168:171], v2 offset:34816
    ds_read_b128 v[172:175], v2 offset:35840
    v_mfma_f32_16x16x32_bf16 a[20:23], v[96:99], v[180:183], a[20:23]
    s_add_u32 m0, s21, 28672
    v_cvt_pk_bf16_f32 v130, v240, v241
    v_mfma_f32_16x16x32_bf16 a[68:71], v[104:107], v[180:183], a[68:71]
    buffer_load_dwordx4 v3, s[8:11], s20 offen offset:0 sc1 lds
    v_cvt_pk_bf16_f32 v131, v242, v243
    v_mfma_f32_16x16x32_bf16 a[116:119], v[112:115], v[180:183], a[116:119]
    v_exp_f32 v69, v69
    v_mfma_f32_16x16x32_bf16 a[164:167], v[120:123], v[180:183], a[164:167]
    v_add_f32 v145, v145, v69
    v_cvt_pk_bf16_f32 v66, v68, v69
    v_mfma_f32_16x16x32_bf16 a[24:27], v[96:99], v[184:187], a[24:27]
    v_exp_f32 v70, v70
    v_mfma_f32_16x16x32_bf16 a[72:75], v[104:107], v[184:187], a[72:75]
    buffer_load_dwordx4 v3, s[8:11], s20 offen offset:1024 sc1 lds
    v_add_f32 v144, v144, v70
    v_mfma_f32_16x16x32_bf16 a[120:123], v[112:115], v[184:187], a[120:123]
    s_add_u32 s20, s20, 12288
    v_cvt_f32_i32 v244, v244
    v_mfma_f32_16x16x32_bf16 a[168:171], v[120:123], v[184:187], a[168:171]
    v_cvt_f32_i32 v245, v245
    v_cvt_f32_i32 v246, v246
    v_mfma_f32_16x16x32_bf16 a[28:31], v[96:99], v[188:191], a[28:31]
    v_exp_f32 v71, v71
    v_mfma_f32_16x16x32_bf16 a[76:79], v[104:107], v[188:191], a[76:79]
    v_add_f32 v145, v145, v71
    v_cvt_pk_bf16_f32 v67, v70, v71
    v_mfma_f32_16x16x32_bf16 a[124:127], v[112:115], v[188:191], a[124:127]
    buffer_load_dwordx4 v[232:235], v4, s[24:27], s58 offen offset:3072 nt
    v_cvt_f32_i32 v247, v247
    v_mfma_f32_16x16x32_bf16 a[172:175], v[120:123], v[188:191], a[172:175]
    v_fma_f32 v244, v244, v48, v52
    s_waitcnt vmcnt(31) lgkmcnt(0)
    v_mfma_f32_16x16x32_bf16 a[32:35], v[96:99], v[160:163], a[32:35]
    v_exp_f32 v72, v72
    v_mfma_f32_16x16x32_bf16 a[80:83], v[104:107], v[160:163], a[80:83]
    ds_read_b128 v[176:179], v2 offset:36864
    ds_read_b128 v[180:183], v2 offset:37888
    v_mfma_f32_16x16x32_bf16 a[128:131], v[112:115], v[160:163], a[128:131]
    buffer_load_dwordx4 v[236:239], v5, s[24:27], s58 offen offset:3072 nt
    v_add_f32 v146, v146, v72
    v_mfma_f32_16x16x32_bf16 a[176:179], v[120:123], v[160:163], a[176:179]
    ds_read_b128 v[184:187], v2 offset:38912
    ds_read_b128 v[188:191], v2 offset:39936
    v_mfma_f32_16x16x32_bf16 a[36:39], v[96:99], v[164:167], a[36:39]
    v_fma_f32 v245, v245, v49, v53
    v_fma_f32 v246, v246, v50, v54
    v_mfma_f32_16x16x32_bf16 a[84:87], v[104:107], v[164:167], a[84:87]
    v_exp_f32 v73, v73
    v_mfma_f32_16x16x32_bf16 a[132:135], v[112:115], v[164:167], a[132:135]
    v_add_f32 v147, v147, v73
    v_cvt_pk_bf16_f32 v72, v72, v73
    v_mfma_f32_16x16x32_bf16 a[180:183], v[120:123], v[164:167], a[180:183]
    v_exp_f32 v74, v74
    v_mfma_f32_16x16x32_bf16 a[40:43], v[96:99], v[168:171], a[40:43]
    v_exp_f32 v75, v75
    v_mfma_f32_16x16x32_bf16 a[88:91], v[104:107], v[168:171], a[88:91]
    v_add_f32 v146, v146, v74
    v_add_f32 v147, v147, v75
    v_mfma_f32_16x16x32_bf16 a[136:139], v[112:115], v[168:171], a[136:139]
    v_exp_f32 v76, v76
    v_mfma_f32_16x16x32_bf16 a[184:187], v[120:123], v[168:171], a[184:187]
    v_cvt_pk_bf16_f32 v73, v74, v75
    v_add_f32 v146, v146, v76
    v_mfma_f32_16x16x32_bf16 a[44:47], v[96:99], v[172:175], a[44:47]
    v_exp_f32 v77, v77
    v_mfma_f32_16x16x32_bf16 a[92:95], v[104:107], v[172:175], a[92:95]
    v_add_f32 v147, v147, v77
    v_cvt_pk_bf16_f32 v74, v76, v77
    v_mfma_f32_16x16x32_bf16 a[140:143], v[112:115], v[172:175], a[140:143]
    v_exp_f32 v78, v78
    v_mfma_f32_16x16x32_bf16 a[188:191], v[120:123], v[172:175], a[188:191]
    v_add_f32 v146, v146, v78
    s_waitcnt vmcnt(28) lgkmcnt(0)
    v_mfma_f32_16x16x32_bf16 v[96:99], v[176:179], v[192:195], 0
    v_fma_f32 v247, v247, v51, v55
    v_cvt_pk_bf16_f32 v134, v244, v245
    v_mfma_f32_16x16x32_bf16 v[104:107], v[176:179], v[196:199], 0
    ds_read_b128 v[160:163], v2 offset:40960
    ds_read_b128 v[164:167], v2 offset:41984
    v_mfma_f32_16x16x32_bf16 v[112:115], v[176:179], v[200:203], 0
    v_exp_f32 v79, v79
    v_mfma_f32_16x16x32_bf16 v[120:123], v[176:179], v[204:207], 0
    ds_read_b128 v[168:171], v2 offset:43008
    ds_read_b128 v[172:175], v2 offset:44032
    v_mfma_f32_16x16x32_bf16 v[96:99], v[180:183], v[208:211], v[96:99]
    v_add_f32 v147, v147, v79
    v_cvt_pk_bf16_f32 v75, v78, v79
    v_mfma_f32_16x16x32_bf16 v[104:107], v[180:183], v[212:215], v[104:107]
    v_exp_f32 v80, v80
    v_mfma_f32_16x16x32_bf16 v[112:115], v[180:183], v[216:219], v[112:115]
    v_add_f32 v148, v148, v80
    v_cvt_pk_bf16_f32 v135, v246, v247
    v_mfma_f32_16x16x32_bf16 v[120:123], v[180:183], v[220:223], v[120:123]
    v_exp_f32 v81, v81
    v_mfma_f32_16x16x32_bf16 v[96:99], v[184:187], a[192:195], v[96:99]
    v_add_f32 v149, v149, v81
    v_cvt_pk_bf16_f32 v80, v80, v81
    v_mfma_f32_16x16x32_bf16 v[104:107], v[184:187], a[196:199], v[104:107]
    v_exp_f32 v82, v82
    v_mfma_f32_16x16x32_bf16 v[112:115], v[184:187], a[200:203], v[112:115]
    v_add_f32 v148, v148, v82
    buffer_store_dwordx4 v[128:131], v6, s[36:39], s60 offen offset:0 sc1
    v_mfma_f32_16x16x32_bf16 v[120:123], v[184:187], a[204:207], v[120:123]
    v_exp_f32 v83, v83
    v_mfma_f32_16x16x32_bf16 v[96:99], v[188:191], a[208:211], v[96:99]
    v_add_f32 v149, v149, v83
    v_cvt_pk_bf16_f32 v81, v82, v83
    v_mfma_f32_16x16x32_bf16 v[104:107], v[188:191], a[212:215], v[104:107]
    v_exp_f32 v84, v84
    v_mfma_f32_16x16x32_bf16 v[112:115], v[188:191], a[216:219], v[112:115]
    v_add_f32 v148, v148, v84
    buffer_store_dwordx4 v[132:135], v6, s[36:39], s60 offen offset:128 sc1
    v_mfma_f32_16x16x32_bf16 v[120:123], v[188:191], a[220:223], v[120:123]
    v_lshlrev_b32 v40, 16, v24
    s_waitcnt vmcnt(30) lgkmcnt(0)
    v_mfma_f32_16x16x32_bf16 v[96:99], v[160:163], a[224:227], v[96:99]
    v_exp_f32 v85, v85
    v_mfma_f32_16x16x32_bf16 v[104:107], v[160:163], a[228:231], v[104:107]
    ds_read_b128 v[176:179], v2 offset:45056
    ds_read_b128 v[180:183], v2 offset:46080
    v_mfma_f32_16x16x32_bf16 v[112:115], v[160:163], a[232:235], v[112:115]
    v_exp_f32 v86, v86
    v_mfma_f32_16x16x32_bf16 v[120:123], v[160:163], a[236:239], v[120:123]
    ds_read_b128 v[184:187], v2 offset:47104
    ds_read_b128 v[188:191], v2 offset:48128
    v_mfma_f32_16x16x32_bf16 v[96:99], v[164:167], a[240:243], v[96:99]
    v_add_f32 v149, v149, v85
    v_cvt_pk_bf16_f32 v82, v84, v85
    v_mfma_f32_16x16x32_bf16 v[104:107], v[164:167], a[244:247], v[104:107]
    v_exp_f32 v87, v87
    v_mfma_f32_16x16x32_bf16 v[112:115], v[164:167], a[248:251], v[112:115]
    v_add_f32 v148, v148, v86
    v_add_f32 v149, v149, v87
    v_mfma_f32_16x16x32_bf16 v[120:123], v[164:167], a[252:255], v[120:123]
    v_exp_f32 v88, v88
    v_mfma_f32_16x16x32_bf16 v[100:103], v[168:171], v[192:195], 0
    v_cvt_pk_bf16_f32 v83, v86, v87
    v_add_f32 v150, v150, v88
    v_mfma_f32_16x16x32_bf16 v[108:111], v[168:171], v[196:199], 0
    v_exp_f32 v89, v89
    v_mfma_f32_16x16x32_bf16 v[116:119], v[168:171], v[200:203], 0
    v_add_f32 v151, v151, v89
    v_cvt_pk_bf16_f32 v88, v88, v89
    v_mfma_f32_16x16x32_bf16 v[124:127], v[168:171], v[204:207], 0
    v_exp_f32 v90, v90
    v_mfma_f32_16x16x32_bf16 v[100:103], v[172:175], v[208:211], v[100:103]
    v_add_f32 v150, v150, v90
    v_and_b32 v41, s62, v24
    v_mfma_f32_16x16x32_bf16 v[108:111], v[172:175], v[212:215], v[108:111]
    v_exp_f32 v91, v91
    v_mfma_f32_16x16x32_bf16 v[116:119], v[172:175], v[216:219], v[116:119]
    v_add_f32 v151, v151, v91
    v_cvt_pk_bf16_f32 v89, v90, v91
    v_mfma_f32_16x16x32_bf16 v[124:127], v[172:175], v[220:223], v[124:127]
    s_waitcnt vmcnt(15) lgkmcnt(0)
    s_barrier
    v_mfma_f32_16x16x32_bf16 v[100:103], v[176:179], a[192:195], v[100:103]
    v_exp_f32 v92, v92
    v_mfma_f32_16x16x32_bf16 v[108:111], v[176:179], a[196:199], v[108:111]
    ds_read_b128 v[160:163], v1 offset:0
    ds_read_b128 v[164:167], v1 offset:1024
    v_mfma_f32_16x16x32_bf16 v[116:119], v[176:179], a[200:203], v[116:119]
    v_add_f32 v150, v150, v92
    v_lshlrev_b32 v44, 16, v28
    v_mfma_f32_16x16x32_bf16 v[124:127], v[176:179], a[204:207], v[124:127]
    ds_read_b128 v[168:171], v1 offset:2048
    ds_read_b128 v[172:175], v1 offset:3072
    v_mfma_f32_16x16x32_bf16 v[100:103], v[180:183], a[208:211], v[100:103]
    v_exp_f32 v93, v93
    v_mfma_f32_16x16x32_bf16 v[108:111], v[180:183], a[212:215], v[108:111]
    v_add_f32 v151, v151, v93
    v_cvt_pk_bf16_f32 v90, v92, v93
    v_mfma_f32_16x16x32_bf16 v[116:119], v[180:183], a[216:219], v[116:119]
    v_exp_f32 v94, v94
    v_mfma_f32_16x16x32_bf16 v[124:127], v[180:183], a[220:223], v[124:127]
    v_add_f32 v150, v150, v94
    v_and_b32 v45, s62, v28
    v_mfma_f32_16x16x32_bf16 v[100:103], v[184:187], a[224:227], v[100:103]
    v_exp_f32 v95, v95
    v_mfma_f32_16x16x32_bf16 v[108:111], v[184:187], a[228:231], v[108:111]
    v_add_f32 v151, v151, v95
    v_cvt_pk_bf16_f32 v91, v94, v95
    v_mfma_f32_16x16x32_bf16 v[116:119], v[184:187], a[232:235], v[116:119]
    v_mul_f32 v40, s61, v40
    v_mul_f32 v41, s61, v41
    v_mfma_f32_16x16x32_bf16 v[124:127], v[184:187], a[236:239], v[124:127]
    v_mul_f32 v44, -v44, v40
    v_mul_f32 v45, -v45, v41
    v_mfma_f32_16x16x32_bf16 v[100:103], v[188:191], a[240:243], v[100:103]
    v_mfma_f32_16x16x32_bf16 v[108:111], v[188:191], a[244:247], v[108:111]
    v_mfma_f32_16x16x32_bf16 v[116:119], v[188:191], a[248:251], v[116:119]
    v_mfma_f32_16x16x32_bf16 v[124:127], v[188:191], a[252:255], v[124:127]
    s_sub_u32 s57, s57, 1
    s_cmp_lg_u32 s57, 0
    s_cbranch_scc1 LOOP_A
    s_branch TAIL
VER_B:
    v_mul_u32_u24 v4, 6144, v16
    v_lshl_add_u32 v4, v15, 4, v4
    v_add_u32 v5, 3072, v4
    v_lshlrev_b32 v8, 4, v16
    s_sub_u32 s63, s51, 2
    s_mul_i32 s58, s63, 24576
    s_lshl_b32 s19, s52, 8
    s_add_u32 s58, s58, s19
    s_lshl_b32 s59, s63, 6
    s_mul_i32 s60, s63, 12288
    s_lshl_b32 s19, s52, 12
    s_add_u32 s60, s60, s19
    s_lshl_b32 s68, s17, 12
    s_waitcnt lgkmcnt(0)
    s_add_u32 s24, s76, s71
    s_addc_u32 s25, s77, 0
    s_mov_b32 s26, 1572864
    s_mov_b32 s27, 0x00020000
    s_add_u32 s28, s82, s68
    s_addc_u32 s29, s83, 0
    s_mov_b32 s30, 4096
    s_mov_b32 s31, 0x00020000
    s_add_u32 s32, s84, s68
    s_addc_u32 s33, s85, 0
    s_mov_b32 s34, 4096
    s_mov_b32 s35, 0x00020000
    s_add_u32 s36, s90, s67
    s_addc_u32 s37, s91, 0
    s_mov_b32 s38, 786432
    s_mov_b32 s39, 0x00020000
    s_cmp_lt_u32 s63, 2
    s_cselect_b32 s26, s26, 0
    s_cselect_b32 s30, s30, 0
    s_cselect_b32 s34, s34, 0
    s_cselect_b32 s38, s38, 0
    v_cmp_ne_u32 vcc, 0, v0
    v_mov_b32 v17, 4096
    s_lshl_b32 s19, s18, 2
    s_add_u32 s19, s19, s16
    s_lshl_b32 s19, s19, 2
    buffer_load_dwordx2 v[24:25], v8, s[28:31], s59 offen offset:0
    buffer_load_dwordx2 v[28:29], v8, s[32:35], s59 offen offset:0
    buffer_load_dwordx2 v[26:27], v8, s[28:31], s59 offen offset:8
    buffer_load_dwordx2 v[30:31], v8, s[32:35], s59 offen offset:8
    buffer_load_dwordx4 v[224:227], v4, s[24:27], s58 offen offset:0 nt
    buffer_load_dwordx4 v[228:231], v4, s[24:27], s58 offen offset:768 nt
    buffer_load_dwordx4 v[232:235], v4, s[24:27], s58 offen offset:1536 nt
    buffer_load_dwordx4 v[236:239], v4, s[24:27], s58 offen offset:2304 nt
    buffer_load_dwordx4 v[240:243], v5, s[24:27], s58 offen offset:0 nt
    buffer_load_dwordx4 v[244:247], v5, s[24:27], s58 offen offset:768 nt
    buffer_load_dwordx4 v[248:251], v5, s[24:27], s58 offen offset:1536 nt
    buffer_load_dwordx4 v[252:255], v5, s[24:27], s58 offen offset:2304 nt
    s_cmp_lt_u32 s50, 12
    s_cselect_b32 s26, 1572864, 0
    s_cselect_b32 s30, 4096, 0
    s_cselect_b32 s34, 4096, 0
    s_cselect_b32 s64, 786432, 0
    s_add_u32 s58, s58, 98304
    s_add_u32 s59, s59, 256
    s_add_u32 s63, s60, 49152
    buffer_load_dwordx2 v[32:33], v8, s[28:31], s59 offen offset:0
    buffer_load_dwordx2 v[36:37], v8, s[32:35], s59 offen offset:0
    buffer_load_dwordx2 v[34:35], v8, s[28:31], s59 offen offset:8
    buffer_load_dwordx2 v[38:39], v8, s[32:35], s59 offen offset:8
    buffer_load_dwordx4 v[64:67], v4, s[24:27], s58 offen offset:0 nt
    buffer_load_dwordx4 v[68:71], v4, s[24:27], s58 offen offset:768 nt
    buffer_load_dwordx4 v[72:75], v4, s[24:27], s58 offen offset:1536 nt
    buffer_load_dwordx4 v[76:79], v4, s[24:27], s58 offen offset:2304 nt
    buffer_load_dwordx4 v[80:83], v5, s[24:27], s58 offen offset:0 nt
    buffer_load_dwordx4 v[84:87], v5, s[24:27], s58 offen offset:768 nt
    buffer_load_dwordx4 v[88:91], v5, s[24:27], s58 offen offset:1536 nt
    buffer_load_dwordx4 v[92:95], v5, s[24:27], s58 offen offset:2304 nt
    s_add_u32 s58, s58, 98304
    s_add_u32 s59, s59, 256
    s_add_u32 s4, s72, s57
    s_addc_u32 s5, s73, 0
    s_mov_b32 s6, 25165824
    s_mov_b32 s7, 0x00020000
    v_mov_b32 v16, s19
    v_cndmask_b32 v9, v16, v17, vcc
    v_and_b32 v13, 31, v0
    v_lshlrev_b32 v13, 2, v13
    s_lshl_b32 s19, s17, 12
    s_add_u32 s19, s19, 50331648
    s_add_u32 s12, s86, s57
    s_addc_u32 s13, s87, 0
    s_mov_b32 s14, 25165824
    s_mov_b32 s15, 0x00020000
    s_add_u32 s40, s90, s19
    s_addc_u32 s41, s91, 0
    s_mov_b32 s42, 256
    s_mov_b32 s43, 0x00020000
    s_add_u32 s8, s90, s22
    s_addc_u32 s9, s91, 0
    s_mov_b32 s10, 786432
    s_mov_b32 s11, 0x00020000
    v_and_b32 v15, 15, v0
    v_lshrrev_b32 v16, 4, v0
    v_mul_u32_u24 v22, 1536, v16
    v_lshl_add_u32 v22, v15, 3, v22
    v_lshl_add_u32 v20, v15, 2, s70
    v_lshl_add_u32 v21, v16, 4, s70
    v_mov_b32 v23, 99328
    s_barrier
    ds_read_b64 v[18:19], v23 offset:16
    v_accvgpr_write_b32 a0, 0
    v_accvgpr_write_b32 a1, 0
    v_accvgpr_write_b32 a2, 0
    v_accvgpr_write_b32 a3, 0
    v_accvgpr_write_b32 a4, 0
    v_accvgpr_write_b32 a5, 0
    v_accvgpr_write_b32 a6, 0
    v_accvgpr_write_b32 a7, 0
    v_accvgpr_write_b32 a8, 0
    v_accvgpr_write_b32 a9, 0
    v_accvgpr_write_b32 a10, 0
    v_accvgpr_write_b32 a11, 0
    v_accvgpr_write_b32 a12, 0
    v_accvgpr_write_b32 a13, 0
    v_accvgpr_write_b32 a14, 0
    v_accvgpr_write_b32 a15, 0
    v_accvgpr_write_b32 a16, 0
    v_accvgpr_write_b32 a17, 0
    v_accvgpr_write_b32 a18, 0
    v_accvgpr_write_b32 a19, 0
    v_accvgpr_write_b32 a20, 0
    v_accvgpr_write_b32 a21, 0
    v_accvgpr_write_b32 a22, 0
    v_accvgpr_write_b32 a23, 0
    v_accvgpr_write_b32 a24, 0
    v_accvgpr_write_b32 a25, 0
    v_accvgpr_write_b32 a26, 0
    v_accvgpr_write_b32 a27, 0
    v_accvgpr_write_b32 a28, 0
    v_accvgpr_write_b32 a29, 0
    v_accvgpr_write_b32 a30, 0
    v_accvgpr_write_b32 a31, 0
    v_accvgpr_write_b32 a32, 0
    v_accvgpr_write_b32 a33, 0
    v_accvgpr_write_b32 a34, 0
    v_accvgpr_write_b32 a35, 0
    v_accvgpr_write_b32 a36, 0
    v_accvgpr_write_b32 a37, 0
    v_accvgpr_write_b32 a38, 0
    v_accvgpr_write_b32 a39, 0
    v_accvgpr_write_b32 a40, 0
    v_accvgpr_write_b32 a41, 0
    v_accvgpr_write_b32 a42, 0
    v_accvgpr_write_b32 a43, 0
    v_accvgpr_write_b32 a44, 0
    v_accvgpr_write_b32 a45, 0
    v_accvgpr_write_b32 a46, 0
    v_accvgpr_write_b32 a47, 0
    v_accvgpr_write_b32 a48, 0
    v_accvgpr_write_b32 a49, 0
    v_accvgpr_write_b32 a50, 0
    v_accvgpr_write_b32 a51, 0
    v_accvgpr_write_b32 a52, 0
    v_accvgpr_write_b32 a53, 0
    v_accvgpr_write_b32 a54, 0
    v_accvgpr_write_b32 a55, 0
    v_accvgpr_write_b32 a56, 0
    v_accvgpr_write_b32 a57, 0
    v_accvgpr_write_b32 a58, 0
    v_accvgpr_write_b32 a59, 0
    v_accvgpr_write_b32 a60, 0
    v_accvgpr_write_b32 a61, 0
    v_accvgpr_write_b32 a62, 0
    v_accvgpr_write_b32 a63, 0
    v_accvgpr_write_b32 a64, 0
    v_accvgpr_write_b32 a65, 0
    v_accvgpr_write_b32 a66, 0
    v_accvgpr_write_b32 a67, 0
    v_accvgpr_write_b32 a68, 0
    v_accvgpr_write_b32 a69, 0
    v_accvgpr_write_b32 a70, 0
    v_accvgpr_write_b32 a71, 0
    v_accvgpr_write_b32 a72, 0
    v_accvgpr_write_b32 a73, 0
    v_accvgpr_write_b32 a74, 0
    v_accvgpr_write_b32 a75, 0
    v_accvgpr_write_b32 a76, 0
    v_accvgpr_write_b32 a77, 0
    v_accvgpr_write_b32 a78, 0
    v_accvgpr_write_b32 a79, 0
    v_accvgpr_write_b32 a80, 0
    v_accvgpr_write_b32 a81, 0
    v_accvgpr_write_b32 a82, 0
    v_accvgpr_write_b32 a83, 0
    v_accvgpr_write_b32 a84, 0
    v_accvgpr_write_b32 a85, 0
    v_accvgpr_write_b32 a86, 0
    v_accvgpr_write_b32 a87, 0
    v_accvgpr_write_b32 a88, 0
    v_accvgpr_write_b32 a89, 0
    v_accvgpr_write_b32 a90, 0
    v_accvgpr_write_b32 a91, 0
    v_accvgpr_write_b32 a92, 0
    v_accvgpr_write_b32 a93, 0
    v_accvgpr_write_b32 a94, 0
    v_accvgpr_write_b32 a95, 0
    v_accvgpr_write_b32 a96, 0
    v_accvgpr_write_b32 a97, 0
    v_accvgpr_write_b32 a98, 0
    v_accvgpr_write_b32 a99, 0
    v_accvgpr_write_b32 a100, 0
    v_accvgpr_write_b32 a101, 0
    v_accvgpr_write_b32 a102, 0
    v_accvgpr_write_b32 a103, 0
    v_accvgpr_write_b32 a104, 0
    v_accvgpr_write_b32 a105, 0
    v_accvgpr_write_b32 a106, 0
    v_accvgpr_write_b32 a107, 0
    v_accvgpr_write_b32 a108, 0
    v_accvgpr_write_b32 a109, 0
    v_accvgpr_write_b32 a110, 0
    v_accvgpr_write_b32 a111, 0
    v_accvgpr_write_b32 a112, 0
    v_accvgpr_write_b32 a113, 0
    v_accvgpr_write_b32 a114, 0
    v_accvgpr_write_b32 a115, 0
    v_accvgpr_write_b32 a116, 0
    v_accvgpr_write_b32 a117, 0
    v_accvgpr_write_b32 a118, 0
    v_accvgpr_write_b32 a119, 0
    v_accvgpr_write_b32 a120, 0
    v_accvgpr_write_b32 a121, 0
    v_accvgpr_write_b32 a122, 0
    v_accvgpr_write_b32 a123, 0
    v_accvgpr_write_b32 a124, 0
    v_accvgpr_write_b32 a125, 0
    v_accvgpr_write_b32 a126, 0
    v_accvgpr_write_b32 a127, 0
    v_accvgpr_write_b32 a128, 0
    v_accvgpr_write_b32 a129, 0
    v_accvgpr_write_b32 a130, 0
    v_accvgpr_write_b32 a131, 0
    v_accvgpr_write_b32 a132, 0
    v_accvgpr_write_b32 a133, 0
    v_accvgpr_write_b32 a134, 0
    v_accvgpr_write_b32 a135, 0
    v_accvgpr_write_b32 a136, 0
    v_accvgpr_write_b32 a137, 0
    v_accvgpr_write_b32 a138, 0
    v_accvgpr_write_b32 a139, 0
    v_accvgpr_write_b32 a140, 0
    v_accvgpr_write_b32 a141, 0
    v_accvgpr_write_b32 a142, 0
    v_accvgpr_write_b32 a143, 0
    v_accvgpr_write_b32 a144, 0
    v_accvgpr_write_b32 a145, 0
    v_accvgpr_write_b32 a146, 0
    v_accvgpr_write_b32 a147, 0
    v_accvgpr_write_b32 a148, 0
    v_accvgpr_write_b32 a149, 0
    v_accvgpr_write_b32 a150, 0
    v_accvgpr_write_b32 a151, 0
    v_accvgpr_write_b32 a152, 0
    v_accvgpr_write_b32 a153, 0
    v_accvgpr_write_b32 a154, 0
    v_accvgpr_write_b32 a155, 0
    v_accvgpr_write_b32 a156, 0
    v_accvgpr_write_b32 a157, 0
    v_accvgpr_write_b32 a158, 0
    v_accvgpr_write_b32 a159, 0
    v_accvgpr_write_b32 a160, 0
    v_accvgpr_write_b32 a161, 0
    v_accvgpr_write_b32 a162, 0
    v_accvgpr_write_b32 a163, 0
    v_accvgpr_write_b32 a164, 0
    v_accvgpr_write_b32 a165, 0
    v_accvgpr_write_b32 a166, 0
    v_accvgpr_write_b32 a167, 0
    v_accvgpr_write_b32 a168, 0
    v_accvgpr_write_b32 a169, 0
    v_accvgpr_write_b32 a170, 0
    v_accvgpr_write_b32 a171, 0
    v_accvgpr_write_b32 a172, 0
    v_accvgpr_write_b32 a173, 0
    v_accvgpr_write_b32 a174, 0
    v_accvgpr_write_b32 a175, 0
    v_accvgpr_write_b32 a176, 0
    v_accvgpr_write_b32 a177, 0
    v_accvgpr_write_b32 a178, 0
    v_accvgpr_write_b32 a179, 0
    v_accvgpr_write_b32 a180, 0
    v_accvgpr_write_b32 a181, 0
    v_accvgpr_write_b32 a182, 0
    v_accvgpr_write_b32 a183, 0
    v_accvgpr_write_b32 a184, 0
    v_accvgpr_write_b32 a185, 0
    v_accvgpr_write_b32 a186, 0
    v_accvgpr_write_b32 a187, 0
    v_accvgpr_write_b32 a188, 0
    v_accvgpr_write_b32 a189, 0
    v_accvgpr_write_b32 a190, 0
    v_accvgpr_write_b32 a191, 0
    s_waitcnt lgkmcnt(0)
    v_readfirstlane_b32 s44, v18
    v_readfirstlane_b32 s45, v19
    v_mov_b32 v144, 0
    v_mov_b32 v145, 0
    v_mov_b32 v146, 0
    v_mov_b32 v147, 0
    v_mov_b32 v148, 0
    v_mov_b32 v149, 0
    v_mov_b32 v150, 0
    v_mov_b32 v151, 0
    buffer_load_dwordx4 v[192:195], v14, s[4:7], s23 offen offset:0 nt
    buffer_load_dwordx4 v[196:199], v14, s[4:7], s54 offen offset:0 nt
    s_waitcnt vmcnt(24)
    v_lshlrev_b32 v40, 16, v24
    v_and_b32 v41, s62, v24
    v_lshlrev_b32 v42, 16, v28
    v_and_b32 v43, s62, v28
    v_mul_f32 v42, -v42, v40
    v_mul_f32 v43, -v43, v41
    s_waitcnt vmcnt(20)
    v_cvt_f32_i32 v224, v224
    v_cvt_f32_i32 v225, v225
    v_cvt_f32_i32 v226, v226
    v_cvt_f32_i32 v227, v227
    v_cvt_f32_i32 v228, v228
    v_cvt_f32_i32 v229, v229
    v_cvt_f32_i32 v230, v230
    v_cvt_f32_i32 v231, v231
    v_fma_f32 v224, v224, v40, v42
    v_fma_f32 v225, v225, v40, v42
    v_fma_f32 v226, v226, v40, v42
    v_fma_f32 v227, v227, v40, v42
    v_fma_f32 v228, v228, v41, v43
    v_fma_f32 v229, v229, v41, v43
    v_fma_f32 v230, v230, v41, v43
    v_fma_f32 v231, v231, v41, v43
    v_cvt_pk_bf16_f32 v128, v224, v228
    v_cvt_pk_bf16_f32 v132, v225, v229
    v_cvt_pk_bf16_f32 v136, v226, v230
    v_cvt_pk_bf16_f32 v140, v227, v231
    s_waitcnt vmcnt(24)
    v_lshlrev_b32 v44, 16, v25
    v_and_b32 v45, s62, v25
    v_lshlrev_b32 v46, 16, v29
    v_and_b32 v47, s62, v29
    v_mul_f32 v46, -v46, v44
    v_mul_f32 v47, -v47, v45
    s_waitcnt vmcnt(18)
    v_cvt_f32_i32 v232, v232
    v_cvt_f32_i32 v233, v233
    v_cvt_f32_i32 v234, v234
    v_cvt_f32_i32 v235, v235
    v_cvt_f32_i32 v236, v236
    v_cvt_f32_i32 v237, v237
    v_cvt_f32_i32 v238, v238
    v_cvt_f32_i32 v239, v239
    v_fma_f32 v232, v232, v44, v46
    v_fma_f32 v233, v233, v44, v46
    v_fma_f32 v234, v234, v44, v46
    v_fma_f32 v235, v235, v44, v46
    v_fma_f32 v236, v236, v45, v47
    v_fma_f32 v237, v237, v45, v47
    v_fma_f32 v238, v238, v45, v47
    v_fma_f32 v239, v239, v45, v47
    v_cvt_pk_bf16_f32 v129, v232, v236
    v_cvt_pk_bf16_f32 v133, v233, v237
    v_cvt_pk_bf16_f32 v137, v234, v238
    v_cvt_pk_bf16_f32 v141, v235, v239
    s_waitcnt vmcnt(22)
    v_lshlrev_b32 v40, 16, v26
    v_and_b32 v41, s62, v26
    v_lshlrev_b32 v42, 16, v30
    v_and_b32 v43, s62, v30
    v_mul_f32 v42, -v42, v40
    v_mul_f32 v43, -v43, v41
    s_waitcnt vmcnt(16)
    v_cvt_f32_i32 v240, v240
    v_cvt_f32_i32 v241, v241
    v_cvt_f32_i32 v242, v242
    v_cvt_f32_i32 v243, v243
    v_cvt_f32_i32 v244, v244
    v_cvt_f32_i32 v245, v245
    v_cvt_f32_i32 v246, v246
    v_cvt_f32_i32 v247, v247
    v_fma_f32 v240, v240, v40, v42
    v_fma_f32 v241, v241, v40, v42
    v_fma_f32 v242, v242, v40, v42
    v_fma_f32 v243, v243, v40, v42
    v_fma_f32 v244, v244, v41, v43
    v_fma_f32 v245, v245, v41, v43
    v_fma_f32 v246, v246, v41, v43
    v_fma_f32 v247, v247, v41, v43
    v_cvt_pk_bf16_f32 v130, v240, v244
    v_cvt_pk_bf16_f32 v134, v241, v245
    v_cvt_pk_bf16_f32 v138, v242, v246
    v_cvt_pk_bf16_f32 v142, v243, v247
    s_waitcnt vmcnt(22)
    v_lshlrev_b32 v44, 16, v27
    v_and_b32 v45, s62, v27
    v_lshlrev_b32 v46, 16, v31
    v_and_b32 v47, s62, v31
    v_mul_f32 v46, -v46, v44
    v_mul_f32 v47, -v47, v45
    s_waitcnt vmcnt(14)
    v_cvt_f32_i32 v248, v248
    v_cvt_f32_i32 v249, v249
    v_cvt_f32_i32 v250, v250
    v_cvt_f32_i32 v251, v251
    v_cvt_f32_i32 v252, v252
    v_cvt_f32_i32 v253, v253
    v_cvt_f32_i32 v254, v254
    v_cvt_f32_i32 v255, v255
    v_fma_f32 v248, v248, v44, v46
    v_fma_f32 v249, v249, v44, v46
    v_fma_f32 v250, v250, v44, v46
    v_fma_f32 v251, v251, v44, v46
    v_fma_f32 v252, v252, v45, v47
    v_fma_f32 v253, v253, v45, v47
    v_fma_f32 v254, v254, v45, v47
    v_fma_f32 v255, v255, v45, v47
    v_cvt_pk_bf16_f32 v131, v248, v252
    v_cvt_pk_bf16_f32 v135, v249, v253
    v_cvt_pk_bf16_f32 v139, v250, v254
    v_cvt_pk_bf16_f32 v143, v251, v255
    buffer_store_dwordx4 v[128:131], v1, s[36:39], s60 offen offset:0
    buffer_store_dwordx4 v[132:135], v1, s[36:39], s60 offen offset:1024
    buffer_store_dwordx4 v[136:139], v1, s[36:39], s60 offen offset:2048
    buffer_store_dwordx4 v[140:143], v1, s[36:39], s60 offen offset:3072
    s_mov_b32 s38, s64
    s_waitcnt vmcnt(12)
    s_waitcnt vmcnt(14)
    v_lshlrev_b32 v40, 16, v32
    v_and_b32 v41, s62, v32
    v_lshlrev_b32 v42, 16, v36
    v_and_b32 v43, s62, v36
    v_mul_f32 v42, -v42, v40
    v_mul_f32 v43, -v43, v41
    v_cvt_f32_i32 v64, v64
    v_cvt_f32_i32 v65, v65
    v_cvt_f32_i32 v66, v66
    v_cvt_f32_i32 v67, v67
    v_cvt_f32_i32 v68, v68
    v_cvt_f32_i32 v69, v69
    v_cvt_f32_i32 v70, v70
    v_cvt_f32_i32 v71, v71
    v_fma_f32 v64, v64, v40, v42
    v_fma_f32 v65, v65, v40, v42
    v_fma_f32 v66, v66, v40, v42
    v_fma_f32 v67, v67, v40, v42
    v_fma_f32 v68, v68, v41, v43
    v_fma_f32 v69, v69, v41, v43
    v_fma_f32 v70, v70, v41, v43
    v_fma_f32 v71, v71, v41, v43
    v_cvt_pk_bf16_f32 v128, v64, v68
    v_cvt_pk_bf16_f32 v132, v65, v69
    v_cvt_pk_bf16_f32 v136, v66, v70
    v_cvt_pk_bf16_f32 v140, v67, v71
    s_waitcnt vmcnt(10)
    s_waitcnt vmcnt(14)
    v_lshlrev_b32 v44, 16, v33
    v_and_b32 v45, s62, v33
    v_lshlrev_b32 v46, 16, v37
    v_and_b32 v47, s62, v37
    v_mul_f32 v46, -v46, v44
    v_mul_f32 v47, -v47, v45
    v_cvt_f32_i32 v72, v72
    v_cvt_f32_i32 v73, v73
    v_cvt_f32_i32 v74, v74
    v_cvt_f32_i32 v75, v75
    v_cvt_f32_i32 v76, v76
    v_cvt_f32_i32 v77, v77
    v_cvt_f32_i32 v78, v78
    v_cvt_f32_i32 v79, v79
    v_fma_f32 v72, v72, v44, v46
    v_fma_f32 v73, v73, v44, v46
    v_fma_f32 v74, v74, v44, v46
    v_fma_f32 v75, v75, v44, v46
    v_fma_f32 v76, v76, v45, v47
    v_fma_f32 v77, v77, v45, v47
    v_fma_f32 v78, v78, v45, v47
    v_fma_f32 v79, v79, v45, v47
    v_cvt_pk_bf16_f32 v129, v72, v76
    v_cvt_pk_bf16_f32 v133, v73, v77
    v_cvt_pk_bf16_f32 v137, v74, v78
    v_cvt_pk_bf16_f32 v141, v75, v79
    s_waitcnt vmcnt(8)
    s_waitcnt vmcnt(14)
    v_lshlrev_b32 v40, 16, v34
    v_and_b32 v41, s62, v34
    v_lshlrev_b32 v42, 16, v38
    v_and_b32 v43, s62, v38
    v_mul_f32 v42, -v42, v40
    v_mul_f32 v43, -v43, v41
    v_cvt_f32_i32 v80, v80
    v_cvt_f32_i32 v81, v81
    v_cvt_f32_i32 v82, v82
    v_cvt_f32_i32 v83, v83
    v_cvt_f32_i32 v84, v84
    v_cvt_f32_i32 v85, v85
    v_cvt_f32_i32 v86, v86
    v_cvt_f32_i32 v87, v87
    v_fma_f32 v80, v80, v40, v42
    v_fma_f32 v81, v81, v40, v42
    v_fma_f32 v82, v82, v40, v42
    v_fma_f32 v83, v83, v40, v42
    v_fma_f32 v84, v84, v41, v43
    v_fma_f32 v85, v85, v41, v43
    v_fma_f32 v86, v86, v41, v43
    v_fma_f32 v87, v87, v41, v43
    v_cvt_pk_bf16_f32 v130, v80, v84
    v_cvt_pk_bf16_f32 v134, v81, v85
    v_cvt_pk_bf16_f32 v138, v82, v86
    v_cvt_pk_bf16_f32 v142, v83, v87
    s_waitcnt vmcnt(6)
    s_waitcnt vmcnt(14)
    v_lshlrev_b32 v44, 16, v35
    v_and_b32 v45, s62, v35
    v_lshlrev_b32 v46, 16, v39
    v_and_b32 v47, s62, v39
    v_mul_f32 v46, -v46, v44
    v_mul_f32 v47, -v47, v45
    v_cvt_f32_i32 v88, v88
    v_cvt_f32_i32 v89, v89
    v_cvt_f32_i32 v90, v90
    v_cvt_f32_i32 v91, v91
    v_cvt_f32_i32 v92, v92
    v_cvt_f32_i32 v93, v93
    v_cvt_f32_i32 v94, v94
    v_cvt_f32_i32 v95, v95
    v_fma_f32 v88, v88, v44, v46
    v_fma_f32 v89, v89, v44, v46
    v_fma_f32 v90, v90, v44, v46
    v_fma_f32 v91, v91, v44, v46
    v_fma_f32 v92, v92, v45, v47
    v_fma_f32 v93, v93, v45, v47
    v_fma_f32 v94, v94, v45, v47
    v_fma_f32 v95, v95, v45, v47
    v_cvt_pk_bf16_f32 v131, v88, v92
    v_cvt_pk_bf16_f32 v135, v89, v93
    v_cvt_pk_bf16_f32 v139, v90, v94
    v_cvt_pk_bf16_f32 v143, v91, v95
    buffer_store_dwordx4 v[128:131], v1, s[36:39], s63 offen offset:0
    buffer_store_dwordx4 v[132:135], v1, s[36:39], s63 offen offset:1024
    buffer_store_dwordx4 v[136:139], v1, s[36:39], s63 offen offset:2048
    buffer_store_dwordx4 v[140:143], v1, s[36:39], s63 offen offset:3072
    s_add_u32 s60, s60, 98304
    s_getreg_b32 s64, hwreg(HW_REG_XCC_ID, 0, 3)
    s_lshl_b32 s64, s64, 5
    s_lshl_b32 s63, s44, 8
    s_add_u32 s64, s64, 2
    s_add_u32 s64, s64, s63
    s_lshr_b64 s[44:45], s[44:45], 24
    s_mov_b32 s57, s44
    s_sub_u32 s63, s64, 524288
    v_mov_b32 v10, s64
    v_mov_b32 v11, s57
    s_lshl_b32 s19, s18, 3
    s_add_u32 s19, s19, 128
    s_cmp_eq_u32 s16, 0
    s_cselect_b32 s19, s19, 4096
    v_max_u32 v16, s19, v9
    v_lshrrev_b32 v17, 4, v13
    v_lshlrev_b32 v17, 3, v17
    s_waitcnt vmcnt(0)
    s_barrier
    buffer_store_dword v10, v9, s[40:43], 0 offen
    v_add_u32 v10, 1, v10
    buffer_load_dwordx4 v[200:203], v14, s[4:7], s55 offen offset:0 nt
    buffer_load_dwordx4 v[204:207], v14, s[4:7], s56 offen offset:0 nt
    buffer_load_dwordx4 v[208:211], v14, s[4:7], s23 offen offset:64 nt
    buffer_load_dwordx4 v[212:215], v14, s[4:7], s54 offen offset:64 nt
    buffer_load_dwordx4 v[216:219], v14, s[4:7], s55 offen offset:64 nt
    buffer_load_dwordx4 v[220:223], v14, s[4:7], s56 offen offset:64 nt
    buffer_load_dwordx2 v[24:25], v8, s[28:31], s59 offen offset:0
    buffer_load_dwordx2 v[28:29], v8, s[32:35], s59 offen offset:0
    buffer_load_dwordx2 v[26:27], v8, s[28:31], s59 offen offset:8
    buffer_load_dwordx2 v[30:31], v8, s[32:35], s59 offen offset:8
    buffer_load_dwordx4 v[224:227], v4, s[24:27], s58 offen offset:0 nt
    buffer_load_dwordx4 v[228:231], v4, s[24:27], s58 offen offset:768 nt
    buffer_load_dwordx4 a[192:195], v14, s[4:7], s23 offen offset:128 nt
    buffer_load_dwordx4 a[196:199], v14, s[4:7], s54 offen offset:128 nt
    buffer_load_dwordx4 a[200:203], v14, s[4:7], s55 offen offset:128 nt
    buffer_load_dwordx4 a[204:207], v14, s[4:7], s56 offen offset:128 nt
    buffer_load_dwordx4 a[208:211], v14, s[4:7], s23 offen offset:192 nt
    buffer_load_dwordx4 a[212:215], v14, s[4:7], s54 offen offset:192 nt
    buffer_load_dwordx4 a[216:219], v14, s[4:7], s55 offen offset:192 nt
    buffer_load_dwordx4 a[220:223], v14, s[4:7], s56 offen offset:192 nt
    buffer_load_dwordx4 a[224:227], v14, s[4:7], s23 offen offset:256 nt
    buffer_load_dwordx4 a[228:231], v14, s[4:7], s54 offen offset:256 nt
    buffer_load_dwordx4 a[232:235], v14, s[4:7], s55 offen offset:256 nt
    buffer_load_dwordx4 a[236:239], v14, s[4:7], s56 offen offset:256 nt
    buffer_load_dwordx4 a[240:243], v14, s[4:7], s23 offen offset:320 nt
    buffer_load_dwordx4 a[244:247], v14, s[4:7], s54 offen offset:320 nt
    buffer_load_dwordx4 a[248:251], v14, s[4:7], s55 offen offset:320 nt
    buffer_load_dwordx4 a[252:255], v14, s[4:7], s56 offen offset:320 nt
    s_mov_b32 s52, 1024
SPOLL_B:
    s_load_dwordx8 s[44:51], s[40:41], 128 glc
    s_load_dwordx8 s[64:71], s[40:41], 160 glc
    s_sub_u32 s52, s52, 1
    s_waitcnt lgkmcnt(0)
    s_sub_u32 s44, s44, s63
    s_xor_b32 s45, s45, s57
    s_sub_u32 s46, s46, s63
    s_xor_b32 s47, s47, s57
    s_sub_u32 s48, s48, s63
    s_xor_b32 s49, s49, s57
    s_sub_u32 s50, s50, s63
    s_xor_b32 s51, s51, s57
    s_sub_u32 s64, s64, s63
    s_xor_b32 s65, s65, s57
    s_sub_u32 s66, s66, s63
    s_xor_b32 s67, s67, s57
    s_sub_u32 s68, s68, s63
    s_xor_b32 s69, s69, s57
    s_sub_u32 s70, s70, s63
    s_xor_b32 s71, s71, s57
    s_or_b64 s[44:45], s[44:45], s[64:65]
    s_or_b64 s[46:47], s[46:47], s[66:67]
    s_or_b64 s[48:49], s[48:49], s[68:69]
    s_or_b64 s[50:51], s[50:51], s[70:71]
    s_or_b64 s[44:45], s[44:45], s[46:47]
    s_or_b64 s[48:49], s[48:49], s[50:51]
    s_or_b64 s[44:45], s[44:45], s[48:49]
    s_and_b32 s44, s44, 0xfff000ff
    s_or_b32 s44, s44, s45
    s_cbranch_scc0 RET_B0
    s_cmp_lg_u32 s52, 0
    s_cbranch_scc1 SPOLL_B
    s_mov_b32 s10, 0
    s_mov_b32 s53, 1
RET_B0:
    buffer_load_dword v11, v17, s[40:43], 0 offen offset:128 sc1
    s_add_u32 m0, s21, 49152
    s_nop 0
    buffer_load_dwordx4 v1, s[8:11], s20 offen offset:0 sc1 lds
    buffer_load_dwordx4 v1, s[8:11], s20 offen offset:1024 sc1 lds
    buffer_load_dwordx4 v1, s[8:11], s20 offen offset:2048 sc1 lds
    buffer_load_dwordx4 v1, s[8:11], s20 offen offset:3072 sc1 lds
    s_add_u32 m0, s21, 53248
    s_nop 0
    buffer_load_dwordx4 v3, s[8:11], s20 offen offset:0 sc1 lds
    buffer_load_dwordx4 v3, s[8:11], s20 offen offset:1024 sc1 lds
    s_add_u32 s20, s20, 12288
    s_add_u32 m0, s21, 73728
    s_nop 0
    buffer_load_dwordx4 v1, s[8:11], s20 offen offset:0 sc1 lds
    buffer_load_dwordx4 v1, s[8:11], s20 offen offset:1024 sc1 lds
    buffer_load_dwordx4 v1, s[8:11], s20 offen offset:2048 sc1 lds
    buffer_load_dwordx4 v1, s[8:11], s20 offen offset:3072 sc1 lds
    s_add_u32 m0, s21, 77824
    s_nop 0
    buffer_load_dwordx4 v3, s[8:11], s20 offen offset:0 sc1 lds
    buffer_load_dwordx4 v3, s[8:11], s20 offen offset:1024 sc1 lds
    s_add_u32 s20, s20, 12288
    buffer_load_dwordx4 v[232:235], v4, s[24:27], s58 offen offset:1536 nt
    buffer_load_dwordx4 v[236:239], v4, s[24:27], s58 offen offset:2304 nt
    buffer_load_dwordx4 v[240:243], v5, s[24:27], s58 offen offset:0 nt
    buffer_load_dwordx4 v[244:247], v5, s[24:27], s58 offen offset:768 nt
    buffer_load_dwordx4 v[248:251], v5, s[24:27], s58 offen offset:1536 nt
    buffer_load_dwordx4 v[252:255], v5, s[24:27], s58 offen offset:2304 nt
    s_add_u32 s59, s59, 256
    s_waitcnt vmcnt(39)
    v_lshlrev_b32 v40, 16, v24
    v_and_b32 v41, s62, v24
    v_lshlrev_b32 v42, 16, v28
    v_and_b32 v43, s62, v28
    v_mul_f32 v42, -v42, v40
    v_mul_f32 v43, -v43, v41
    s_waitcnt vmcnt(35)
    v_cvt_f32_i32 v224, v224
    v_cvt_f32_i32 v225, v225
    v_cvt_f32_i32 v226, v226
    v_cvt_f32_i32 v227, v227
    v_cvt_f32_i32 v228, v228
    v_cvt_f32_i32 v229, v229
    v_cvt_f32_i32 v230, v230
    v_cvt_f32_i32 v231, v231
    v_fma_f32 v224, v224, v40, v42
    v_fma_f32 v225, v225, v40, v42
    v_fma_f32 v226, v226, v40, v42
    v_fma_f32 v227, v227, v40, v42
    v_fma_f32 v228, v228, v41, v43
    v_fma_f32 v229, v229, v41, v43
    v_fma_f32 v230, v230, v41, v43
    v_fma_f32 v231, v231, v41, v43
    v_cvt_pk_bf16_f32 v128, v224, v228
    v_cvt_pk_bf16_f32 v132, v225, v229
    v_cvt_pk_bf16_f32 v136, v226, v230
    v_cvt_pk_bf16_f32 v140, v227, v231
    s_waitcnt vmcnt(12) lgkmcnt(0)
    s_barrier
    ds_read_b128 v[160:163], v2 offset:12288
    ds_read_b128 v[164:167], v2 offset:13312
    ds_read_b128 v[168:171], v2 offset:14336
    ds_read_b128 v[172:175], v2 offset:15360
    s_waitcnt vmcnt(4) lgkmcnt(0)
    v_mfma_f32_16x16x32_bf16 v[64:67], v[160:163], v[192:195], 0
    v_lshlrev_b32 v44, 16, v25
    v_and_b32 v45, s62, v25
    v_mfma_f32_16x16x32_bf16 v[72:75], v[160:163], v[196:199], 0
    ds_read_b128 v[176:179], v2 offset:16384
    ds_read_b128 v[180:183], v2 offset:17408
    v_mfma_f32_16x16x32_bf16 v[80:83], v[160:163], v[200:203], 0
    v_lshlrev_b32 v46, 16, v29
    v_and_b32 v47, s62, v29
    v_mfma_f32_16x16x32_bf16 v[88:91], v[160:163], v[204:207], 0
    ds_read_b128 v[184:187], v2 offset:18432
    ds_read_b128 v[188:191], v2 offset:19456
    v_mfma_f32_16x16x32_bf16 v[64:67], v[164:167], v[208:211], v[64:67]
    s_add_u32 m0, s21, 0
    v_mul_f32 v46, -v46, v44
    v_mfma_f32_16x16x32_bf16 v[72:75], v[164:167], v[212:215], v[72:75]
    buffer_load_dwordx4 v1, s[8:11], s20 offen offset:0 sc1 lds
    v_mul_f32 v47, -v47, v45
    v_mfma_f32_16x16x32_bf16 v[80:83], v[164:167], v[216:219], v[80:83]
    v_cvt_f32_i32 v232, v232
    v_cvt_f32_i32 v233, v233
    v_mfma_f32_16x16x32_bf16 v[88:91], v[164:167], v[220:223], v[88:91]
    v_cvt_f32_i32 v234, v234
    v_cvt_f32_i32 v235, v235
    v_mfma_f32_16x16x32_bf16 v[64:67], v[168:171], a[192:195], v[64:67]
    v_cvt_f32_i32 v236, v236
    v_cvt_f32_i32 v237, v237
    v_mfma_f32_16x16x32_bf16 v[72:75], v[168:171], a[196:199], v[72:75]
    buffer_load_dwordx4 v1, s[8:11], s20 offen offset:1024 sc1 lds
    v_cvt_f32_i32 v238, v238
    v_mfma_f32_16x16x32_bf16 v[80:83], v[168:171], a[200:203], v[80:83]
    v_cvt_f32_i32 v239, v239
    v_fma_f32 v232, v232, v44, v46
    v_mfma_f32_16x16x32_bf16 v[88:91], v[168:171], a[204:207], v[88:91]
    v_fma_f32 v233, v233, v44, v46
    v_fma_f32 v234, v234, v44, v46
    v_mfma_f32_16x16x32_bf16 v[64:67], v[172:175], a[208:211], v[64:67]
    v_fma_f32 v235, v235, v44, v46
    v_fma_f32 v236, v236, v45, v47
    v_mfma_f32_16x16x32_bf16 v[72:75], v[172:175], a[212:215], v[72:75]
    buffer_load_dwordx4 v1, s[8:11], s20 offen offset:2048 sc1 lds
    v_fma_f32 v237, v237, v45, v47
    v_mfma_f32_16x16x32_bf16 v[80:83], v[172:175], a[216:219], v[80:83]
    v_fma_f32 v238, v238, v45, v47
    v_fma_f32 v239, v239, v45, v47
    v_mfma_f32_16x16x32_bf16 v[88:91], v[172:175], a[220:223], v[88:91]
    v_cvt_pk_bf16_f32 v129, v232, v236
    s_waitcnt lgkmcnt(0)
    v_mfma_f32_16x16x32_bf16 v[64:67], v[176:179], a[224:227], v[64:67]
    v_cvt_pk_bf16_f32 v133, v233, v237
    v_cvt_pk_bf16_f32 v137, v234, v238
    v_mfma_f32_16x16x32_bf16 v[72:75], v[176:179], a[228:231], v[72:75]
    ds_read_b128 v[160:163], v2 offset:20480
    ds_read_b128 v[164:167], v2 offset:21504
    v_mfma_f32_16x16x32_bf16 v[80:83], v[176:179], a[232:235], v[80:83]
    buffer_load_dwordx4 v1, s[8:11], s20 offen offset:3072 sc1 lds
    v_cvt_pk_bf16_f32 v141, v235, v239
    v_mfma_f32_16x16x32_bf16 v[88:91], v[176:179], a[236:239], v[88:91]
    ds_read_b128 v[168:171], v2 offset:22528
    ds_read_b128 v[172:175], v2 offset:23552
    v_mfma_f32_16x16x32_bf16 v[64:67], v[180:183], a[240:243], v[64:67]
    s_add_u32 m0, s21, 4096
    buffer_load_dwordx2 v[24:25], v8, s[28:31], s59 offen offset:0
    v_mfma_f32_16x16x32_bf16 v[72:75], v[180:183], a[244:247], v[72:75]
    buffer_load_dwordx4 v3, s[8:11], s20 offen offset:0 sc1 lds
    buffer_load_dwordx2 v[28:29], v8, s[32:35], s59 offen offset:0
    v_mfma_f32_16x16x32_bf16 v[80:83], v[180:183], a[248:251], v[80:83]
    v_mfma_f32_16x16x32_bf16 v[88:91], v[180:183], a[252:255], v[88:91]
    v_mfma_f32_16x16x32_bf16 v[68:71], v[184:187], v[192:195], 0
    v_mfma_f32_16x16x32_bf16 v[76:79], v[184:187], v[196:199], 0
    buffer_load_dwordx4 v3, s[8:11], s20 offen offset:1024 sc1 lds
    v_mfma_f32_16x16x32_bf16 v[84:87], v[184:187], v[200:203], 0
    s_add_u32 s20, s20, 12288
    s_add_u32 s58, s58, 98304
    v_mfma_f32_16x16x32_bf16 v[92:95], v[184:187], v[204:207], 0
    v_mfma_f32_16x16x32_bf16 v[68:71], v[188:191], v[208:211], v[68:71]
    buffer_load_dwordx4 v[224:227], v4, s[24:27], s58 offen offset:0 nt
    v_mfma_f32_16x16x32_bf16 v[76:79], v[188:191], v[212:215], v[76:79]
    v_mfma_f32_16x16x32_bf16 v[84:87], v[188:191], v[216:219], v[84:87]
    buffer_load_dwordx4 v[228:231], v4, s[24:27], s58 offen offset:768 nt
    v_mfma_f32_16x16x32_bf16 v[92:95], v[188:191], v[220:223], v[92:95]
    s_waitcnt vmcnt(16) lgkmcnt(0)
    s_barrier
    v_mfma_f32_16x16x32_bf16 v[68:71], v[160:163], a[192:195], v[68:71]
    v_mfma_f32_16x16x32_bf16 v[76:79], v[160:163], a[196:199], v[76:79]
    ds_read_b128 v[176:179], v2 offset:36864
    ds_read_b128 v[180:183], v2 offset:37888
    v_mfma_f32_16x16x32_bf16 v[84:87], v[160:163], a[200:203], v[84:87]
    v_mfma_f32_16x16x32_bf16 v[92:95], v[160:163], a[204:207], v[92:95]
    ds_read_b128 v[184:187], v2 offset:38912
    ds_read_b128 v[188:191], v2 offset:39936
    v_mfma_f32_16x16x32_bf16 v[68:71], v[164:167], a[208:211], v[68:71]
    v_mfma_f32_16x16x32_bf16 v[76:79], v[164:167], a[212:215], v[76:79]
    v_mfma_f32_16x16x32_bf16 v[84:87], v[164:167], a[216:219], v[84:87]
    v_mfma_f32_16x16x32_bf16 v[92:95], v[164:167], a[220:223], v[92:95]
    v_mfma_f32_16x16x32_bf16 v[68:71], v[168:171], a[224:227], v[68:71]
    v_mfma_f32_16x16x32_bf16 v[76:79], v[168:171], a[228:231], v[76:79]
    v_mfma_f32_16x16x32_bf16 v[84:87], v[168:171], a[232:235], v[84:87]
    v_mfma_f32_16x16x32_bf16 v[92:95], v[168:171], a[236:239], v[92:95]
    v_mfma_f32_16x16x32_bf16 v[68:71], v[172:175], a[240:243], v[68:71]
    v_mfma_f32_16x16x32_bf16 v[76:79], v[172:175], a[244:247], v[76:79]
    v_mfma_f32_16x16x32_bf16 v[84:87], v[172:175], a[248:251], v[84:87]
    v_mfma_f32_16x16x32_bf16 v[92:95], v[172:175], a[252:255], v[92:95]
    s_waitcnt vmcnt(12) lgkmcnt(0)
    v_mfma_f32_16x16x32_bf16 v[96:99], v[176:179], v[192:195], 0
    v_exp_f32 v64, v64
    v_lshlrev_b32 v40, 16, v26
    v_mfma_f32_16x16x32_bf16 v[104:107], v[176:179], v[196:199], 0
    ds_read_b128 v[160:163], v2 offset:40960
    ds_read_b128 v[164:167], v2 offset:41984
    v_exp_f32 v65, v65
    v_and_b32 v41, s62, v26
    v_mfma_f32_16x16x32_bf16 v[112:115], v[176:179], v[200:203], 0
    buffer_load_dword v12, v13, s[40:43], 0 offen sc1
    v_exp_f32 v66, v66
    v_mfma_f32_16x16x32_bf16 v[120:123], v[176:179], v[204:207], 0
    ds_read_b128 v[168:171], v2 offset:43008
    ds_read_b128 v[172:175], v2 offset:44032
    v_add_f32 v144, v144, v64
    v_lshlrev_b32 v42, 16, v30
    v_mfma_f32_16x16x32_bf16 v[96:99], v[180:183], v[208:211], v[96:99]
    s_add_u32 m0, s21, 24576
    v_exp_f32 v67, v67
    v_mfma_f32_16x16x32_bf16 v[104:107], v[180:183], v[212:215], v[104:107]
    buffer_load_dwordx4 v1, s[8:11], s20 offen offset:0 sc1 lds
    v_exp_f32 v68, v68
    v_and_b32 v43, s62, v30
    v_mfma_f32_16x16x32_bf16 v[112:115], v[180:183], v[216:219], v[112:115]
    v_exp_f32 v69, v69
    v_add_f32 v145, v145, v65
    v_mfma_f32_16x16x32_bf16 v[120:123], v[180:183], v[220:223], v[120:123]
    v_cvt_pk_bf16_f32 v64, v64, v65
    v_add_f32 v144, v144, v66
    v_add_f32 v145, v145, v67
    v_mul_f32 v42, -v42, v40
    v_mfma_f32_16x16x32_bf16 v[96:99], v[184:187], a[192:195], v[96:99]
    v_exp_f32 v70, v70
    v_cvt_pk_bf16_f32 v65, v66, v67
    v_mfma_f32_16x16x32_bf16 v[104:107], v[184:187], a[196:199], v[104:107]
    buffer_load_dwordx4 v1, s[8:11], s20 offen offset:1024 sc1 lds
    v_exp_f32 v71, v71
    v_mul_f32 v43, -v43, v41
    v_mfma_f32_16x16x32_bf16 v[112:115], v[184:187], a[200:203], v[112:115]
    v_add_f32 v144, v144, v68
    v_add_f32 v145, v145, v69
    v_cvt_pk_bf16_f32 v66, v68, v69
    v_mfma_f32_16x16x32_bf16 v[120:123], v[184:187], a[204:207], v[120:123]
    v_exp_f32 v72, v72
    v_add_f32 v144, v144, v70
    v_cvt_f32_i32 v240, v240
    v_mfma_f32_16x16x32_bf16 v[96:99], v[188:191], a[208:211], v[96:99]
    v_exp_f32 v73, v73
    v_add_f32 v145, v145, v71
    v_cvt_f32_i32 v241, v241
    v_mfma_f32_16x16x32_bf16 v[104:107], v[188:191], a[212:215], v[104:107]
    buffer_load_dwordx4 v1, s[8:11], s20 offen offset:2048 sc1 lds
    v_exp_f32 v74, v74
    v_mfma_f32_16x16x32_bf16 v[112:115], v[188:191], a[216:219], v[112:115]
    v_cvt_pk_bf16_f32 v67, v70, v71
    v_add_f32 v146, v146, v72
    v_add_f32 v147, v147, v73
    v_cvt_f32_i32 v242, v242
    v_mfma_f32_16x16x32_bf16 v[120:123], v[188:191], a[220:223], v[120:123]
    v_exp_f32 v75, v75
    s_waitcnt vmcnt(16) lgkmcnt(0)
    v_mfma_f32_16x16x32_bf16 v[96:99], v[160:163], a[224:227], v[96:99]
    v_exp_f32 v76, v76
    v_cvt_pk_bf16_f32 v72, v72, v73
    v_cvt_f32_i32 v243, v243
    v_mfma_f32_16x16x32_bf16 v[104:107], v[160:163], a[228:231], v[104:107]
    ds_read_b128 v[176:179], v2 offset:45056
    ds_read_b128 v[180:183], v2 offset:46080
    buffer_load_dwordx4 v1, s[8:11], s20 offen offset:3072 sc1 lds
    v_exp_f32 v77, v77
    v_mfma_f32_16x16x32_bf16 v[112:115], v[160:163], a[232:235], v[112:115]
    v_add_f32 v146, v146, v74
    v_add_f32 v147, v147, v75
    v_cvt_pk_bf16_f32 v73, v74, v75
    v_cvt_f32_i32 v244, v244
    v_mfma_f32_16x16x32_bf16 v[120:123], v[160:163], a[236:239], v[120:123]
    ds_read_b128 v[184:187], v2 offset:47104
    ds_read_b128 v[188:191], v2 offset:48128
    v_exp_f32 v78, v78
    v_mfma_f32_16x16x32_bf16 v[96:99], v[164:167], a[240:243], v[96:99]
    s_add_u32 m0, s21, 28672
    v_exp_f32 v79, v79
    v_cvt_f32_i32 v245, v245
    v_mfma_f32_16x16x32_bf16 v[104:107], v[164:167], a[244:247], v[104:107]
    buffer_load_dwordx4 v3, s[8:11], s20 offen offset:0 sc1 lds
    v_add_f32 v146, v146, v76
    v_add_f32 v147, v147, v77
    v_mfma_f32_16x16x32_bf16 v[112:115], v[164:167], a[248:251], v[112:115]
    v_exp_f32 v80, v80
    v_cvt_pk_bf16_f32 v74, v76, v77
    v_cvt_f32_i32 v246, v246
    v_mfma_f32_16x16x32_bf16 v[120:123], v[164:167], a[252:255], v[120:123]
    v_exp_f32 v81, v81
    v_add_f32 v146, v146, v78
    v_mfma_f32_16x16x32_bf16 v[100:103], v[168:171], v[192:195], 0
    v_exp_f32 v82, v82
    v_add_f32 v147, v147, v79
    v_cvt_f32_i32 v247, v247
    v_mfma_f32_16x16x32_bf16 v[108:111], v[168:171], v[196:199], 0
    buffer_load_dwordx4 v3, s[8:11], s20 offen offset:1024 sc1 lds
    v_cvt_pk_bf16_f32 v75, v78, v79
    v_add_f32 v148, v148, v80
    v_fma_f32 v240, v240, v40, v42
    v_mfma_f32_16x16x32_bf16 v[116:119], v[168:171], v[200:203], 0
    s_add_u32 s20, s20, 12288
    v_exp_f32 v83, v83
    v_mfma_f32_16x16x32_bf16 v[124:127], v[168:171], v[204:207], 0
    v_exp_f32 v84, v84
    v_add_f32 v149, v149, v81
    v_fma_f32 v241, v241, v40, v42
    v_mfma_f32_16x16x32_bf16 v[100:103], v[172:175], v[208:211], v[100:103]
    buffer_load_dwordx4 v[232:235], v4, s[24:27], s58 offen offset:1536 nt
    v_exp_f32 v85, v85
    v_mfma_f32_16x16x32_bf16 v[108:111], v[172:175], v[212:215], v[108:111]
    v_cvt_pk_bf16_f32 v80, v80, v81
    v_add_f32 v148, v148, v82
    v_add_f32 v149, v149, v83
    v_fma_f32 v242, v242, v40, v42
    v_mfma_f32_16x16x32_bf16 v[116:119], v[172:175], v[216:219], v[116:119]
    buffer_load_dwordx4 v[236:239], v4, s[24:27], s58 offen offset:2304 nt
    v_exp_f32 v86, v86
    v_mfma_f32_16x16x32_bf16 v[124:127], v[172:175], v[220:223], v[124:127]
    v_exp_f32 v87, v87
    v_fma_f32 v243, v243, v40, v42
    s_waitcnt vmcnt(11) lgkmcnt(0)
    s_barrier
    v_mfma_f32_16x16x32_bf16 v[100:103], v[176:179], a[192:195], v[100:103]
    v_cvt_pk_bf16_f32 v81, v82, v83
    v_add_f32 v148, v148, v84
    v_add_f32 v149, v149, v85
    v_mfma_f32_16x16x32_bf16 v[108:111], v[176:179], a[196:199], v[108:111]
    ds_read_b128 v[160:163], v1 offset:0
    ds_read_b128 v[164:167], v1 offset:1024
    v_exp_f32 v88, v88
    v_fma_f32 v244, v244, v41, v43
    v_mfma_f32_16x16x32_bf16 v[116:119], v[176:179], a[200:203], v[116:119]
    v_exp_f32 v89, v89
    v_cvt_pk_bf16_f32 v82, v84, v85
    v_mfma_f32_16x16x32_bf16 v[124:127], v[176:179], a[204:207], v[124:127]
    ds_read_b128 v[168:171], v1 offset:2048
    ds_read_b128 v[172:175], v1 offset:3072
    v_exp_f32 v90, v90
    v_fma_f32 v245, v245, v41, v43
    v_mfma_f32_16x16x32_bf16 v[100:103], v[180:183], a[208:211], v[100:103]
    v_add_f32 v148, v148, v86
    v_add_f32 v149, v149, v87
    v_cvt_pk_bf16_f32 v83, v86, v87
    v_fma_f32 v246, v246, v41, v43
    v_mfma_f32_16x16x32_bf16 v[108:111], v[180:183], a[212:215], v[108:111]
    v_exp_f32 v91, v91
    v_add_f32 v150, v150, v88
    v_mfma_f32_16x16x32_bf16 v[116:119], v[180:183], a[216:219], v[116:119]
    v_exp_f32 v92, v92
    v_add_f32 v151, v151, v89
    v_fma_f32 v247, v247, v41, v43
    v_mfma_f32_16x16x32_bf16 v[124:127], v[180:183], a[220:223], v[124:127]
    v_exp_f32 v93, v93
    v_cvt_pk_bf16_f32 v88, v88, v89
    v_mfma_f32_16x16x32_bf16 v[100:103], v[184:187], a[224:227], v[100:103]
    v_add_f32 v150, v150, v90
    v_add_f32 v151, v151, v91
    v_cvt_pk_bf16_f32 v89, v90, v91
    v_cvt_pk_bf16_f32 v130, v240, v244
    v_mfma_f32_16x16x32_bf16 v[108:111], v[184:187], a[228:231], v[108:111]
    v_exp_f32 v94, v94
    v_add_f32 v150, v150, v92
    v_mfma_f32_16x16x32_bf16 v[116:119], v[184:187], a[232:235], v[116:119]
    v_exp_f32 v95, v95
    v_add_f32 v151, v151, v93
    v_cvt_pk_bf16_f32 v134, v241, v245
    v_mfma_f32_16x16x32_bf16 v[124:127], v[184:187], a[236:239], v[124:127]
    v_cvt_pk_bf16_f32 v90, v92, v93
    v_add_f32 v150, v150, v94
    v_add_f32 v151, v151, v95
    v_mfma_f32_16x16x32_bf16 v[100:103], v[188:191], a[240:243], v[100:103]
    v_cvt_pk_bf16_f32 v91, v94, v95
    v_cvt_pk_bf16_f32 v138, v242, v246
    v_mfma_f32_16x16x32_bf16 v[108:111], v[188:191], a[244:247], v[108:111]
    v_mfma_f32_16x16x32_bf16 v[116:119], v[188:191], a[248:251], v[116:119]
    v_cvt_pk_bf16_f32 v142, v243, v247
    v_mfma_f32_16x16x32_bf16 v[124:127], v[188:191], a[252:255], v[124:127]
    s_mov_b32 s57, 15
.p2align 6
LOOP_B:
    s_waitcnt vmcnt(8) lgkmcnt(0)
    v_mfma_f32_16x16x32_bf16 a[0:3], v[64:67], v[160:163], a[0:3]
    v_sub_u32 v12, v12, v11
    v_cmp_lt_u32 vcc, 31, v12
    v_mfma_f32_16x16x32_bf16 a[48:51], v[72:75], v[160:163], a[48:51]
    ds_read_b128 v[176:179], v1 offset:4096
    ds_read_b128 v[180:183], v1 offset:5120
    v_mfma_f32_16x16x32_bf16 a[96:99], v[80:83], v[160:163], a[96:99]
    s_cbranch_vccnz SPIN_B
RET_B:
    v_add_u32 v11, 1, v11
    v_mfma_f32_16x16x32_bf16 a[144:147], v[88:91], v[160:163], a[144:147]
    ds_read_b128 v[184:187], v1 offset:6144
    ds_read_b128 v[188:191], v1 offset:7168
    v_mfma_f32_16x16x32_bf16 a[4:7], v[64:67], v[164:167], a[4:7]
    s_add_u32 m0, s21, 49152
    v_lshlrev_b32 v44, 16, v27
    v_mfma_f32_16x16x32_bf16 a[52:55], v[72:75], v[164:167], a[52:55]
    buffer_load_dwordx4 v1, s[8:11], s20 offen offset:0 sc1 lds
    v_and_b32 v45, s62, v27
    v_mfma_f32_16x16x32_bf16 a[100:103], v[80:83], v[164:167], a[100:103]
    v_exp_f32 v96, v96
    v_mfma_f32_16x16x32_bf16 a[148:151], v[88:91], v[164:167], a[148:151]
    v_exp_f32 v97, v97
    v_mfma_f32_16x16x32_bf16 a[8:11], v[64:67], v[168:171], a[8:11]
    v_add_f32 v144, v144, v96
    v_add_f32 v145, v145, v97
    v_mfma_f32_16x16x32_bf16 a[56:59], v[72:75], v[168:171], a[56:59]
    buffer_load_dwordx4 v1, s[8:11], s20 offen offset:1024 sc1 lds
    v_cvt_pk_bf16_f32 v96, v96, v97
    v_mfma_f32_16x16x32_bf16 a[104:107], v[80:83], v[168:171], a[104:107]
    v_exp_f32 v98, v98
    v_mfma_f32_16x16x32_bf16 a[152:155], v[88:91], v[168:171], a[152:155]
    v_add_f32 v144, v144, v98
    v_lshlrev_b32 v46, 16, v31
    v_mfma_f32_16x16x32_bf16 a[12:15], v[64:67], v[172:175], a[12:15]
    v_exp_f32 v99, v99
    v_mfma_f32_16x16x32_bf16 a[60:63], v[72:75], v[172:175], a[60:63]
    buffer_load_dwordx4 v1, s[8:11], s20 offen offset:2048 sc1 lds
    v_add_f32 v145, v145, v99
    v_mfma_f32_16x16x32_bf16 a[108:111], v[80:83], v[172:175], a[108:111]
    v_cvt_pk_bf16_f32 v97, v98, v99
    v_and_b32 v47, s62, v31
    v_mfma_f32_16x16x32_bf16 a[156:159], v[88:91], v[172:175], a[156:159]
    v_mul_f32 v46, -v46, v44
    s_waitcnt vmcnt(22) lgkmcnt(0)
    v_mfma_f32_16x16x32_bf16 a[16:19], v[64:67], v[176:179], a[16:19]
    v_exp_f32 v100, v100
    v_mfma_f32_16x16x32_bf16 a[64:67], v[72:75], v[176:179], a[64:67]
    ds_read_b128 v[160:163], v1 offset:8192
    ds_read_b128 v[164:167], v1 offset:9216
    v_mfma_f32_16x16x32_bf16 a[112:115], v[80:83], v[176:179], a[112:115]
    buffer_load_dwordx4 v1, s[8:11], s20 offen offset:3072 sc1 lds
    v_add_f32 v144, v144, v100
    v_mfma_f32_16x16x32_bf16 a[160:163], v[88:91], v[176:179], a[160:163]
    ds_read_b128 v[168:171], v1 offset:10240
    ds_read_b128 v[172:175], v1 offset:11264
    v_mfma_f32_16x16x32_bf16 a[20:23], v[64:67], v[180:183], a[20:23]
    s_add_u32 m0, s21, 53248
    v_mul_f32 v47, -v47, v45
    v_mfma_f32_16x16x32_bf16 a[68:71], v[72:75], v[180:183], a[68:71]
    buffer_load_dwordx4 v3, s[8:11], s20 offen offset:0 sc1 lds
    v_cvt_f32_i32 v248, v248
    v_mfma_f32_16x16x32_bf16 a[116:119], v[80:83], v[180:183], a[116:119]
    v_cvt_f32_i32 v249, v249
    v_cvt_f32_i32 v250, v250
    v_mfma_f32_16x16x32_bf16 a[164:167], v[88:91], v[180:183], a[164:167]
    v_exp_f32 v101, v101
    v_mfma_f32_16x16x32_bf16 a[24:27], v[64:67], v[184:187], a[24:27]
    v_add_f32 v145, v145, v101
    v_cvt_pk_bf16_f32 v98, v100, v101
    v_mfma_f32_16x16x32_bf16 a[72:75], v[72:75], v[184:187], a[72:75]
    buffer_load_dwordx4 v3, s[8:11], s20 offen offset:1024 sc1 lds
    v_cvt_f32_i32 v251, v251
    v_mfma_f32_16x16x32_bf16 a[120:123], v[80:83], v[184:187], a[120:123]
    s_add_u32 s20, s20, 12288
    v_cvt_f32_i32 v252, v252
    v_mfma_f32_16x16x32_bf16 a[168:171], v[88:91], v[184:187], a[168:171]
    v_exp_f32 v102, v102
    v_mfma_f32_16x16x32_bf16 a[28:31], v[64:67], v[188:191], a[28:31]
    v_add_f32 v144, v144, v102
    v_cvt_f32_i32 v253, v253
    v_mfma_f32_16x16x32_bf16 a[76:79], v[72:75], v[188:191], a[76:79]
    v_exp_f32 v103, v103
    v_mfma_f32_16x16x32_bf16 a[124:127], v[80:83], v[188:191], a[124:127]
    buffer_load_dwordx4 v[240:243], v5, s[24:27], s58 offen offset:0 nt
    v_add_f32 v145, v145, v103
    v_mfma_f32_16x16x32_bf16 a[172:175], v[88:91], v[188:191], a[172:175]
    v_cvt_pk_bf16_f32 v99, v102, v103
    s_waitcnt vmcnt(26) lgkmcnt(0)
    v_mfma_f32_16x16x32_bf16 a[32:35], v[64:67], v[160:163], a[32:35]
    v_cvt_f32_i32 v254, v254
    v_cvt_f32_i32 v255, v255
    v_mfma_f32_16x16x32_bf16 a[80:83], v[72:75], v[160:163], a[80:83]
    ds_read_b128 v[176:179], v1 offset:12288
    ds_read_b128 v[180:183], v1 offset:13312
    v_mfma_f32_16x16x32_bf16 a[128:131], v[80:83], v[160:163], a[128:131]
    buffer_load_dwordx4 v[244:247], v5, s[24:27], s58 offen offset:768 nt
    v_fma_f32 v248, v248, v44, v46
    v_mfma_f32_16x16x32_bf16 a[176:179], v[88:91], v[160:163], a[176:179]
    ds_read_b128 v[184:187], v1 offset:14336
    ds_read_b128 v[188:191], v1 offset:15360
    v_mfma_f32_16x16x32_bf16 a[36:39], v[64:67], v[164:167], a[36:39]
    v_exp_f32 v104, v104
    v_mfma_f32_16x16x32_bf16 a[84:87], v[72:75], v[164:167], a[84:87]
    v_exp_f32 v105, v105
    v_mfma_f32_16x16x32_bf16 a[132:135], v[80:83], v[164:167], a[132:135]
    v_add_f32 v146, v146, v104
    v_add_f32 v147, v147, v105
    v_mfma_f32_16x16x32_bf16 a[180:183], v[88:91], v[164:167], a[180:183]
    v_exp_f32 v106, v106
    v_mfma_f32_16x16x32_bf16 a[40:43], v[64:67], v[168:171], a[40:43]
    v_cvt_pk_bf16_f32 v104, v104, v105
    v_add_f32 v146, v146, v106
    v_mfma_f32_16x16x32_bf16 a[88:91], v[72:75], v[168:171], a[88:91]
    v_exp_f32 v107, v107
    v_mfma_f32_16x16x32_bf16 a[136:139], v[80:83], v[168:171], a[136:139]
    v_add_f32 v147, v147, v107
    v_cvt_pk_bf16_f32 v105, v106, v107
    v_mfma_f32_16x16x32_bf16 a[184:187], v[88:91], v[168:171], a[184:187]
    v_exp_f32 v108, v108
    v_mfma_f32_16x16x32_bf16 a[44:47], v[64:67], v[172:175], a[44:47]
    v_add_f32 v146, v146, v108
    v_fma_f32 v249, v249, v44, v46
    v_mfma_f32_16x16x32_bf16 a[92:95], v[72:75], v[172:175], a[92:95]
    v_exp_f32 v109, v109
    v_mfma_f32_16x16x32_bf16 a[140:143], v[80:83], v[172:175], a[140:143]
    v_add_f32 v147, v147, v109
    v_cvt_pk_bf16_f32 v106, v108, v109
    v_mfma_f32_16x16x32_bf16 a[188:191], v[88:91], v[172:175], a[188:191]
    v_fma_f32 v250, v250, v44, v46
    s_waitcnt lgkmcnt(0)
    v_mfma_f32_16x16x32_bf16 v[64:67], v[176:179], v[192:195], 0
    v_exp_f32 v110, v110
    v_mfma_f32_16x16x32_bf16 v[72:75], v[176:179], v[196:199], 0
    ds_read_b128 v[160:163], v1 offset:16384
    ds_read_b128 v[164:167], v1 offset:17408
    v_mfma_f32_16x16x32_bf16 v[80:83], v[176:179], v[200:203], 0
    v_add_f32 v146, v146, v110
    v_fma_f32 v251, v251, v44, v46
    v_mfma_f32_16x16x32_bf16 v[88:91], v[176:179], v[204:207], 0
    ds_read_b128 v[168:171], v1 offset:18432
    ds_read_b128 v[172:175], v1 offset:19456
    v_mfma_f32_16x16x32_bf16 v[64:67], v[180:183], v[208:211], v[64:67]
    v_exp_f32 v111, v111
    v_mfma_f32_16x16x32_bf16 v[72:75], v[180:183], v[212:215], v[72:75]
    v_add_f32 v147, v147, v111
    v_cvt_pk_bf16_f32 v107, v110, v111
    v_mfma_f32_16x16x32_bf16 v[80:83], v[180:183], v[216:219], v[80:83]
    v_exp_f32 v112, v112
    v_mfma_f32_16x16x32_bf16 v[88:91], v[180:183], v[220:223], v[88:91]
    v_exp_f32 v113, v113
    v_mfma_f32_16x16x32_bf16 v[64:67], v[184:187], a[192:195], v[64:67]
    v_add_f32 v148, v148, v112
    v_add_f32 v149, v149, v113
    v_mfma_f32_16x16x32_bf16 v[72:75], v[184:187], a[196:199], v[72:75]
    v_exp_f32 v114, v114
    v_mfma_f32_16x16x32_bf16 v[80:83], v[184:187], a[200:203], v[80:83]
    v_cvt_pk_bf16_f32 v112, v112, v113
    v_add_f32 v148, v148, v114
    v_mfma_f32_16x16x32_bf16 v[88:91], v[184:187], a[204:207], v[88:91]
    v_exp_f32 v115, v115
    v_mfma_f32_16x16x32_bf16 v[64:67], v[188:191], a[208:211], v[64:67]
    v_add_f32 v149, v149, v115
    v_cvt_pk_bf16_f32 v113, v114, v115
    v_mfma_f32_16x16x32_bf16 v[72:75], v[188:191], a[212:215], v[72:75]
    v_exp_f32 v116, v116
    v_mfma_f32_16x16x32_bf16 v[80:83], v[188:191], a[216:219], v[80:83]
    v_add_f32 v148, v148, v116
    v_fma_f32 v252, v252, v45, v47
    v_mfma_f32_16x16x32_bf16 v[88:91], v[188:191], a[220:223], v[88:91]
    v_fma_f32 v253, v253, v45, v47
    s_waitcnt lgkmcnt(0)
    v_mfma_f32_16x16x32_bf16 v[64:67], v[160:163], a[224:227], v[64:67]
    v_exp_f32 v117, v117
    v_mfma_f32_16x16x32_bf16 v[72:75], v[160:163], a[228:231], v[72:75]
    ds_read_b128 v[176:179], v1 offset:20480
    ds_read_b128 v[180:183], v1 offset:21504
    v_mfma_f32_16x16x32_bf16 v[80:83], v[160:163], a[232:235], v[80:83]
    v_add_f32 v149, v149, v117
    v_cvt_pk_bf16_f32 v114, v116, v117
    v_mfma_f32_16x16x32_bf16 v[88:91], v[160:163], a[236:239], v[88:91]
    ds_read_b128 v[184:187], v1 offset:22528
    ds_read_b128 v[188:191], v1 offset:23552
    v_mfma_f32_16x16x32_bf16 v[64:67], v[164:167], a[240:243], v[64:67]
    v_exp_f32 v118, v118
    v_mfma_f32_16x16x32_bf16 v[72:75], v[164:167], a[244:247], v[72:75]
    v_add_f32 v148, v148, v118
    v_fma_f32 v254, v254, v45, v47
    v_mfma_f32_16x16x32_bf16 v[80:83], v[164:167], a[248:251], v[80:83]
    v_exp_f32 v119, v119
    v_mfma_f32_16x16x32_bf16 v[88:91], v[164:167], a[252:255], v[88:91]
    v_add_f32 v149, v149, v119
    v_cvt_pk_bf16_f32 v115, v118, v119
    v_mfma_f32_16x16x32_bf16 v[68:71], v[168:171], v[192:195], 0
    v_exp_f32 v120, v120
    v_mfma_f32_16x16x32_bf16 v[76:79], v[168:171], v[196:199], 0
    v_exp_f32 v121, v121
    v_mfma_f32_16x16x32_bf16 v[84:87], v[168:171], v[200:203], 0
    v_add_f32 v150, v150, v120
    v_add_f32 v151, v151, v121
    v_mfma_f32_16x16x32_bf16 v[92:95], v[168:171], v[204:207], 0
    v_exp_f32 v122, v122
    v_mfma_f32_16x16x32_bf16 v[68:71], v[172:175], v[208:211], v[68:71]
    v_cvt_pk_bf16_f32 v120, v120, v121
    v_add_f32 v150, v150, v122
    v_mfma_f32_16x16x32_bf16 v[76:79], v[172:175], v[212:215], v[76:79]
    v_exp_f32 v123, v123
    v_mfma_f32_16x16x32_bf16 v[84:87], v[172:175], v[216:219], v[84:87]
    v_add_f32 v151, v151, v123
    v_cvt_pk_bf16_f32 v121, v122, v123
    v_mfma_f32_16x16x32_bf16 v[92:95], v[172:175], v[220:223], v[92:95]
    s_waitcnt vmcnt(10) lgkmcnt(0)
    s_barrier
    v_mfma_f32_16x16x32_bf16 v[68:71], v[176:179], a[192:195], v[68:71]
    v_exp_f32 v124, v124
    v_mfma_f32_16x16x32_bf16 v[76:79], v[176:179], a[196:199], v[76:79]
    ds_read_b128 v[160:163], v1 offset:24576
    ds_read_b128 v[164:167], v1 offset:25600
    v_mfma_f32_16x16x32_bf16 v[84:87], v[176:179], a[200:203], v[84:87]
    v_add_f32 v150, v150, v124
    v_fma_f32 v255, v255, v45, v47
    v_mfma_f32_16x16x32_bf16 v[92:95], v[176:179], a[204:207], v[92:95]
    ds_read_b128 v[168:171], v1 offset:26624
    ds_read_b128 v[172:175], v1 offset:27648
    v_mfma_f32_16x16x32_bf16 v[68:71], v[180:183], a[208:211], v[68:71]
    v_exp_f32 v125, v125
    v_mfma_f32_16x16x32_bf16 v[76:79], v[180:183], a[212:215], v[76:79]
    v_add_f32 v151, v151, v125
    v_cvt_pk_bf16_f32 v122, v124, v125
    v_mfma_f32_16x16x32_bf16 v[84:87], v[180:183], a[216:219], v[84:87]
    v_exp_f32 v126, v126
    v_mfma_f32_16x16x32_bf16 v[92:95], v[180:183], a[220:223], v[92:95]
    v_add_f32 v150, v150, v126
    v_cvt_pk_bf16_f32 v131, v248, v252
    v_mfma_f32_16x16x32_bf16 v[68:71], v[184:187], a[224:227], v[68:71]
    v_exp_f32 v127, v127
    v_mfma_f32_16x16x32_bf16 v[76:79], v[184:187], a[228:231], v[76:79]
    v_add_f32 v151, v151, v127
    v_cvt_pk_bf16_f32 v123, v126, v127
    v_mfma_f32_16x16x32_bf16 v[84:87], v[184:187], a[232:235], v[84:87]
    v_cvt_pk_bf16_f32 v135, v249, v253
    v_cvt_pk_bf16_f32 v139, v250, v254
    v_mfma_f32_16x16x32_bf16 v[92:95], v[184:187], a[236:239], v[92:95]
    v_cvt_pk_bf16_f32 v143, v251, v255
    buffer_store_dwordx4 v[128:131], v1, s[36:39], s60 offen offset:0 sc1
    v_mfma_f32_16x16x32_bf16 v[68:71], v[188:191], a[240:243], v[68:71]
    buffer_store_dwordx4 v[132:135], v1, s[36:39], s60 offen offset:1024 sc1
    buffer_store_dwordx4 v[136:139], v1, s[36:39], s60 offen offset:2048 sc1
    v_mfma_f32_16x16x32_bf16 v[76:79], v[188:191], a[244:247], v[76:79]
    buffer_store_dwordx4 v[140:143], v1, s[36:39], s60 offen offset:3072 sc1
    buffer_load_dwordx2 v[26:27], v8, s[28:31], s59 offen offset:8
    v_mfma_f32_16x16x32_bf16 v[84:87], v[188:191], a[248:251], v[84:87]
    buffer_load_dwordx2 v[30:31], v8, s[32:35], s59 offen offset:8
    s_add_u32 s59, s59, 256
    v_mfma_f32_16x16x32_bf16 v[92:95], v[188:191], a[252:255], v[92:95]
    s_add_u32 s60, s60, 49152
    s_waitcnt vmcnt(23) lgkmcnt(0)
    v_mfma_f32_16x16x32_bf16 a[0:3], v[96:99], v[160:163], a[0:3]
    v_exp_f32 v64, v64
    v_mfma_f32_16x16x32_bf16 a[48:51], v[104:107], v[160:163], a[48:51]
    ds_read_b128 v[176:179], v1 offset:28672
    ds_read_b128 v[180:183], v1 offset:29696
    v_mfma_f32_16x16x32_bf16 a[96:99], v[112:115], v[160:163], a[96:99]
    v_exp_f32 v65, v65
    v_mfma_f32_16x16x32_bf16 a[144:147], v[120:123], v[160:163], a[144:147]
    ds_read_b128 v[184:187], v1 offset:30720
    ds_read_b128 v[188:191], v1 offset:31744
    v_mfma_f32_16x16x32_bf16 a[4:7], v[96:99], v[164:167], a[4:7]
    s_add_u32 m0, s21, 73728
    v_add_f32 v144, v144, v64
    v_mfma_f32_16x16x32_bf16 a[52:55], v[104:107], v[164:167], a[52:55]
    buffer_load_dwordx4 v1, s[8:11], s20 offen offset:0 sc1 lds
    v_add_f32 v145, v145, v65
    v_mfma_f32_16x16x32_bf16 a[100:103], v[112:115], v[164:167], a[100:103]
    v_cvt_pk_bf16_f32 v64, v64, v65
    v_lshlrev_b32 v40, 16, v24
    v_mfma_f32_16x16x32_bf16 a[148:151], v[120:123], v[164:167], a[148:151]
    v_exp_f32 v66, v66
    v_mfma_f32_16x16x32_bf16 a[8:11], v[96:99], v[168:171], a[8:11]
    v_add_f32 v144, v144, v66
    v_and_b32 v41, s62, v24
    v_mfma_f32_16x16x32_bf16 a[56:59], v[104:107], v[168:171], a[56:59]
    buffer_load_dwordx4 v1, s[8:11], s20 offen offset:1024 sc1 lds
    v_lshlrev_b32 v42, 16, v28
    v_mfma_f32_16x16x32_bf16 a[104:107], v[112:115], v[168:171], a[104:107]
    v_exp_f32 v67, v67
    v_mfma_f32_16x16x32_bf16 a[152:155], v[120:123], v[168:171], a[152:155]
    v_add_f32 v145, v145, v67
    v_cvt_pk_bf16_f32 v65, v66, v67
    v_mfma_f32_16x16x32_bf16 a[12:15], v[96:99], v[172:175], a[12:15]
    v_exp_f32 v68, v68
    v_mfma_f32_16x16x32_bf16 a[60:63], v[104:107], v[172:175], a[60:63]
    buffer_load_dwordx4 v1, s[8:11], s20 offen offset:2048 sc1 lds
    v_add_f32 v144, v144, v68
    v_mfma_f32_16x16x32_bf16 a[108:111], v[112:115], v[172:175], a[108:111]
    v_and_b32 v43, s62, v28
    v_mul_f32 v42, -v42, v40
    v_mfma_f32_16x16x32_bf16 a[156:159], v[120:123], v[172:175], a[156:159]
    v_mul_f32 v43, -v43, v41
    s_waitcnt vmcnt(26) lgkmcnt(0)
    v_mfma_f32_16x16x32_bf16 a[16:19], v[96:99], v[176:179], a[16:19]
    v_exp_f32 v69, v69
    v_mfma_f32_16x16x32_bf16 a[64:67], v[104:107], v[176:179], a[64:67]
    ds_read_b128 v[160:163], v1 offset:32768
    ds_read_b128 v[164:167], v1 offset:33792
    v_mfma_f32_16x16x32_bf16 a[112:115], v[112:115], v[176:179], a[112:115]
    buffer_load_dwordx4 v1, s[8:11], s20 offen offset:3072 sc1 lds
    v_add_f32 v145, v145, v69
    v_mfma_f32_16x16x32_bf16 a[160:163], v[120:123], v[176:179], a[160:163]
    ds_read_b128 v[168:171], v1 offset:34816
    ds_read_b128 v[172:175], v1 offset:35840
    v_mfma_f32_16x16x32_bf16 a[20:23], v[96:99], v[180:183], a[20:23]
    s_add_u32 m0, s21, 77824
    v_cvt_pk_bf16_f32 v66, v68, v69
    v_mfma_f32_16x16x32_bf16 a[68:71], v[104:107], v[180:183], a[68:71]
    buffer_load_dwordx4 v3, s[8:11], s20 offen offset:0 sc1 lds
    v_cvt_f32_i32 v224, v224
    v_mfma_f32_16x16x32_bf16 a[116:119], v[112:115], v[180:183], a[116:119]
    v_cvt_f32_i32 v225, v225
    v_cvt_f32_i32 v226, v226
    v_mfma_f32_16x16x32_bf16 a[164:167], v[120:123], v[180:183], a[164:167]
    v_exp_f32 v70, v70
    v_mfma_f32_16x16x32_bf16 a[24:27], v[96:99], v[184:187], a[24:27]
    v_add_f32 v144, v144, v70
    v_cvt_f32_i32 v227, v227
    v_mfma_f32_16x16x32_bf16 a[72:75], v[104:107], v[184:187], a[72:75]
    buffer_load_dwordx4 v3, s[8:11], s20 offen offset:1024 sc1 lds
    v_cvt_f32_i32 v228, v228
    v_mfma_f32_16x16x32_bf16 a[120:123], v[112:115], v[184:187], a[120:123]
    s_add_u32 s20, s20, 12288
    v_cvt_f32_i32 v229, v229
    v_mfma_f32_16x16x32_bf16 a[168:171], v[120:123], v[184:187], a[168:171]
    v_exp_f32 v71, v71
    v_mfma_f32_16x16x32_bf16 a[28:31], v[96:99], v[188:191], a[28:31]
    v_add_f32 v145, v145, v71
    v_cvt_pk_bf16_f32 v67, v70, v71
    v_mfma_f32_16x16x32_bf16 a[76:79], v[104:107], v[188:191], a[76:79]
    v_exp_f32 v72, v72
    v_mfma_f32_16x16x32_bf16 a[124:127], v[112:115], v[188:191], a[124:127]
    buffer_load_dwordx4 v[248:251], v5, s[24:27], s58 offen offset:1536 nt
    v_add_f32 v146, v146, v72
    v_mfma_f32_16x16x32_bf16 a[172:175], v[120:123], v[188:191], a[172:175]
    v_cvt_f32_i32 v230, v230
    s_waitcnt vmcnt(30) lgkmcnt(0)
    v_mfma_f32_16x16x32_bf16 a[32:35], v[96:99], v[160:163], a[32:35]
    v_cvt_f32_i32 v231, v231
    v_fma_f32 v224, v224, v40, v42
    v_mfma_f32_16x16x32_bf16 a[80:83], v[104:107], v[160:163], a[80:83]
    ds_read_b128 v[176:179], v1 offset:36864
    ds_read_b128 v[180:183], v1 offset:37888
    v_mfma_f32_16x16x32_bf16 a[128:131], v[112:115], v[160:163], a[128:131]
    buffer_load_dwordx4 v[252:255], v5, s[24:27], s58 offen offset:2304 nt
    s_add_u32 s58, s58, 98304
    v_mfma_f32_16x16x32_bf16 a[176:179], v[120:123], v[160:163], a[176:179]
    ds_read_b128 v[184:187], v1 offset:38912
    ds_read_b128 v[188:191], v1 offset:39936
    v_mfma_f32_16x16x32_bf16 a[36:39], v[96:99], v[164:167], a[36:39]
    v_exp_f32 v73, v73
    v_mfma_f32_16x16x32_bf16 a[84:87], v[104:107], v[164:167], a[84:87]
    v_add_f32 v147, v147, v73
    v_cvt_pk_bf16_f32 v72, v72, v73
    v_mfma_f32_16x16x32_bf16 a[132:135], v[112:115], v[164:167], a[132:135]
    v_exp_f32 v74, v74
    v_mfma_f32_16x16x32_bf16 a[180:183], v[120:123], v[164:167], a[180:183]
    v_exp_f32 v75, v75
    v_mfma_f32_16x16x32_bf16 a[40:43], v[96:99], v[168:171], a[40:43]
    v_add_f32 v146, v146, v74
    v_add_f32 v147, v147, v75
    v_mfma_f32_16x16x32_bf16 a[88:91], v[104:107], v[168:171], a[88:91]
    v_exp_f32 v76, v76
    v_mfma_f32_16x16x32_bf16 a[136:139], v[112:115], v[168:171], a[136:139]
    v_cvt_pk_bf16_f32 v73, v74, v75
    v_add_f32 v146, v146, v76
    v_mfma_f32_16x16x32_bf16 a[184:187], v[120:123], v[168:171], a[184:187]
    v_exp_f32 v77, v77
    v_mfma_f32_16x16x32_bf16 a[44:47], v[96:99], v[172:175], a[44:47]
    v_add_f32 v147, v147, v77
    v_cvt_pk_bf16_f32 v74, v76, v77
    v_mfma_f32_16x16x32_bf16 a[92:95], v[104:107], v[172:175], a[92:95]
    v_exp_f32 v78, v78
    v_mfma_f32_16x16x32_bf16 a[140:143], v[112:115], v[172:175], a[140:143]
    v_add_f32 v146, v146, v78
    v_fma_f32 v225, v225, v40, v42
    v_mfma_f32_16x16x32_bf16 a[188:191], v[120:123], v[172:175], a[188:191]
    v_fma_f32 v226, v226, v40, v42
    s_waitcnt lgkmcnt(0)
    v_mfma_f32_16x16x32_bf16 v[96:99], v[176:179], v[192:195], 0
    v_exp_f32 v79, v79
    v_mfma_f32_16x16x32_bf16 v[104:107], v[176:179], v[196:199], 0
    ds_read_b128 v[160:163], v1 offset:40960
    ds_read_b128 v[164:167], v1 offset:41984
    v_mfma_f32_16x16x32_bf16 v[112:115], v[176:179], v[200:203], 0
    v_add_f32 v147, v147, v79
    v_cvt_pk_bf16_f32 v75, v78, v79
    v_mfma_f32_16x16x32_bf16 v[120:123], v[176:179], v[204:207], 0
    ds_read_b128 v[168:171], v1 offset:43008
    ds_read_b128 v[172:175], v1 offset:44032
    v_mfma_f32_16x16x32_bf16 v[96:99], v[180:183], v[208:211], v[96:99]
    v_exp_f32 v80, v80
    v_mfma_f32_16x16x32_bf16 v[104:107], v[180:183], v[212:215], v[104:107]
    v_add_f32 v148, v148, v80
    v_fma_f32 v227, v227, v40, v42
    v_mfma_f32_16x16x32_bf16 v[112:115], v[180:183], v[216:219], v[112:115]
    v_exp_f32 v81, v81
    v_mfma_f32_16x16x32_bf16 v[120:123], v[180:183], v[220:223], v[120:123]
    v_add_f32 v149, v149, v81
    v_cvt_pk_bf16_f32 v80, v80, v81
    v_mfma_f32_16x16x32_bf16 v[96:99], v[184:187], a[192:195], v[96:99]
    v_exp_f32 v82, v82
    v_mfma_f32_16x16x32_bf16 v[104:107], v[184:187], a[196:199], v[104:107]
    v_add_f32 v148, v148, v82
    v_fma_f32 v228, v228, v41, v43
    v_mfma_f32_16x16x32_bf16 v[112:115], v[184:187], a[200:203], v[112:115]
    v_exp_f32 v83, v83
    v_mfma_f32_16x16x32_bf16 v[120:123], v[184:187], a[204:207], v[120:123]
    v_add_f32 v149, v149, v83
    v_cvt_pk_bf16_f32 v81, v82, v83
    v_mfma_f32_16x16x32_bf16 v[96:99], v[188:191], a[208:211], v[96:99]
    v_exp_f32 v84, v84
    v_mfma_f32_16x16x32_bf16 v[104:107], v[188:191], a[212:215], v[104:107]
    v_add_f32 v148, v148, v84
    v_fma_f32 v229, v229, v41, v43
    v_mfma_f32_16x16x32_bf16 v[112:115], v[188:191], a[216:219], v[112:115]
    v_exp_f32 v85, v85
    v_mfma_f32_16x16x32_bf16 v[120:123], v[188:191], a[220:223], v[120:123]
    v_add_f32 v149, v149, v85
    s_waitcnt lgkmcnt(0)
    v_mfma_f32_16x16x32_bf16 v[96:99], v[160:163], a[224:227], v[96:99]
    v_exp_f32 v86, v86
    v_mfma_f32_16x16x32_bf16 v[104:107], v[160:163], a[228:231], v[104:107]
    ds_read_b128 v[176:179], v1 offset:45056
    ds_read_b128 v[180:183], v1 offset:46080
    v_mfma_f32_16x16x32_bf16 v[112:115], v[160:163], a[232:235], v[112:115]
    v_cvt_pk_bf16_f32 v82, v84, v85
    v_add_f32 v148, v148, v86
    v_mfma_f32_16x16x32_bf16 v[120:123], v[160:163], a[236:239], v[120:123]
    ds_read_b128 v[184:187], v1 offset:47104
    ds_read_b128 v[188:191], v1 offset:48128
    v_mfma_f32_16x16x32_bf16 v[96:99], v[164:167], a[240:243], v[96:99]
    v_exp_f32 v87, v87
    v_mfma_f32_16x16x32_bf16 v[104:107], v[164:167], a[244:247], v[104:107]
    v_add_f32 v149, v149, v87
    v_cvt_pk_bf16_f32 v83, v86, v87
    v_mfma_f32_16x16x32_bf16 v[112:115], v[164:167], a[248:251], v[112:115]
    v_exp_f32 v88, v88
    v_mfma_f32_16x16x32_bf16 v[120:123], v[164:167], a[252:255], v[120:123]
    v_add_f32 v150, v150, v88
    v_fma_f32 v230, v230, v41, v43
    v_mfma_f32_16x16x32_bf16 v[100:103], v[168:171], v[192:195], 0
    v_exp_f32 v89, v89
    v_mfma_f32_16x16x32_bf16 v[108:111], v[168:171], v[196:199], 0
    v_add_f32 v151, v151, v89
    v_cvt_pk_bf16_f32 v88, v88, v89
    v_mfma_f32_16x16x32_bf16 v[116:119], v[168:171], v[200:203], 0
    v_exp_f32 v90, v90
    v_mfma_f32_16x16x32_bf16 v[124:127], v[168:171], v[204:207], 0
    v_add_f32 v150, v150, v90
    v_fma_f32 v231, v231, v41, v43
    v_mfma_f32_16x16x32_bf16 v[100:103], v[172:175], v[208:211], v[100:103]
    v_exp_f32 v91, v91
    v_mfma_f32_16x16x32_bf16 v[108:111], v[172:175], v[212:215], v[108:111]
    v_add_f32 v151, v151, v91
    v_cvt_pk_bf16_f32 v89, v90, v91
    v_mfma_f32_16x16x32_bf16 v[116:119], v[172:175], v[216:219], v[116:119]
    v_exp_f32 v92, v92
    v_mfma_f32_16x16x32_bf16 v[124:127], v[172:175], v[220:223], v[124:127]
    s_waitcnt vmcnt(10) lgkmcnt(0)
    s_barrier
    v_mfma_f32_16x16x32_bf16 v[100:103], v[176:179], a[192:195], v[100:103]
    buffer_store_dword v10, v9, s[40:43], 0 offen
    v_add_u32 v10, 1, v10
    v_mfma_f32_16x16x32_bf16 v[108:111], v[176:179], a[196:199], v[108:111]
    ds_read_b128 v[160:163], v2 offset:0
    ds_read_b128 v[164:167], v2 offset:1024
    v_mfma_f32_16x16x32_bf16 v[116:119], v[176:179], a[200:203], v[116:119]
    v_add_f32 v150, v150, v92
    v_cvt_pk_bf16_f32 v128, v224, v228
    v_mfma_f32_16x16x32_bf16 v[124:127], v[176:179], a[204:207], v[124:127]
    ds_read_b128 v[168:171], v2 offset:2048
    ds_read_b128 v[172:175], v2 offset:3072
    v_mfma_f32_16x16x32_bf16 v[100:103], v[180:183], a[208:211], v[100:103]
    v_exp_f32 v93, v93
    v_mfma_f32_16x16x32_bf16 v[108:111], v[180:183], a[212:215], v[108:111]
    v_add_f32 v151, v151, v93
    v_cvt_pk_bf16_f32 v90, v92, v93
    v_mfma_f32_16x16x32_bf16 v[116:119], v[180:183], a[216:219], v[116:119]
    v_exp_f32 v94, v94
    v_mfma_f32_16x16x32_bf16 v[124:127], v[180:183], a[220:223], v[124:127]
    v_add_f32 v150, v150, v94
    v_cvt_pk_bf16_f32 v132, v225, v229
    v_mfma_f32_16x16x32_bf16 v[100:103], v[184:187], a[224:227], v[100:103]
    v_exp_f32 v95, v95
    v_mfma_f32_16x16x32_bf16 v[108:111], v[184:187], a[228:231], v[108:111]
    v_add_f32 v151, v151, v95
    v_cvt_pk_bf16_f32 v91, v94, v95
    v_mfma_f32_16x16x32_bf16 v[116:119], v[184:187], a[232:235], v[116:119]
    v_cvt_pk_bf16_f32 v136, v226, v230
    v_cvt_pk_bf16_f32 v140, v227, v231
    v_mfma_f32_16x16x32_bf16 v[124:127], v[184:187], a[236:239], v[124:127]
    v_mfma_f32_16x16x32_bf16 v[100:103], v[188:191], a[240:243], v[100:103]
    v_mfma_f32_16x16x32_bf16 v[108:111], v[188:191], a[244:247], v[108:111]
    v_mfma_f32_16x16x32_bf16 v[116:119], v[188:191], a[248:251], v[116:119]
    v_mfma_f32_16x16x32_bf16 v[124:127], v[188:191], a[252:255], v[124:127]
    s_waitcnt vmcnt(32) lgkmcnt(0)
    v_mfma_f32_16x16x32_bf16 a[0:3], v[64:67], v[160:163], a[0:3]
    v_exp_f32 v96, v96
    v_mfma_f32_16x16x32_bf16 a[48:51], v[72:75], v[160:163], a[48:51]
    ds_read_b128 v[176:179], v2 offset:4096
    ds_read_b128 v[180:183], v2 offset:5120
    v_mfma_f32_16x16x32_bf16 a[96:99], v[80:83], v[160:163], a[96:99]
    v_exp_f32 v97, v97
    v_mfma_f32_16x16x32_bf16 a[144:147], v[88:91], v[160:163], a[144:147]
    ds_read_b128 v[184:187], v2 offset:6144
    ds_read_b128 v[188:191], v2 offset:7168
    v_mfma_f32_16x16x32_bf16 a[4:7], v[64:67], v[164:167], a[4:7]
    s_add_u32 m0, s21, 0
    v_add_f32 v144, v144, v96
    v_mfma_f32_16x16x32_bf16 a[52:55], v[72:75], v[164:167], a[52:55]
    buffer_load_dwordx4 v1, s[8:11], s20 offen offset:0 sc1 lds
    v_add_f32 v145, v145, v97
    v_mfma_f32_16x16x32_bf16 a[100:103], v[80:83], v[164:167], a[100:103]
    v_cvt_pk_bf16_f32 v96, v96, v97
    v_lshlrev_b32 v44, 16, v25
    v_mfma_f32_16x16x32_bf16 a[148:151], v[88:91], v[164:167], a[148:151]
    v_exp_f32 v98, v98
    v_mfma_f32_16x16x32_bf16 a[8:11], v[64:67], v[168:171], a[8:11]
    v_add_f32 v144, v144, v98
    v_and_b32 v45, s62, v25
    v_mfma_f32_16x16x32_bf16 a[56:59], v[72:75], v[168:171], a[56:59]
    buffer_load_dwordx4 v1, s[8:11], s20 offen offset:1024 sc1 lds
    v_lshlrev_b32 v46, 16, v29
    v_mfma_f32_16x16x32_bf16 a[104:107], v[80:83], v[168:171], a[104:107]
    v_exp_f32 v99, v99
    v_mfma_f32_16x16x32_bf16 a[152:155], v[88:91], v[168:171], a[152:155]
    v_add_f32 v145, v145, v99
    v_cvt_pk_bf16_f32 v97, v98, v99
    v_mfma_f32_16x16x32_bf16 a[12:15], v[64:67], v[172:175], a[12:15]
    v_exp_f32 v100, v100
    v_mfma_f32_16x16x32_bf16 a[60:63], v[72:75], v[172:175], a[60:63]
    buffer_load_dwordx4 v1, s[8:11], s20 offen offset:2048 sc1 lds
    v_add_f32 v144, v144, v100
    v_mfma_f32_16x16x32_bf16 a[108:111], v[80:83], v[172:175], a[108:111]
    v_and_b32 v47, s62, v29
    v_mul_f32 v46, -v46, v44
    v_mfma_f32_16x16x32_bf16 a[156:159], v[88:91], v[172:175], a[156:159]
    v_mul_f32 v47, -v47, v45
    s_waitcnt vmcnt(26) lgkmcnt(0)
    v_mfma_f32_16x16x32_bf16 a[16:19], v[64:67], v[176:179], a[16:19]
    v_exp_f32 v101, v101
    v_mfma_f32_16x16x32_bf16 a[64:67], v[72:75], v[176:179], a[64:67]
    ds_read_b128 v[160:163], v2 offset:8192
    ds_read_b128 v[164:167], v2 offset:9216
    v_mfma_f32_16x16x32_bf16 a[112:115], v[80:83], v[176:179], a[112:115]
    buffer_load_dwordx4 v1, s[8:11], s20 offen offset:3072 sc1 lds
    v_add_f32 v145, v145, v101
    v_mfma_f32_16x16x32_bf16 a[160:163], v[88:91], v[176:179], a[160:163]
    ds_read_b128 v[168:171], v2 offset:10240
    ds_read_b128 v[172:175], v2 offset:11264
    v_mfma_f32_16x16x32_bf16 a[20:23], v[64:67], v[180:183], a[20:23]
    s_add_u32 m0, s21, 4096
    v_cvt_pk_bf16_f32 v98, v100, v101
    v_mfma_f32_16x16x32_bf16 a[68:71], v[72:75], v[180:183], a[68:71]
    buffer_load_dwordx4 v3, s[8:11], s20 offen offset:0 sc1 lds
    v_cvt_f32_i32 v232, v232
    v_mfma_f32_16x16x32_bf16 a[116:119], v[80:83], v[180:183], a[116:119]
    v_cvt_f32_i32 v233, v233
    v_cvt_f32_i32 v234, v234
    v_mfma_f32_16x16x32_bf16 a[164:167], v[88:91], v[180:183], a[164:167]
    v_exp_f32 v102, v102
    v_mfma_f32_16x16x32_bf16 a[24:27], v[64:67], v[184:187], a[24:27]
    v_add_f32 v144, v144, v102
    v_cvt_f32_i32 v235, v235
    v_mfma_f32_16x16x32_bf16 a[72:75], v[72:75], v[184:187], a[72:75]
    buffer_load_dwordx4 v3, s[8:11], s20 offen offset:1024 sc1 lds
    v_cvt_f32_i32 v236, v236
    v_mfma_f32_16x16x32_bf16 a[120:123], v[80:83], v[184:187], a[120:123]
    s_add_u32 s20, s20, 12288
    v_cvt_f32_i32 v237, v237
    v_mfma_f32_16x16x32_bf16 a[168:171], v[88:91], v[184:187], a[168:171]
    v_exp_f32 v103, v103
    v_mfma_f32_16x16x32_bf16 a[28:31], v[64:67], v[188:191], a[28:31]
    v_add_f32 v145, v145, v103
    v_cvt_pk_bf16_f32 v99, v102, v103
    v_mfma_f32_16x16x32_bf16 a[76:79], v[72:75], v[188:191], a[76:79]
    v_exp_f32 v104, v104
    v_mfma_f32_16x16x32_bf16 a[124:127], v[80:83], v[188:191], a[124:127]
    buffer_load_dwordx4 v[224:227], v4, s[24:27], s58 offen offset:0 nt
    v_add_f32 v146, v146, v104
    v_mfma_f32_16x16x32_bf16 a[172:175], v[88:91], v[188:191], a[172:175]
    v_cvt_f32_i32 v238, v238
    s_waitcnt vmcnt(30) lgkmcnt(0)
    v_mfma_f32_16x16x32_bf16 a[32:35], v[64:67], v[160:163], a[32:35]
    v_cvt_f32_i32 v239, v239
    v_fma_f32 v232, v232, v44, v46
    v_mfma_f32_16x16x32_bf16 a[80:83], v[72:75], v[160:163], a[80:83]
    ds_read_b128 v[176:179], v2 offset:12288
    ds_read_b128 v[180:183], v2 offset:13312
    v_mfma_f32_16x16x32_bf16 a[128:131], v[80:83], v[160:163], a[128:131]
    buffer_load_dwordx4 v[228:231], v4, s[24:27], s58 offen offset:768 nt
    v_fma_f32 v233, v233, v44, v46
    v_mfma_f32_16x16x32_bf16 a[176:179], v[88:91], v[160:163], a[176:179]
    ds_read_b128 v[184:187], v2 offset:14336
    ds_read_b128 v[188:191], v2 offset:15360
    v_mfma_f32_16x16x32_bf16 a[36:39], v[64:67], v[164:167], a[36:39]
    v_exp_f32 v105, v105
    v_mfma_f32_16x16x32_bf16 a[84:87], v[72:75], v[164:167], a[84:87]
    v_add_f32 v147, v147, v105
    v_cvt_pk_bf16_f32 v104, v104, v105
    v_mfma_f32_16x16x32_bf16 a[132:135], v[80:83], v[164:167], a[132:135]
    v_exp_f32 v106, v106
    v_mfma_f32_16x16x32_bf16 a[180:183], v[88:91], v[164:167], a[180:183]
    v_add_f32 v146, v146, v106
    v_fma_f32 v234, v234, v44, v46
    v_mfma_f32_16x16x32_bf16 a[40:43], v[64:67], v[168:171], a[40:43]
    v_exp_f32 v107, v107
    v_mfma_f32_16x16x32_bf16 a[88:91], v[72:75], v[168:171], a[88:91]
    v_add_f32 v147, v147, v107
    v_cvt_pk_bf16_f32 v105, v106, v107
    v_mfma_f32_16x16x32_bf16 a[136:139], v[80:83], v[168:171], a[136:139]
    v_exp_f32 v108, v108
    v_mfma_f32_16x16x32_bf16 a[184:187], v[88:91], v[168:171], a[184:187]
    v_add_f32 v146, v146, v108
    v_fma_f32 v235, v235, v44, v46
    v_mfma_f32_16x16x32_bf16 a[44:47], v[64:67], v[172:175], a[44:47]
    v_exp_f32 v109, v109
    v_mfma_f32_16x16x32_bf16 a[92:95], v[72:75], v[172:175], a[92:95]
    v_add_f32 v147, v147, v109
    v_cvt_pk_bf16_f32 v106, v108, v109
    v_mfma_f32_16x16x32_bf16 a[140:143], v[80:83], v[172:175], a[140:143]
    v_exp_f32 v110, v110
    v_mfma_f32_16x16x32_bf16 a[188:191], v[88:91], v[172:175], a[188:191]
    v_add_f32 v146, v146, v110
    s_waitcnt lgkmcnt(0)
    v_mfma_f32_16x16x32_bf16 v[64:67], v[176:179], v[192:195], 0
    v_fma_f32 v236, v236, v45, v47
    v_fma_f32 v237, v237, v45, v47
    v_mfma_f32_16x16x32_bf16 v[72:75], v[176:179], v[196:199], 0
    ds_read_b128 v[160:163], v2 offset:16384
    ds_read_b128 v[164:167], v2 offset:17408
    v_mfma_f32_16x16x32_bf16 v[80:83], v[176:179], v[200:203], 0
    v_exp_f32 v111, v111
    v_mfma_f32_16x16x32_bf16 v[88:91], v[176:179], v[204:207], 0
    ds_read_b128 v[168:171], v2 offset:18432
    ds_read_b128 v[172:175], v2 offset:19456
    v_mfma_f32_16x16x32_bf16 v[64:67], v[180:183], v[208:211], v[64:67]
    v_add_f32 v147, v147, v111
    v_cvt_pk_bf16_f32 v107, v110, v111
    v_mfma_f32_16x16x32_bf16 v[72:75], v[180:183], v[212:215], v[72:75]
    v_exp_f32 v112, v112
    v_mfma_f32_16x16x32_bf16 v[80:83], v[180:183], v[216:219], v[80:83]
    v_exp_f32 v113, v113
    v_mfma_f32_16x16x32_bf16 v[88:91], v[180:183], v[220:223], v[88:91]
    v_add_f32 v148, v148, v112
    v_add_f32 v149, v149, v113
    v_mfma_f32_16x16x32_bf16 v[64:67], v[184:187], a[192:195], v[64:67]
    v_exp_f32 v114, v114
    v_mfma_f32_16x16x32_bf16 v[72:75], v[184:187], a[196:199], v[72:75]
    v_cvt_pk_bf16_f32 v112, v112, v113
    v_add_f32 v148, v148, v114
    v_mfma_f32_16x16x32_bf16 v[80:83], v[184:187], a[200:203], v[80:83]
    v_exp_f32 v115, v115
    v_mfma_f32_16x16x32_bf16 v[88:91], v[184:187], a[204:207], v[88:91]
    v_add_f32 v149, v149, v115
    v_cvt_pk_bf16_f32 v113, v114, v115
    v_mfma_f32_16x16x32_bf16 v[64:67], v[188:191], a[208:211], v[64:67]
    v_exp_f32 v116, v116
    v_mfma_f32_16x16x32_bf16 v[72:75], v[188:191], a[212:215], v[72:75]
    v_add_f32 v148, v148, v116
    v_fma_f32 v238, v238, v45, v47
    v_mfma_f32_16x16x32_bf16 v[80:83], v[188:191], a[216:219], v[80:83]
    v_exp_f32 v117, v117
    v_mfma_f32_16x16x32_bf16 v[88:91], v[188:191], a[220:223], v[88:91]
    v_add_f32 v149, v149, v117
    s_waitcnt lgkmcnt(0)
    v_mfma_f32_16x16x32_bf16 v[64:67], v[160:163], a[224:227], v[64:67]
    v_cvt_pk_bf16_f32 v114, v116, v117
    v_fma_f32 v239, v239, v45, v47
    v_mfma_f32_16x16x32_bf16 v[72:75], v[160:163], a[228:231], v[72:75]
    ds_read_b128 v[176:179], v2 offset:20480
    ds_read_b128 v[180:183], v2 offset:21504
    v_mfma_f32_16x16x32_bf16 v[80:83], v[160:163], a[232:235], v[80:83]
    v_exp_f32 v118, v118
    v_mfma_f32_16x16x32_bf16 v[88:91], v[160:163], a[236:239], v[88:91]
    ds_read_b128 v[184:187], v2 offset:22528
    ds_read_b128 v[188:191], v2 offset:23552
    v_mfma_f32_16x16x32_bf16 v[64:67], v[164:167], a[240:243], v[64:67]
    v_add_f32 v148, v148, v118
    v_cvt_pk_bf16_f32 v129, v232, v236
    v_mfma_f32_16x16x32_bf16 v[72:75], v[164:167], a[244:247], v[72:75]
    v_exp_f32 v119, v119
    v_mfma_f32_16x16x32_bf16 v[80:83], v[164:167], a[248:251], v[80:83]
    v_add_f32 v149, v149, v119
    v_cvt_pk_bf16_f32 v115, v118, v119
    v_mfma_f32_16x16x32_bf16 v[88:91], v[164:167], a[252:255], v[88:91]
    v_exp_f32 v120, v120
    v_mfma_f32_16x16x32_bf16 v[68:71], v[168:171], v[192:195], 0
    v_add_f32 v150, v150, v120
    v_cvt_pk_bf16_f32 v133, v233, v237
    v_mfma_f32_16x16x32_bf16 v[76:79], v[168:171], v[196:199], 0
    v_exp_f32 v121, v121
    v_mfma_f32_16x16x32_bf16 v[84:87], v[168:171], v[200:203], 0
    v_add_f32 v151, v151, v121
    v_cvt_pk_bf16_f32 v120, v120, v121
    v_mfma_f32_16x16x32_bf16 v[92:95], v[168:171], v[204:207], 0
    v_exp_f32 v122, v122
    v_mfma_f32_16x16x32_bf16 v[68:71], v[172:175], v[208:211], v[68:71]
    v_add_f32 v150, v150, v122
    v_cvt_pk_bf16_f32 v137, v234, v238
    v_mfma_f32_16x16x32_bf16 v[76:79], v[172:175], v[212:215], v[76:79]
    v_exp_f32 v123, v123
    v_mfma_f32_16x16x32_bf16 v[84:87], v[172:175], v[216:219], v[84:87]
    v_add_f32 v151, v151, v123
    v_cvt_pk_bf16_f32 v121, v122, v123
    v_mfma_f32_16x16x32_bf16 v[92:95], v[172:175], v[220:223], v[92:95]
    s_waitcnt vmcnt(11) lgkmcnt(0)
    s_barrier
    v_mfma_f32_16x16x32_bf16 v[68:71], v[176:179], a[192:195], v[68:71]
    v_exp_f32 v124, v124
    v_mfma_f32_16x16x32_bf16 v[76:79], v[176:179], a[196:199], v[76:79]
    ds_read_b128 v[160:163], v2 offset:24576
    ds_read_b128 v[164:167], v2 offset:25600
    v_mfma_f32_16x16x32_bf16 v[84:87], v[176:179], a[200:203], v[84:87]
    v_add_f32 v150, v150, v124
    v_cvt_pk_bf16_f32 v141, v235, v239
    v_mfma_f32_16x16x32_bf16 v[92:95], v[176:179], a[204:207], v[92:95]
    ds_read_b128 v[168:171], v2 offset:26624
    ds_read_b128 v[172:175], v2 offset:27648
    v_mfma_f32_16x16x32_bf16 v[68:71], v[180:183], a[208:211], v[68:71]
    v_exp_f32 v125, v125
    v_mfma_f32_16x16x32_bf16 v[76:79], v[180:183], a[212:215], v[76:79]
    v_add_f32 v151, v151, v125
    v_cvt_pk_bf16_f32 v122, v124, v125
    v_mfma_f32_16x16x32_bf16 v[84:87], v[180:183], a[216:219], v[84:87]
    v_exp_f32 v126, v126
    v_mfma_f32_16x16x32_bf16 v[92:95], v[180:183], a[220:223], v[92:95]
    v_add_f32 v150, v150, v126
    buffer_load_dwordx2 v[24:25], v8, s[28:31], s59 offen offset:0
    v_mfma_f32_16x16x32_bf16 v[68:71], v[184:187], a[224:227], v[68:71]
    v_exp_f32 v127, v127
    v_mfma_f32_16x16x32_bf16 v[76:79], v[184:187], a[228:231], v[76:79]
    v_add_f32 v151, v151, v127
    v_cvt_pk_bf16_f32 v123, v126, v127
    v_mfma_f32_16x16x32_bf16 v[84:87], v[184:187], a[232:235], v[84:87]
    buffer_load_dwordx2 v[28:29], v8, s[32:35], s59 offen offset:0
    v_mfma_f32_16x16x32_bf16 v[92:95], v[184:187], a[236:239], v[92:95]
    v_mfma_f32_16x16x32_bf16 v[68:71], v[188:191], a[240:243], v[68:71]
    v_mfma_f32_16x16x32_bf16 v[76:79], v[188:191], a[244:247], v[76:79]
    v_mfma_f32_16x16x32_bf16 v[84:87], v[188:191], a[248:251], v[84:87]
    v_mfma_f32_16x16x32_bf16 v[92:95], v[188:191], a[252:255], v[92:95]
    s_waitcnt vmcnt(19) lgkmcnt(0)
    v_mfma_f32_16x16x32_bf16 a[0:3], v[96:99], v[160:163], a[0:3]
    v_exp_f32 v64, v64
    v_mfma_f32_16x16x32_bf16 a[48:51], v[104:107], v[160:163], a[48:51]
    ds_read_b128 v[176:179], v2 offset:28672
    ds_read_b128 v[180:183], v2 offset:29696
    v_mfma_f32_16x16x32_bf16 a[96:99], v[112:115], v[160:163], a[96:99]
    buffer_load_dword v12, v13, s[40:43], 0 offen sc1
    v_add_f32 v144, v144, v64
    v_mfma_f32_16x16x32_bf16 a[144:147], v[120:123], v[160:163], a[144:147]
    ds_read_b128 v[184:187], v2 offset:30720
    ds_read_b128 v[188:191], v2 offset:31744
    v_mfma_f32_16x16x32_bf16 a[4:7], v[96:99], v[164:167], a[4:7]
    s_add_u32 m0, s21, 24576
    v_lshlrev_b32 v40, 16, v26
    v_mfma_f32_16x16x32_bf16 a[52:55], v[104:107], v[164:167], a[52:55]
    buffer_load_dwordx4 v1, s[8:11], s20 offen offset:0 sc1 lds
    v_and_b32 v41, s62, v26
    v_mfma_f32_16x16x32_bf16 a[100:103], v[112:115], v[164:167], a[100:103]
    v_exp_f32 v65, v65
    v_mfma_f32_16x16x32_bf16 a[148:151], v[120:123], v[164:167], a[148:151]
    v_add_f32 v145, v145, v65
    v_cvt_pk_bf16_f32 v64, v64, v65
    v_mfma_f32_16x16x32_bf16 a[8:11], v[96:99], v[168:171], a[8:11]
    v_exp_f32 v66, v66
    v_mfma_f32_16x16x32_bf16 a[56:59], v[104:107], v[168:171], a[56:59]
    buffer_load_dwordx4 v1, s[8:11], s20 offen offset:1024 sc1 lds
    v_add_f32 v144, v144, v66
    v_mfma_f32_16x16x32_bf16 a[104:107], v[112:115], v[168:171], a[104:107]
    v_lshlrev_b32 v42, 16, v30
    v_and_b32 v43, s62, v30
    v_mfma_f32_16x16x32_bf16 a[152:155], v[120:123], v[168:171], a[152:155]
    v_exp_f32 v67, v67
    v_mfma_f32_16x16x32_bf16 a[12:15], v[96:99], v[172:175], a[12:15]
    v_add_f32 v145, v145, v67
    v_cvt_pk_bf16_f32 v65, v66, v67
    v_mfma_f32_16x16x32_bf16 a[60:63], v[104:107], v[172:175], a[60:63]
    buffer_load_dwordx4 v1, s[8:11], s20 offen offset:2048 sc1 lds
    v_mul_f32 v42, -v42, v40
    v_mfma_f32_16x16x32_bf16 a[108:111], v[112:115], v[172:175], a[108:111]
    v_exp_f32 v68, v68
    v_mfma_f32_16x16x32_bf16 a[156:159], v[120:123], v[172:175], a[156:159]
    v_add_f32 v144, v144, v68
    s_waitcnt vmcnt(29) lgkmcnt(0)
    v_mfma_f32_16x16x32_bf16 a[16:19], v[96:99], v[176:179], a[16:19]
    v_mul_f32 v43, -v43, v41
    v_cvt_f32_i32 v240, v240
    v_mfma_f32_16x16x32_bf16 a[64:67], v[104:107], v[176:179], a[64:67]
    ds_read_b128 v[160:163], v2 offset:32768
    ds_read_b128 v[164:167], v2 offset:33792
    v_mfma_f32_16x16x32_bf16 a[112:115], v[112:115], v[176:179], a[112:115]
    buffer_load_dwordx4 v1, s[8:11], s20 offen offset:3072 sc1 lds
    v_cvt_f32_i32 v241, v241
    v_mfma_f32_16x16x32_bf16 a[160:163], v[120:123], v[176:179], a[160:163]
    ds_read_b128 v[168:171], v2 offset:34816
    ds_read_b128 v[172:175], v2 offset:35840
    v_mfma_f32_16x16x32_bf16 a[20:23], v[96:99], v[180:183], a[20:23]
    s_add_u32 m0, s21, 28672
    v_cvt_f32_i32 v242, v242
    v_mfma_f32_16x16x32_bf16 a[68:71], v[104:107], v[180:183], a[68:71]
    buffer_load_dwordx4 v3, s[8:11], s20 offen offset:0 sc1 lds
    v_cvt_f32_i32 v243, v243
    v_mfma_f32_16x16x32_bf16 a[116:119], v[112:115], v[180:183], a[116:119]
    v_exp_f32 v69, v69
    v_mfma_f32_16x16x32_bf16 a[164:167], v[120:123], v[180:183], a[164:167]
    v_add_f32 v145, v145, v69
    v_cvt_pk_bf16_f32 v66, v68, v69
    v_mfma_f32_16x16x32_bf16 a[24:27], v[96:99], v[184:187], a[24:27]
    v_exp_f32 v70, v70
    v_mfma_f32_16x16x32_bf16 a[72:75], v[104:107], v[184:187], a[72:75]
    buffer_load_dwordx4 v3, s[8:11], s20 offen offset:1024 sc1 lds
    v_add_f32 v144, v144, v70
    v_mfma_f32_16x16x32_bf16 a[120:123], v[112:115], v[184:187], a[120:123]
    s_add_u32 s20, s20, 12288
    v_cvt_f32_i32 v244, v244
    v_mfma_f32_16x16x32_bf16 a[168:171], v[120:123], v[184:187], a[168:171]
    v_cvt_f32_i32 v245, v245
    v_cvt_f32_i32 v246, v246
    v_mfma_f32_16x16x32_bf16 a[28:31], v[96:99], v[188:191], a[28:31]
    v_exp_f32 v71, v71
    v_mfma_f32_16x16x32_bf16 a[76:79], v[104:107], v[188:191], a[76:79]
    v_add_f32 v145, v145, v71
    v_cvt_pk_bf16_f32 v67, v70, v71
    v_mfma_f32_16x16x32_bf16 a[124:127], v[112:115], v[188:191], a[124:127]
    buffer_load_dwordx4 v[232:235], v4, s[24:27], s58 offen offset:1536 nt
    v_cvt_f32_i32 v247, v247
    v_mfma_f32_16x16x32_bf16 a[172:175], v[120:123], v[188:191], a[172:175]
    v_fma_f32 v240, v240, v40, v42
    s_waitcnt lgkmcnt(0)
    v_mfma_f32_16x16x32_bf16 a[32:35], v[96:99], v[160:163], a[32:35]
    v_exp_f32 v72, v72
    v_mfma_f32_16x16x32_bf16 a[80:83], v[104:107], v[160:163], a[80:83]
    ds_read_b128 v[176:179], v2 offset:36864
    ds_read_b128 v[180:183], v2 offset:37888
    v_mfma_f32_16x16x32_bf16 a[128:131], v[112:115], v[160:163], a[128:131]
    buffer_load_dwordx4 v[236:239], v4, s[24:27], s58 offen offset:2304 nt
    v_add_f32 v146, v146, v72
    v_mfma_f32_16x16x32_bf16 a[176:179], v[120:123], v[160:163], a[176:179]
    ds_read_b128 v[184:187], v2 offset:38912
    ds_read_b128 v[188:191], v2 offset:39936
    v_mfma_f32_16x16x32_bf16 a[36:39], v[96:99], v[164:167], a[36:39]
    v_fma_f32 v241, v241, v40, v42
    v_fma_f32 v242, v242, v40, v42
    v_mfma_f32_16x16x32_bf16 a[84:87], v[104:107], v[164:167], a[84:87]
    v_exp_f32 v73, v73
    v_mfma_f32_16x16x32_bf16 a[132:135], v[112:115], v[164:167], a[132:135]
    v_add_f32 v147, v147, v73
    v_cvt_pk_bf16_f32 v72, v72, v73
    v_mfma_f32_16x16x32_bf16 a[180:183], v[120:123], v[164:167], a[180:183]
    v_exp_f32 v74, v74
    v_mfma_f32_16x16x32_bf16 a[40:43], v[96:99], v[168:171], a[40:43]
    v_exp_f32 v75, v75
    v_mfma_f32_16x16x32_bf16 a[88:91], v[104:107], v[168:171], a[88:91]
    v_add_f32 v146, v146, v74
    v_add_f32 v147, v147, v75
    v_mfma_f32_16x16x32_bf16 a[136:139], v[112:115], v[168:171], a[136:139]
    v_exp_f32 v76, v76
    v_mfma_f32_16x16x32_bf16 a[184:187], v[120:123], v[168:171], a[184:187]
    v_cvt_pk_bf16_f32 v73, v74, v75
    v_add_f32 v146, v146, v76
    v_mfma_f32_16x16x32_bf16 a[44:47], v[96:99], v[172:175], a[44:47]
    v_exp_f32 v77, v77
    v_mfma_f32_16x16x32_bf16 a[92:95], v[104:107], v[172:175], a[92:95]
    v_add_f32 v147, v147, v77
    v_cvt_pk_bf16_f32 v74, v76, v77
    v_mfma_f32_16x16x32_bf16 a[140:143], v[112:115], v[172:175], a[140:143]
    v_exp_f32 v78, v78
    v_mfma_f32_16x16x32_bf16 a[188:191], v[120:123], v[172:175], a[188:191]
    v_add_f32 v146, v146, v78
    s_waitcnt lgkmcnt(0)
    v_mfma_f32_16x16x32_bf16 v[96:99], v[176:179], v[192:195], 0
    v_fma_f32 v243, v243, v40, v42
    v_fma_f32 v244, v244, v41, v43
    v_mfma_f32_16x16x32_bf16 v[104:107], v[176:179], v[196:199], 0
    ds_read_b128 v[160:163], v2 offset:40960
    ds_read_b128 v[164:167], v2 offset:41984
    v_mfma_f32_16x16x32_bf16 v[112:115], v[176:179], v[200:203], 0
    v_exp_f32 v79, v79
    v_mfma_f32_16x16x32_bf16 v[120:123], v[176:179], v[204:207], 0
    ds_read_b128 v[168:171], v2 offset:43008
    ds_read_b128 v[172:175], v2 offset:44032
    v_mfma_f32_16x16x32_bf16 v[96:99], v[180:183], v[208:211], v[96:99]
    v_add_f32 v147, v147, v79
    v_cvt_pk_bf16_f32 v75, v78, v79
    v_mfma_f32_16x16x32_bf16 v[104:107], v[180:183], v[212:215], v[104:107]
    v_exp_f32 v80, v80
    v_mfma_f32_16x16x32_bf16 v[112:115], v[180:183], v[216:219], v[112:115]
    v_add_f32 v148, v148, v80
    v_fma_f32 v245, v245, v41, v43
    v_mfma_f32_16x16x32_bf16 v[120:123], v[180:183], v[220:223], v[120:123]
    v_exp_f32 v81, v81
    v_mfma_f32_16x16x32_bf16 v[96:99], v[184:187], a[192:195], v[96:99]
    v_add_f32 v149, v149, v81
    v_cvt_pk_bf16_f32 v80, v80, v81
    v_mfma_f32_16x16x32_bf16 v[104:107], v[184:187], a[196:199], v[104:107]
    v_exp_f32 v82, v82
    v_mfma_f32_16x16x32_bf16 v[112:115], v[184:187], a[200:203], v[112:115]
    v_add_f32 v148, v148, v82
    v_fma_f32 v246, v246, v41, v43
    v_mfma_f32_16x16x32_bf16 v[120:123], v[184:187], a[204:207], v[120:123]
    v_exp_f32 v83, v83
    v_mfma_f32_16x16x32_bf16 v[96:99], v[188:191], a[208:211], v[96:99]
    v_add_f32 v149, v149, v83
    v_cvt_pk_bf16_f32 v81, v82, v83
    v_mfma_f32_16x16x32_bf16 v[104:107], v[188:191], a[212:215], v[104:107]
    v_exp_f32 v84, v84
    v_mfma_f32_16x16x32_bf16 v[112:115], v[188:191], a[216:219], v[112:115]
    v_add_f32 v148, v148, v84
    v_fma_f32 v247, v247, v41, v43
    v_mfma_f32_16x16x32_bf16 v[120:123], v[188:191], a[220:223], v[120:123]
    v_cvt_pk_bf16_f32 v130, v240, v244
    s_waitcnt lgkmcnt(0)
    v_mfma_f32_16x16x32_bf16 v[96:99], v[160:163], a[224:227], v[96:99]
    v_exp_f32 v85, v85
    v_mfma_f32_16x16x32_bf16 v[104:107], v[160:163], a[228:231], v[104:107]
    ds_read_b128 v[176:179], v2 offset:45056
    ds_read_b128 v[180:183], v2 offset:46080
    v_mfma_f32_16x16x32_bf16 v[112:115], v[160:163], a[232:235], v[112:115]
    v_exp_f32 v86, v86
    v_mfma_f32_16x16x32_bf16 v[120:123], v[160:163], a[236:239], v[120:123]
    ds_read_b128 v[184:187], v2 offset:47104
    ds_read_b128 v[188:191], v2 offset:48128
    v_mfma_f32_16x16x32_bf16 v[96:99], v[164:167], a[240:243], v[96:99]
    v_add_f32 v149, v149, v85
    v_cvt_pk_bf16_f32 v82, v84, v85
    v_mfma_f32_16x16x32_bf16 v[104:107], v[164:167], a[244:247], v[104:107]
    v_exp_f32 v87, v87
    v_mfma_f32_16x16x32_bf16 v[112:115], v[164:167], a[248:251], v[112:115]
    v_add_f32 v148, v148, v86
    v_add_f32 v149, v149, v87
    v_mfma_f32_16x16x32_bf16 v[120:123], v[164:167], a[252:255], v[120:123]
    v_exp_f32 v88, v88
    v_mfma_f32_16x16x32_bf16 v[100:103], v[168:171], v[192:195], 0
    v_cvt_pk_bf16_f32 v83, v86, v87
    v_add_f32 v150, v150, v88
    v_mfma_f32_16x16x32_bf16 v[108:111], v[168:171], v[196:199], 0
    v_exp_f32 v89, v89
    v_mfma_f32_16x16x32_bf16 v[116:119], v[168:171], v[200:203], 0
    v_add_f32 v151, v151, v89
    v_cvt_pk_bf16_f32 v88, v88, v89
    v_mfma_f32_16x16x32_bf16 v[124:127], v[168:171], v[204:207], 0
    v_exp_f32 v90, v90
    v_mfma_f32_16x16x32_bf16 v[100:103], v[172:175], v[208:211], v[100:103]
    v_add_f32 v150, v150, v90
    v_cvt_pk_bf16_f32 v134, v241, v245
    v_mfma_f32_16x16x32_bf16 v[108:111], v[172:175], v[212:215], v[108:111]
    v_exp_f32 v91, v91
    v_mfma_f32_16x16x32_bf16 v[116:119], v[172:175], v[216:219], v[116:119]
    v_add_f32 v151, v151, v91
    v_cvt_pk_bf16_f32 v89, v90, v91
    v_mfma_f32_16x16x32_bf16 v[124:127], v[172:175], v[220:223], v[124:127]
    s_waitcnt vmcnt(13) lgkmcnt(0)
    s_barrier
    v_mfma_f32_16x16x32_bf16 v[100:103], v[176:179], a[192:195], v[100:103]
    v_exp_f32 v92, v92
    v_mfma_f32_16x16x32_bf16 v[108:111], v[176:179], a[196:199], v[108:111]
    ds_read_b128 v[160:163], v1 offset:0
    ds_read_b128 v[164:167], v1 offset:1024
    v_mfma_f32_16x16x32_bf16 v[116:119], v[176:179], a[200:203], v[116:119]
    v_add_f32 v150, v150, v92
    v_cvt_pk_bf16_f32 v138, v242, v246
    v_mfma_f32_16x16x32_bf16 v[124:127], v[176:179], a[204:207], v[124:127]
    ds_read_b128 v[168:171], v1 offset:2048
    ds_read_b128 v[172:175], v1 offset:3072
    v_mfma_f32_16x16x32_bf16 v[100:103], v[180:183], a[208:211], v[100:103]
    v_exp_f32 v93, v93
    v_mfma_f32_16x16x32_bf16 v[108:111], v[180:183], a[212:215], v[108:111]
    v_add_f32 v151, v151, v93
    v_cvt_pk_bf16_f32 v90, v92, v93
    v_mfma_f32_16x16x32_bf16 v[116:119], v[180:183], a[216:219], v[116:119]
    v_exp_f32 v94, v94
    v_mfma_f32_16x16x32_bf16 v[124:127], v[180:183], a[220:223], v[124:127]
    v_add_f32 v150, v150, v94
    v_cvt_pk_bf16_f32 v142, v243, v247
    v_mfma_f32_16x16x32_bf16 v[100:103], v[184:187], a[224:227], v[100:103]
    v_exp_f32 v95, v95
    v_mfma_f32_16x16x32_bf16 v[108:111], v[184:187], a[228:231], v[108:111]
    v_add_f32 v151, v151, v95
    v_cvt_pk_bf16_f32 v91, v94, v95
    v_mfma_f32_16x16x32_bf16 v[116:119], v[184:187], a[232:235], v[116:119]
    v_mfma_f32_16x16x32_bf16 v[124:127], v[184:187], a[236:239], v[124:127]
    v_mfma_f32_16x16x32_bf16 v[100:103], v[188:191], a[240:243], v[100:103]
    v_mfma_f32_16x16x32_bf16 v[108:111], v[188:191], a[244:247], v[108:111]
    v_mfma_f32_16x16x32_bf16 v[116:119], v[188:191], a[248:251], v[116:119]
    v_mfma_f32_16x16x32_bf16 v[124:127], v[188:191], a[252:255], v[124:127]
    s_sub_u32 s57, s57, 1
    s_cmp_lg_u32 s57, 0
    s_cbranch_scc1 LOOP_B
TAIL:
    s_waitcnt vmcnt(8) lgkmcnt(0)
    v_mfma_f32_16x16x32_bf16 a[0:3], v[64:67], v[160:163], a[0:3]
    v_sub_u32 v12, v12, v11
    v_cmp_lt_u32 vcc, 31, v12
    v_mfma_f32_16x16x32_bf16 a[48:51], v[72:75], v[160:163], a[48:51]
    ds_read_b128 v[176:179], v1 offset:4096
    ds_read_b128 v[180:183], v1 offset:5120
    v_mfma_f32_16x16x32_bf16 a[96:99], v[80:83], v[160:163], a[96:99]
    s_cbranch_vccnz SPIN_T
RET_T:
    v_add_u32 v11, 1, v11
    v_mfma_f32_16x16x32_bf16 a[144:147], v[88:91], v[160:163], a[144:147]
    ds_read_b128 v[184:187], v1 offset:6144
    ds_read_b128 v[188:191], v1 offset:7168
    v_mfma_f32_16x16x32_bf16 a[4:7], v[64:67], v[164:167], a[4:7]
    s_add_u32 m0, s21, 49152
    s_lshl_b32 s19, s16, 2
    v_mfma_f32_16x16x32_bf16 a[52:55], v[72:75], v[164:167], a[52:55]
    buffer_load_dwordx4 v1, s[8:11], s20 offen offset:0 sc1 lds
    s_add_u32 s19, s19, 99328
    v_mfma_f32_16x16x32_bf16 a[100:103], v[80:83], v[164:167], a[100:103]
    v_exp_f32 v96, v96
    v_mfma_f32_16x16x32_bf16 a[148:151], v[88:91], v[164:167], a[148:151]
    v_exp_f32 v97, v97
    v_mfma_f32_16x16x32_bf16 a[8:11], v[64:67], v[168:171], a[8:11]
    v_add_f32 v144, v144, v96
    v_add_f32 v145, v145, v97
    v_mfma_f32_16x16x32_bf16 a[56:59], v[72:75], v[168:171], a[56:59]
    buffer_load_dwordx4 v1, s[8:11], s20 offen offset:1024 sc1 lds
    v_cvt_pk_bf16_f32 v96, v96, v97
    v_mfma_f32_16x16x32_bf16 a[104:107], v[80:83], v[168:171], a[104:107]
    v_exp_f32 v98, v98
    v_mfma_f32_16x16x32_bf16 a[152:155], v[88:91], v[168:171], a[152:155]
    v_add_f32 v144, v144, v98
    v_mov_b32 v17, s19
    v_mfma_f32_16x16x32_bf16 a[12:15], v[64:67], v[172:175], a[12:15]
    v_exp_f32 v99, v99
    v_mfma_f32_16x16x32_bf16 a[60:63], v[72:75], v[172:175], a[60:63]
    buffer_load_dwordx4 v1, s[8:11], s20 offen offset:2048 sc1 lds
    v_add_f32 v145, v145, v99
    v_mfma_f32_16x16x32_bf16 a[108:111], v[80:83], v[172:175], a[108:111]
    v_cvt_pk_bf16_f32 v97, v98, v99
    v_mov_b32 v18, s53
    v_mfma_f32_16x16x32_bf16 a[156:159], v[88:91], v[172:175], a[156:159]
    ds_write_b32 v17, v18
    s_waitcnt lgkmcnt(0)
    v_mfma_f32_16x16x32_bf16 a[16:19], v[64:67], v[176:179], a[16:19]
    v_exp_f32 v100, v100
    v_mfma_f32_16x16x32_bf16 a[64:67], v[72:75], v[176:179], a[64:67]
    ds_read_b128 v[160:163], v1 offset:8192
    ds_read_b128 v[164:167], v1 offset:9216
    v_mfma_f32_16x16x32_bf16 a[112:115], v[80:83], v[176:179], a[112:115]
    buffer_load_dwordx4 v1, s[8:11], s20 offen offset:3072 sc1 lds
    v_add_f32 v144, v144, v100
    v_mfma_f32_16x16x32_bf16 a[160:163], v[88:91], v[176:179], a[160:163]
    ds_read_b128 v[168:171], v1 offset:10240
    ds_read_b128 v[172:175], v1 offset:11264
    v_mfma_f32_16x16x32_bf16 a[20:23], v[64:67], v[180:183], a[20:23]
    s_add_u32 m0, s21, 53248
    v_mfma_f32_16x16x32_bf16 a[68:71], v[72:75], v[180:183], a[68:71]
    buffer_load_dwordx4 v3, s[8:11], s20 offen offset:0 sc1 lds
    v_mfma_f32_16x16x32_bf16 a[116:119], v[80:83], v[180:183], a[116:119]
    v_mfma_f32_16x16x32_bf16 a[164:167], v[88:91], v[180:183], a[164:167]
    v_exp_f32 v101, v101
    v_mfma_f32_16x16x32_bf16 a[24:27], v[64:67], v[184:187], a[24:27]
    v_add_f32 v145, v145, v101
    v_cvt_pk_bf16_f32 v98, v100, v101
    v_mfma_f32_16x16x32_bf16 a[72:75], v[72:75], v[184:187], a[72:75]
    buffer_load_dwordx4 v3, s[8:11], s20 offen offset:1024 sc1 lds
    v_mfma_f32_16x16x32_bf16 a[120:123], v[80:83], v[184:187], a[120:123]
    s_add_u32 s20, s20, 12288
    v_mfma_f32_16x16x32_bf16 a[168:171], v[88:91], v[184:187], a[168:171]
    v_exp_f32 v102, v102
    v_mfma_f32_16x16x32_bf16 a[28:31], v[64:67], v[188:191], a[28:31]
    v_add_f32 v144, v144, v102
    v_mfma_f32_16x16x32_bf16 a[76:79], v[72:75], v[188:191], a[76:79]
    v_exp_f32 v103, v103
    v_mfma_f32_16x16x32_bf16 a[124:127], v[80:83], v[188:191], a[124:127]
    v_add_f32 v145, v145, v103
    v_cvt_pk_bf16_f32 v99, v102, v103
    v_mfma_f32_16x16x32_bf16 a[172:175], v[88:91], v[188:191], a[172:175]
    s_waitcnt lgkmcnt(0)
    v_mfma_f32_16x16x32_bf16 a[32:35], v[64:67], v[160:163], a[32:35]
    v_exp_f32 v104, v104
    v_mfma_f32_16x16x32_bf16 a[80:83], v[72:75], v[160:163], a[80:83]
    ds_read_b128 v[176:179], v1 offset:12288
    ds_read_b128 v[180:183], v1 offset:13312
    v_mfma_f32_16x16x32_bf16 a[128:131], v[80:83], v[160:163], a[128:131]
    v_add_f32 v146, v146, v104
    v_mfma_f32_16x16x32_bf16 a[176:179], v[88:91], v[160:163], a[176:179]
    ds_read_b128 v[184:187], v1 offset:14336
    ds_read_b128 v[188:191], v1 offset:15360
    v_mfma_f32_16x16x32_bf16 a[36:39], v[64:67], v[164:167], a[36:39]
    v_exp_f32 v105, v105
    v_mfma_f32_16x16x32_bf16 a[84:87], v[72:75], v[164:167], a[84:87]
    v_add_f32 v147, v147, v105
    v_cvt_pk_bf16_f32 v104, v104, v105
    v_mfma_f32_16x16x32_bf16 a[132:135], v[80:83], v[164:167], a[132:135]
    v_exp_f32 v106, v106
    v_mfma_f32_16x16x32_bf16 a[180:183], v[88:91], v[164:167], a[180:183]
    v_add_f32 v146, v146, v106
    v_mfma_f32_16x16x32_bf16 a[40:43], v[64:67], v[168:171], a[40:43]
    v_exp_f32 v107, v107
    v_mfma_f32_16x16x32_bf16 a[88:91], v[72:75], v[168:171], a[88:91]
    v_add_f32 v147, v147, v107
    v_cvt_pk_bf16_f32 v105, v106, v107
    v_mfma_f32_16x16x32_bf16 a[136:139], v[80:83], v[168:171], a[136:139]
    v_exp_f32 v108, v108
    v_mfma_f32_16x16x32_bf16 a[184:187], v[88:91], v[168:171], a[184:187]
    v_add_f32 v146, v146, v108
    v_mfma_f32_16x16x32_bf16 a[44:47], v[64:67], v[172:175], a[44:47]
    v_exp_f32 v109, v109
    v_mfma_f32_16x16x32_bf16 a[92:95], v[72:75], v[172:175], a[92:95]
    v_add_f32 v147, v147, v109
    v_cvt_pk_bf16_f32 v106, v108, v109
    v_mfma_f32_16x16x32_bf16 a[140:143], v[80:83], v[172:175], a[140:143]
    v_exp_f32 v110, v110
    v_mfma_f32_16x16x32_bf16 a[188:191], v[88:91], v[172:175], a[188:191]
    v_add_f32 v146, v146, v110
    s_waitcnt lgkmcnt(0)
    v_mfma_f32_16x16x32_bf16 v[64:67], v[176:179], v[192:195], 0
    v_mfma_f32_16x16x32_bf16 v[72:75], v[176:179], v[196:199], 0
    ds_read_b128 v[160:163], v1 offset:16384
    ds_read_b128 v[164:167], v1 offset:17408
    v_mfma_f32_16x16x32_bf16 v[80:83], v[176:179], v[200:203], 0
    v_exp_f32 v111, v111
    v_mfma_f32_16x16x32_bf16 v[88:91], v[176:179], v[204:207], 0
    ds_read_b128 v[168:171], v1 offset:18432
    ds_read_b128 v[172:175], v1 offset:19456
    v_mfma_f32_16x16x32_bf16 v[64:67], v[180:183], v[208:211], v[64:67]
    v_add_f32 v147, v147, v111
    v_cvt_pk_bf16_f32 v107, v110, v111
    v_mfma_f32_16x16x32_bf16 v[72:75], v[180:183], v[212:215], v[72:75]
    v_exp_f32 v112, v112
    v_mfma_f32_16x16x32_bf16 v[80:83], v[180:183], v[216:219], v[80:83]
    v_exp_f32 v113, v113
    v_mfma_f32_16x16x32_bf16 v[88:91], v[180:183], v[220:223], v[88:91]
    v_add_f32 v148, v148, v112
    v_add_f32 v149, v149, v113
    v_mfma_f32_16x16x32_bf16 v[64:67], v[184:187], a[192:195], v[64:67]
    v_exp_f32 v114, v114
    v_mfma_f32_16x16x32_bf16 v[72:75], v[184:187], a[196:199], v[72:75]
    v_cvt_pk_bf16_f32 v112, v112, v113
    v_add_f32 v148, v148, v114
    v_mfma_f32_16x16x32_bf16 v[80:83], v[184:187], a[200:203], v[80:83]
    v_exp_f32 v115, v115
    v_mfma_f32_16x16x32_bf16 v[88:91], v[184:187], a[204:207], v[88:91]
    v_add_f32 v149, v149, v115
    v_cvt_pk_bf16_f32 v113, v114, v115
    v_mfma_f32_16x16x32_bf16 v[64:67], v[188:191], a[208:211], v[64:67]
    v_exp_f32 v116, v116
    v_mfma_f32_16x16x32_bf16 v[72:75], v[188:191], a[212:215], v[72:75]
    v_add_f32 v148, v148, v116
    v_mfma_f32_16x16x32_bf16 v[80:83], v[188:191], a[216:219], v[80:83]
    v_exp_f32 v117, v117
    v_mfma_f32_16x16x32_bf16 v[88:91], v[188:191], a[220:223], v[88:91]
    v_add_f32 v149, v149, v117
    s_waitcnt lgkmcnt(0)
    v_mfma_f32_16x16x32_bf16 v[64:67], v[160:163], a[224:227], v[64:67]
    v_cvt_pk_bf16_f32 v114, v116, v117
    v_mfma_f32_16x16x32_bf16 v[72:75], v[160:163], a[228:231], v[72:75]
    ds_read_b128 v[176:179], v1 offset:20480
    ds_read_b128 v[180:183], v1 offset:21504
    v_mfma_f32_16x16x32_bf16 v[80:83], v[160:163], a[232:235], v[80:83]
    v_exp_f32 v118, v118
    v_mfma_f32_16x16x32_bf16 v[88:91], v[160:163], a[236:239], v[88:91]
    ds_read_b128 v[184:187], v1 offset:22528
    ds_read_b128 v[188:191], v1 offset:23552
    v_mfma_f32_16x16x32_bf16 v[64:67], v[164:167], a[240:243], v[64:67]
    v_add_f32 v148, v148, v118
    v_mfma_f32_16x16x32_bf16 v[72:75], v[164:167], a[244:247], v[72:75]
    v_exp_f32 v119, v119
    v_mfma_f32_16x16x32_bf16 v[80:83], v[164:167], a[248:251], v[80:83]
    v_add_f32 v149, v149, v119
    v_cvt_pk_bf16_f32 v115, v118, v119
    v_mfma_f32_16x16x32_bf16 v[88:91], v[164:167], a[252:255], v[88:91]
    v_exp_f32 v120, v120
    v_mfma_f32_16x16x32_bf16 v[68:71], v[168:171], v[192:195], 0
    v_add_f32 v150, v150, v120
    v_mfma_f32_16x16x32_bf16 v[76:79], v[168:171], v[196:199], 0
    v_exp_f32 v121, v121
    v_mfma_f32_16x16x32_bf16 v[84:87], v[168:171], v[200:203], 0
    v_add_f32 v151, v151, v121
    v_cvt_pk_bf16_f32 v120, v120, v121
    v_mfma_f32_16x16x32_bf16 v[92:95], v[168:171], v[204:207], 0
    v_exp_f32 v122, v122
    v_mfma_f32_16x16x32_bf16 v[68:71], v[172:175], v[208:211], v[68:71]
    v_add_f32 v150, v150, v122
    v_mfma_f32_16x16x32_bf16 v[76:79], v[172:175], v[212:215], v[76:79]
    v_exp_f32 v123, v123
    v_mfma_f32_16x16x32_bf16 v[84:87], v[172:175], v[216:219], v[84:87]
    v_add_f32 v151, v151, v123
    v_cvt_pk_bf16_f32 v121, v122, v123
    v_mfma_f32_16x16x32_bf16 v[92:95], v[172:175], v[220:223], v[92:95]
    s_waitcnt vmcnt(8) lgkmcnt(0)
    s_barrier
    v_mfma_f32_16x16x32_bf16 v[68:71], v[176:179], a[192:195], v[68:71]
    v_exp_f32 v124, v124
    v_mfma_f32_16x16x32_bf16 v[76:79], v[176:179], a[196:199], v[76:79]
    ds_read_b128 v[160:163], v1 offset:24576
    ds_read_b128 v[164:167], v1 offset:25600
    v_mfma_f32_16x16x32_bf16 v[84:87], v[176:179], a[200:203], v[84:87]
    v_add_f32 v150, v150, v124
    v_mfma_f32_16x16x32_bf16 v[92:95], v[176:179], a[204:207], v[92:95]
    ds_read_b128 v[168:171], v1 offset:26624
    ds_read_b128 v[172:175], v1 offset:27648
    v_mfma_f32_16x16x32_bf16 v[68:71], v[180:183], a[208:211], v[68:71]
    v_exp_f32 v125, v125
    v_mfma_f32_16x16x32_bf16 v[76:79], v[180:183], a[212:215], v[76:79]
    v_add_f32 v151, v151, v125
    v_cvt_pk_bf16_f32 v122, v124, v125
    v_mfma_f32_16x16x32_bf16 v[84:87], v[180:183], a[216:219], v[84:87]
    v_exp_f32 v126, v126
    v_mfma_f32_16x16x32_bf16 v[92:95], v[180:183], a[220:223], v[92:95]
    v_add_f32 v150, v150, v126
    v_mfma_f32_16x16x32_bf16 v[68:71], v[184:187], a[224:227], v[68:71]
    v_exp_f32 v127, v127
    v_mfma_f32_16x16x32_bf16 v[76:79], v[184:187], a[228:231], v[76:79]
    v_add_f32 v151, v151, v127
    v_cvt_pk_bf16_f32 v123, v126, v127
    v_mfma_f32_16x16x32_bf16 v[84:87], v[184:187], a[232:235], v[84:87]
    v_mfma_f32_16x16x32_bf16 v[92:95], v[184:187], a[236:239], v[92:95]
    v_mfma_f32_16x16x32_bf16 v[68:71], v[188:191], a[240:243], v[68:71]
    v_mfma_f32_16x16x32_bf16 v[76:79], v[188:191], a[244:247], v[76:79]
    v_mfma_f32_16x16x32_bf16 v[84:87], v[188:191], a[248:251], v[84:87]
    v_mfma_f32_16x16x32_bf16 v[92:95], v[188:191], a[252:255], v[92:95]
    s_waitcnt lgkmcnt(0)
    v_mfma_f32_16x16x32_bf16 a[0:3], v[96:99], v[160:163], a[0:3]
    v_exp_f32 v64, v64
    v_mfma_f32_16x16x32_bf16 a[48:51], v[104:107], v[160:163], a[48:51]
    ds_read_b128 v[176:179], v1 offset:28672
    ds_read_b128 v[180:183], v1 offset:29696
    v_mfma_f32_16x16x32_bf16 a[96:99], v[112:115], v[160:163], a[96:99]
    v_add_f32 v144, v144, v64
    ds_read_b128 v[56:59], v23
    v_mfma_f32_16x16x32_bf16 a[144:147], v[120:123], v[160:163], a[144:147]
    ds_read_b128 v[184:187], v1 offset:30720
    ds_read_b128 v[188:191], v1 offset:31744
    v_mfma_f32_16x16x32_bf16 a[4:7], v[96:99], v[164:167], a[4:7]
    s_add_u32 m0, s21, 73728
    v_mfma_f32_16x16x32_bf16 a[52:55], v[104:107], v[164:167], a[52:55]
    buffer_load_dwordx4 v1, s[8:11], s20 offen offset:0 sc1 lds
    v_mfma_f32_16x16x32_bf16 a[100:103], v[112:115], v[164:167], a[100:103]
    v_exp_f32 v65, v65
    v_mfma_f32_16x16x32_bf16 a[148:151], v[120:123], v[164:167], a[148:151]
    v_add_f32 v145, v145, v65
    v_cvt_pk_bf16_f32 v64, v64, v65
    v_mfma_f32_16x16x32_bf16 a[8:11], v[96:99], v[168:171], a[8:11]
    v_exp_f32 v66, v66
    v_mfma_f32_16x16x32_bf16 a[56:59], v[104:107], v[168:171], a[56:59]
    buffer_load_dwordx4 v1, s[8:11], s20 offen offset:1024 sc1 lds
    v_add_f32 v144, v144, v66
    v_mfma_f32_16x16x32_bf16 a[104:107], v[112:115], v[168:171], a[104:107]
    v_mfma_f32_16x16x32_bf16 a[152:155], v[120:123], v[168:171], a[152:155]
    v_exp_f32 v67, v67
    v_mfma_f32_16x16x32_bf16 a[12:15], v[96:99], v[172:175], a[12:15]
    v_add_f32 v145, v145, v67
    v_cvt_pk_bf16_f32 v65, v66, v67
    v_mfma_f32_16x16x32_bf16 a[60:63], v[104:107], v[172:175], a[60:63]
    buffer_load_dwordx4 v1, s[8:11], s20 offen offset:2048 sc1 lds
    v_mfma_f32_16x16x32_bf16 a[108:111], v[112:115], v[172:175], a[108:111]
    v_exp_f32 v68, v68
    v_mfma_f32_16x16x32_bf16 a[156:159], v[120:123], v[172:175], a[156:159]
    v_add_f32 v144, v144, v68
    s_waitcnt lgkmcnt(0)
    v_mfma_f32_16x16x32_bf16 a[16:19], v[96:99], v[176:179], a[16:19]
    v_mfma_f32_16x16x32_bf16 a[64:67], v[104:107], v[176:179], a[64:67]
    ds_read_b128 v[160:163], v1 offset:32768
    ds_read_b128 v[164:167], v1 offset:33792
    v_mfma_f32_16x16x32_bf16 a[112:115], v[112:115], v[176:179], a[112:115]
    buffer_load_dwordx4 v1, s[8:11], s20 offen offset:3072 sc1 lds
    v_mfma_f32_16x16x32_bf16 a[160:163], v[120:123], v[176:179], a[160:163]
    ds_read_b128 v[168:171], v1 offset:34816
    ds_read_b128 v[172:175], v1 offset:35840
    v_mfma_f32_16x16x32_bf16 a[20:23], v[96:99], v[180:183], a[20:23]
    s_add_u32 m0, s21, 77824
    v_mfma_f32_16x16x32_bf16 a[68:71], v[104:107], v[180:183], a[68:71]
    buffer_load_dwordx4 v3, s[8:11], s20 offen offset:0 sc1 lds
    v_mfma_f32_16x16x32_bf16 a[116:119], v[112:115], v[180:183], a[116:119]
    v_exp_f32 v69, v69
    v_mfma_f32_16x16x32_bf16 a[164:167], v[120:123], v[180:183], a[164:167]
    v_add_f32 v145, v145, v69
    v_cvt_pk_bf16_f32 v66, v68, v69
    v_mfma_f32_16x16x32_bf16 a[24:27], v[96:99], v[184:187], a[24:27]
    v_exp_f32 v70, v70
    v_mfma_f32_16x16x32_bf16 a[72:75], v[104:107], v[184:187], a[72:75]
    buffer_load_dwordx4 v3, s[8:11], s20 offen offset:1024 sc1 lds
    v_add_f32 v144, v144, v70
    v_mfma_f32_16x16x32_bf16 a[120:123], v[112:115], v[184:187], a[120:123]
    s_add_u32 s20, s20, 12288
    v_mfma_f32_16x16x32_bf16 a[168:171], v[120:123], v[184:187], a[168:171]
    v_mfma_f32_16x16x32_bf16 a[28:31], v[96:99], v[188:191], a[28:31]
    v_exp_f32 v71, v71
    v_mfma_f32_16x16x32_bf16 a[76:79], v[104:107], v[188:191], a[76:79]
    v_add_f32 v145, v145, v71
    v_cvt_pk_bf16_f32 v67, v70, v71
    v_mfma_f32_16x16x32_bf16 a[124:127], v[112:115], v[188:191], a[124:127]
    v_exp_f32 v72, v72
    v_mfma_f32_16x16x32_bf16 a[172:175], v[120:123], v[188:191], a[172:175]
    v_add_f32 v146, v146, v72
    s_waitcnt lgkmcnt(0)
    v_mfma_f32_16x16x32_bf16 a[32:35], v[96:99], v[160:163], a[32:35]
    v_mfma_f32_16x16x32_bf16 a[80:83], v[104:107], v[160:163], a[80:83]
    ds_read_b128 v[176:179], v1 offset:36864
    ds_read_b128 v[180:183], v1 offset:37888
    v_mfma_f32_16x16x32_bf16 a[128:131], v[112:115], v[160:163], a[128:131]
    v_exp_f32 v73, v73
    v_mfma_f32_16x16x32_bf16 a[176:179], v[120:123], v[160:163], a[176:179]
    ds_read_b128 v[184:187], v1 offset:38912
    ds_read_b128 v[188:191], v1 offset:39936
    v_mfma_f32_16x16x32_bf16 a[36:39], v[96:99], v[164:167], a[36:39]
    v_add_f32 v147, v147, v73
    v_cvt_pk_bf16_f32 v72, v72, v73
    v_mfma_f32_16x16x32_bf16 a[84:87], v[104:107], v[164:167], a[84:87]
    v_exp_f32 v74, v74
    v_mfma_f32_16x16x32_bf16 a[132:135], v[112:115], v[164:167], a[132:135]
    v_add_f32 v146, v146, v74
    v_mfma_f32_16x16x32_bf16 a[180:183], v[120:123], v[164:167], a[180:183]
    v_exp_f32 v75, v75
    v_mfma_f32_16x16x32_bf16 a[40:43], v[96:99], v[168:171], a[40:43]
    v_add_f32 v147, v147, v75
    v_cvt_pk_bf16_f32 v73, v74, v75
    v_mfma_f32_16x16x32_bf16 a[88:91], v[104:107], v[168:171], a[88:91]
    v_exp_f32 v76, v76
    v_mfma_f32_16x16x32_bf16 a[136:139], v[112:115], v[168:171], a[136:139]
    v_add_f32 v146, v146, v76
    v_mfma_f32_16x16x32_bf16 a[184:187], v[120:123], v[168:171], a[184:187]
    v_exp_f32 v77, v77
    v_mfma_f32_16x16x32_bf16 a[44:47], v[96:99], v[172:175], a[44:47]
    v_add_f32 v147, v147, v77
    v_cvt_pk_bf16_f32 v74, v76, v77
    v_mfma_f32_16x16x32_bf16 a[92:95], v[104:107], v[172:175], a[92:95]
    v_exp_f32 v78, v78
    v_mfma_f32_16x16x32_bf16 a[140:143], v[112:115], v[172:175], a[140:143]
    v_add_f32 v146, v146, v78
    v_mfma_f32_16x16x32_bf16 a[188:191], v[120:123], v[172:175], a[188:191]
    s_waitcnt lgkmcnt(0)
    v_mfma_f32_16x16x32_bf16 v[96:99], v[176:179], v[192:195], 0
    v_exp_f32 v79, v79
    v_mfma_f32_16x16x32_bf16 v[104:107], v[176:179], v[196:199], 0
    ds_read_b128 v[160:163], v1 offset:40960
    ds_read_b128 v[164:167], v1 offset:41984
    v_mfma_f32_16x16x32_bf16 v[112:115], v[176:179], v[200:203], 0
    v_add_f32 v147, v147, v79
    v_cvt_pk_bf16_f32 v75, v78, v79
    v_mfma_f32_16x16x32_bf16 v[120:123], v[176:179], v[204:207], 0
    ds_read_b128 v[168:171], v1 offset:43008
    ds_read_b128 v[172:175], v1 offset:44032
    v_mfma_f32_16x16x32_bf16 v[96:99], v[180:183], v[208:211], v[96:99]
    v_exp_f32 v80, v80
    v_mfma_f32_16x16x32_bf16 v[104:107], v[180:183], v[212:215], v[104:107]
    v_add_f32 v148, v148, v80
    v_mfma_f32_16x16x32_bf16 v[112:115], v[180:183], v[216:219], v[112:115]
    v_exp_f32 v81, v81
    v_mfma_f32_16x16x32_bf16 v[120:123], v[180:183], v[220:223], v[120:123]
    v_add_f32 v149, v149, v81
    v_cvt_pk_bf16_f32 v80, v80, v81
    v_mfma_f32_16x16x32_bf16 v[96:99], v[184:187], a[192:195], v[96:99]
    v_exp_f32 v82, v82
    v_mfma_f32_16x16x32_bf16 v[104:107], v[184:187], a[196:199], v[104:107]
    v_add_f32 v148, v148, v82
    v_mfma_f32_16x16x32_bf16 v[112:115], v[184:187], a[200:203], v[112:115]
    v_exp_f32 v83, v83
    v_mfma_f32_16x16x32_bf16 v[120:123], v[184:187], a[204:207], v[120:123]
    v_add_f32 v149, v149, v83
    v_cvt_pk_bf16_f32 v81, v82, v83
    v_mfma_f32_16x16x32_bf16 v[96:99], v[188:191], a[208:211], v[96:99]
    v_exp_f32 v84, v84
    v_mfma_f32_16x16x32_bf16 v[104:107], v[188:191], a[212:215], v[104:107]
    v_add_f32 v148, v148, v84
    v_mfma_f32_16x16x32_bf16 v[112:115], v[188:191], a[216:219], v[112:115]
    v_exp_f32 v85, v85
    v_mfma_f32_16x16x32_bf16 v[120:123], v[188:191], a[220:223], v[120:123]
    v_add_f32 v149, v149, v85
    s_waitcnt lgkmcnt(0)
    v_mfma_f32_16x16x32_bf16 v[96:99], v[160:163], a[224:227], v[96:99]
    v_cvt_pk_bf16_f32 v82, v84, v85
    v_mfma_f32_16x16x32_bf16 v[104:107], v[160:163], a[228:231], v[104:107]
    ds_read_b128 v[176:179], v1 offset:45056
    ds_read_b128 v[180:183], v1 offset:46080
    v_mfma_f32_16x16x32_bf16 v[112:115], v[160:163], a[232:235], v[112:115]
    v_exp_f32 v86, v86
    v_mfma_f32_16x16x32_bf16 v[120:123], v[160:163], a[236:239], v[120:123]
    ds_read_b128 v[184:187], v1 offset:47104
    ds_read_b128 v[188:191], v1 offset:48128
    v_mfma_f32_16x16x32_bf16 v[96:99], v[164:167], a[240:243], v[96:99]
    v_add_f32 v148, v148, v86
    v_mfma_f32_16x16x32_bf16 v[104:107], v[164:167], a[244:247], v[104:107]
    v_exp_f32 v87, v87
    v_mfma_f32_16x16x32_bf16 v[112:115], v[164:167], a[248:251], v[112:115]
    v_add_f32 v149, v149, v87
    v_cvt_pk_bf16_f32 v83, v86, v87
    v_mfma_f32_16x16x32_bf16 v[120:123], v[164:167], a[252:255], v[120:123]
    v_exp_f32 v88, v88
    v_mfma_f32_16x16x32_bf16 v[100:103], v[168:171], v[192:195], 0
    v_add_f32 v150, v150, v88
    v_mfma_f32_16x16x32_bf16 v[108:111], v[168:171], v[196:199], 0
    v_exp_f32 v89, v89
    v_mfma_f32_16x16x32_bf16 v[116:119], v[168:171], v[200:203], 0
    v_add_f32 v151, v151, v89
    v_cvt_pk_bf16_f32 v88, v88, v89
    v_mfma_f32_16x16x32_bf16 v[124:127], v[168:171], v[204:207], 0
    v_exp_f32 v90, v90
    v_mfma_f32_16x16x32_bf16 v[100:103], v[172:175], v[208:211], v[100:103]
    v_add_f32 v150, v150, v90
    v_mfma_f32_16x16x32_bf16 v[108:111], v[172:175], v[212:215], v[108:111]
    v_exp_f32 v91, v91
    v_mfma_f32_16x16x32_bf16 v[116:119], v[172:175], v[216:219], v[116:119]
    v_add_f32 v151, v151, v91
    v_cvt_pk_bf16_f32 v89, v90, v91
    v_mfma_f32_16x16x32_bf16 v[124:127], v[172:175], v[220:223], v[124:127]
    s_waitcnt vmcnt(6) lgkmcnt(0)
    s_barrier
    v_mfma_f32_16x16x32_bf16 v[100:103], v[176:179], a[192:195], v[100:103]
    v_exp_f32 v92, v92
    v_mfma_f32_16x16x32_bf16 v[108:111], v[176:179], a[196:199], v[108:111]
    ds_read_b128 v[160:163], v2 offset:0
    ds_read_b128 v[164:167], v2 offset:1024
    v_mfma_f32_16x16x32_bf16 v[116:119], v[176:179], a[200:203], v[116:119]
    v_add_f32 v150, v150, v92
    v_mfma_f32_16x16x32_bf16 v[124:127], v[176:179], a[204:207], v[124:127]
    ds_read_b128 v[168:171], v2 offset:2048
    ds_read_b128 v[172:175], v2 offset:3072
    v_mfma_f32_16x16x32_bf16 v[100:103], v[180:183], a[208:211], v[100:103]
    v_exp_f32 v93, v93
    v_mfma_f32_16x16x32_bf16 v[108:111], v[180:183], a[212:215], v[108:111]
    v_add_f32 v151, v151, v93
    v_cvt_pk_bf16_f32 v90, v92, v93
    v_mfma_f32_16x16x32_bf16 v[116:119], v[180:183], a[216:219], v[116:119]
    v_exp_f32 v94, v94
    v_mfma_f32_16x16x32_bf16 v[124:127], v[180:183], a[220:223], v[124:127]
    v_add_f32 v150, v150, v94
    v_mfma_f32_16x16x32_bf16 v[100:103], v[184:187], a[224:227], v[100:103]
    v_exp_f32 v95, v95
    v_mfma_f32_16x16x32_bf16 v[108:111], v[184:187], a[228:231], v[108:111]
    v_add_f32 v151, v151, v95
    v_cvt_pk_bf16_f32 v91, v94, v95
    v_mfma_f32_16x16x32_bf16 v[116:119], v[184:187], a[232:235], v[116:119]
    v_mfma_f32_16x16x32_bf16 v[124:127], v[184:187], a[236:239], v[124:127]
    v_mfma_f32_16x16x32_bf16 v[100:103], v[188:191], a[240:243], v[100:103]
    v_mfma_f32_16x16x32_bf16 v[108:111], v[188:191], a[244:247], v[108:111]
    v_mfma_f32_16x16x32_bf16 v[116:119], v[188:191], a[248:251], v[116:119]
    v_mfma_f32_16x16x32_bf16 v[124:127], v[188:191], a[252:255], v[124:127]
    s_waitcnt lgkmcnt(0)
    v_mfma_f32_16x16x32_bf16 a[0:3], v[64:67], v[160:163], a[0:3]
    v_exp_f32 v96, v96
    v_mfma_f32_16x16x32_bf16 a[48:51], v[72:75], v[160:163], a[48:51]
    ds_read_b128 v[176:179], v2 offset:4096
    ds_read_b128 v[180:183], v2 offset:5120
    v_exp_f32 v97, v97
    v_mfma_f32_16x16x32_bf16 a[96:99], v[80:83], v[160:163], a[96:99]
    v_exp_f32 v98, v98
    v_add_f32 v144, v144, v96
    v_mfma_f32_16x16x32_bf16 a[144:147], v[88:91], v[160:163], a[144:147]
    ds_read_b128 v[184:187], v2 offset:6144
    ds_read_b128 v[188:191], v2 offset:7168
    v_add_f32 v145, v145, v97
    v_mfma_f32_16x16x32_bf16 a[4:7], v[64:67], v[164:167], a[4:7]
    v_exp_f32 v99, v99
    v_cvt_pk_bf16_f32 v96, v96, v97
    v_mfma_f32_16x16x32_bf16 a[52:55], v[72:75], v[164:167], a[52:55]
    v_exp_f32 v100, v100
    v_add_f32 v144, v144, v98
    v_mfma_f32_16x16x32_bf16 a[100:103], v[80:83], v[164:167], a[100:103]
    v_exp_f32 v101, v101
    v_add_f32 v145, v145, v99
    v_mfma_f32_16x16x32_bf16 a[148:151], v[88:91], v[164:167], a[148:151]
    v_cvt_pk_bf16_f32 v97, v98, v99
    v_add_f32 v144, v144, v100
    v_add_f32 v145, v145, v101
    v_mfma_f32_16x16x32_bf16 a[8:11], v[64:67], v[168:171], a[8:11]
    v_exp_f32 v102, v102
    v_cvt_pk_bf16_f32 v98, v100, v101
    v_mfma_f32_16x16x32_bf16 a[56:59], v[72:75], v[168:171], a[56:59]
    v_exp_f32 v103, v103
    v_add_f32 v144, v144, v102
    v_mfma_f32_16x16x32_bf16 a[104:107], v[80:83], v[168:171], a[104:107]
    v_add_f32 v145, v145, v103
    v_cvt_pk_bf16_f32 v99, v102, v103
    v_mfma_f32_16x16x32_bf16 a[152:155], v[88:91], v[168:171], a[152:155]
    v_exp_f32 v104, v104
    v_mfma_f32_16x16x32_bf16 a[12:15], v[64:67], v[172:175], a[12:15]
    v_exp_f32 v105, v105
    v_add_f32 v146, v146, v104
    v_mfma_f32_16x16x32_bf16 a[60:63], v[72:75], v[172:175], a[60:63]
    v_exp_f32 v106, v106
    v_add_f32 v147, v147, v105
    v_mfma_f32_16x16x32_bf16 a[108:111], v[80:83], v[172:175], a[108:111]
    v_cvt_pk_bf16_f32 v104, v104, v105
    v_add_f32 v146, v146, v106
    v_mfma_f32_16x16x32_bf16 a[156:159], v[88:91], v[172:175], a[156:159]
    v_exp_f32 v107, v107
    s_waitcnt lgkmcnt(0)
    v_mfma_f32_16x16x32_bf16 a[16:19], v[64:67], v[176:179], a[16:19]
    v_exp_f32 v108, v108
    v_add_f32 v147, v147, v107
    v_mfma_f32_16x16x32_bf16 a[64:67], v[72:75], v[176:179], a[64:67]
    ds_read_b128 v[160:163], v2 offset:8192
    ds_read_b128 v[164:167], v2 offset:9216
    v_exp_f32 v109, v109
    v_mfma_f32_16x16x32_bf16 a[112:115], v[80:83], v[176:179], a[112:115]
    v_cvt_pk_bf16_f32 v105, v106, v107
    v_add_f32 v146, v146, v108
    v_add_f32 v147, v147, v109
    v_mfma_f32_16x16x32_bf16 a[160:163], v[88:91], v[176:179], a[160:163]
    ds_read_b128 v[168:171], v2 offset:10240
    ds_read_b128 v[172:175], v2 offset:11264
    v_exp_f32 v110, v110
    v_mfma_f32_16x16x32_bf16 a[20:23], v[64:67], v[180:183], a[20:23]
    v_exp_f32 v111, v111
    v_cvt_pk_bf16_f32 v106, v108, v109
    v_mfma_f32_16x16x32_bf16 a[68:71], v[72:75], v[180:183], a[68:71]
    v_add_f32 v146, v146, v110
    v_add_f32 v147, v147, v111
    v_cvt_pk_bf16_f32 v107, v110, v111
    v_mfma_f32_16x16x32_bf16 a[116:119], v[80:83], v[180:183], a[116:119]
    v_exp_f32 v112, v112
    v_mfma_f32_16x16x32_bf16 a[164:167], v[88:91], v[180:183], a[164:167]
    v_exp_f32 v113, v113
    v_add_f32 v148, v148, v112
    v_mfma_f32_16x16x32_bf16 a[24:27], v[64:67], v[184:187], a[24:27]
    v_exp_f32 v114, v114
    v_add_f32 v149, v149, v113
    v_mfma_f32_16x16x32_bf16 a[72:75], v[72:75], v[184:187], a[72:75]
    v_cvt_pk_bf16_f32 v112, v112, v113
    v_add_f32 v148, v148, v114
    v_mfma_f32_16x16x32_bf16 a[120:123], v[80:83], v[184:187], a[120:123]
    v_exp_f32 v115, v115
    v_mfma_f32_16x16x32_bf16 a[168:171], v[88:91], v[184:187], a[168:171]
    v_exp_f32 v116, v116
    v_add_f32 v149, v149, v115
    v_mfma_f32_16x16x32_bf16 a[28:31], v[64:67], v[188:191], a[28:31]
    v_exp_f32 v117, v117
    v_cvt_pk_bf16_f32 v113, v114, v115
    v_mfma_f32_16x16x32_bf16 a[76:79], v[72:75], v[188:191], a[76:79]
    v_add_f32 v148, v148, v116
    v_add_f32 v149, v149, v117
    v_cvt_pk_bf16_f32 v114, v116, v117
    v_mfma_f32_16x16x32_bf16 a[124:127], v[80:83], v[188:191], a[124:127]
    v_exp_f32 v118, v118
    v_mfma_f32_16x16x32_bf16 a[172:175], v[88:91], v[188:191], a[172:175]
    v_exp_f32 v119, v119
    s_waitcnt vmcnt(0) lgkmcnt(0)
    s_barrier
    v_mfma_f32_16x16x32_bf16 a[32:35], v[64:67], v[160:163], a[32:35]
    v_add_f32 v148, v148, v118
    v_add_f32 v149, v149, v119
    v_cvt_pk_bf16_f32 v115, v118, v119
    v_mfma_f32_16x16x32_bf16 a[80:83], v[72:75], v[160:163], a[80:83]
    ds_read_b128 v[176:179], v2 offset:24576
    ds_read_b128 v[180:183], v2 offset:25600
    v_exp_f32 v120, v120
    v_mfma_f32_16x16x32_bf16 a[128:131], v[80:83], v[160:163], a[128:131]
    v_exp_f32 v121, v121
    v_add_f32 v150, v150, v120
    v_mfma_f32_16x16x32_bf16 a[176:179], v[88:91], v[160:163], a[176:179]
    ds_read_b128 v[184:187], v2 offset:26624
    ds_read_b128 v[188:191], v2 offset:27648
    v_exp_f32 v122, v122
    v_mfma_f32_16x16x32_bf16 a[36:39], v[64:67], v[164:167], a[36:39]
    v_add_f32 v151, v151, v121
    v_cvt_pk_bf16_f32 v120, v120, v121
    v_add_f32 v150, v150, v122
    v_mfma_f32_16x16x32_bf16 a[84:87], v[72:75], v[164:167], a[84:87]
    v_exp_f32 v123, v123
    v_mfma_f32_16x16x32_bf16 a[132:135], v[80:83], v[164:167], a[132:135]
    v_exp_f32 v124, v124
    v_add_f32 v151, v151, v123
    v_mfma_f32_16x16x32_bf16 a[180:183], v[88:91], v[164:167], a[180:183]
    v_exp_f32 v125, v125
    v_cvt_pk_bf16_f32 v121, v122, v123
    v_mfma_f32_16x16x32_bf16 a[40:43], v[64:67], v[168:171], a[40:43]
    v_add_f32 v150, v150, v124
    v_add_f32 v151, v151, v125
    v_cvt_pk_bf16_f32 v122, v124, v125
    v_mfma_f32_16x16x32_bf16 a[88:91], v[72:75], v[168:171], a[88:91]
    v_exp_f32 v126, v126
    v_mfma_f32_16x16x32_bf16 a[136:139], v[80:83], v[168:171], a[136:139]
    v_exp_f32 v127, v127
    v_add_f32 v150, v150, v126
    v_mfma_f32_16x16x32_bf16 a[184:187], v[88:91], v[168:171], a[184:187]
    v_add_f32 v151, v151, v127
    v_cvt_pk_bf16_f32 v123, v126, v127
    v_mfma_f32_16x16x32_bf16 a[44:47], v[64:67], v[172:175], a[44:47]
    v_mfma_f32_16x16x32_bf16 a[92:95], v[72:75], v[172:175], a[92:95]
    v_mfma_f32_16x16x32_bf16 a[140:143], v[80:83], v[172:175], a[140:143]
    v_mfma_f32_16x16x32_bf16 a[188:191], v[88:91], v[172:175], a[188:191]
    s_mov_b32 s63, 1266679808
    s_mov_b32 s64, 864026624
    s_waitcnt lgkmcnt(0)
    v_mfma_f32_16x16x32_bf16 a[0:3], v[96:99], v[176:179], a[0:3]
    v_mfma_f32_16x16x32_bf16 a[48:51], v[104:107], v[176:179], a[48:51]
    ds_read_b128 v[160:163], v2 offset:28672
    ds_read_b128 v[164:167], v2 offset:29696
    v_mfma_f32_16x16x32_bf16 a[96:99], v[112:115], v[176:179], a[96:99]
    v_add_f32 v144, v144, v145
    v_add_f32 v146, v146, v147
    v_mfma_f32_16x16x32_bf16 a[144:147], v[120:123], v[176:179], a[144:147]
    ds_read_b128 v[168:171], v2 offset:30720
    ds_read_b128 v[172:175], v2 offset:31744
    v_mfma_f32_16x16x32_bf16 a[4:7], v[96:99], v[180:183], a[4:7]
    v_add_f32 v148, v148, v149
    v_add_f32 v150, v150, v151
    v_mfma_f32_16x16x32_bf16 a[52:55], v[104:107], v[180:183], a[52:55]
    v_mov_b32 v145, v144
    v_mov_b32 v147, v146
    v_mfma_f32_16x16x32_bf16 a[100:103], v[112:115], v[180:183], a[100:103]
    v_mov_b32 v149, v148
    v_mov_b32 v151, v150
    v_mfma_f32_16x16x32_bf16 a[148:151], v[120:123], v[180:183], a[148:151]
    v_permlane32_swap_b32 v144, v145
    v_permlane32_swap_b32 v146, v147
    v_mfma_f32_16x16x32_bf16 a[8:11], v[96:99], v[184:187], a[8:11]
    v_permlane32_swap_b32 v148, v149
    v_permlane32_swap_b32 v150, v151
    v_mfma_f32_16x16x32_bf16 a[56:59], v[104:107], v[184:187], a[56:59]
    v_add_f32 v144, v144, v145
    v_add_f32 v146, v146, v147
    v_mfma_f32_16x16x32_bf16 a[104:107], v[112:115], v[184:187], a[104:107]
    v_add_f32 v148, v148, v149
    v_add_f32 v150, v150, v151
    v_mfma_f32_16x16x32_bf16 a[152:155], v[120:123], v[184:187], a[152:155]
    v_mov_b32 v145, v144
    v_mov_b32 v147, v146
    v_mfma_f32_16x16x32_bf16 a[12:15], v[96:99], v[188:191], a[12:15]
    v_mov_b32 v149, v148
    v_mov_b32 v151, v150
    v_mfma_f32_16x16x32_bf16 a[60:63], v[104:107], v[188:191], a[60:63]
    v_permlane16_swap_b32 v144, v145
    v_permlane16_swap_b32 v146, v147
    v_mfma_f32_16x16x32_bf16 a[108:111], v[112:115], v[188:191], a[108:111]
    v_permlane16_swap_b32 v148, v149
    v_permlane16_swap_b32 v150, v151
    v_mfma_f32_16x16x32_bf16 a[156:159], v[120:123], v[188:191], a[156:159]
    v_add_f32 v144, v144, v145
    s_waitcnt lgkmcnt(0)
    v_mfma_f32_16x16x32_bf16 a[16:19], v[96:99], v[160:163], a[16:19]
    v_add_f32 v146, v146, v147
    v_add_f32 v148, v148, v149
    v_mfma_f32_16x16x32_bf16 a[64:67], v[104:107], v[160:163], a[64:67]
    ds_read_b128 v[176:179], v2 offset:32768
    ds_read_b128 v[180:183], v2 offset:33792
    v_mfma_f32_16x16x32_bf16 a[112:115], v[112:115], v[160:163], a[112:115]
    v_add_f32 v150, v150, v151
    v_max3_f32 v152, v144, v146, v148
    v_mfma_f32_16x16x32_bf16 a[160:163], v[120:123], v[160:163], a[160:163]
    ds_read_b128 v[184:187], v2 offset:34816
    ds_read_b128 v[188:191], v2 offset:35840
    v_mfma_f32_16x16x32_bf16 a[20:23], v[96:99], v[164:167], a[20:23]
    v_min3_f32 v153, v144, v146, v148
    v_max_f32 v152, v152, v150
    v_mfma_f32_16x16x32_bf16 a[68:71], v[104:107], v[164:167], a[68:71]
    v_min_f32 v153, v153, v150
    v_or3_b32 v56, v56, v57, v58
    v_mfma_f32_16x16x32_bf16 a[116:119], v[112:115], v[164:167], a[116:119]
    v_or_b32 v56, v56, v59
    v_cmp_nge_f32 s[66:67], s63, v152
    v_mfma_f32_16x16x32_bf16 a[164:167], v[120:123], v[164:167], a[164:167]
    v_cmp_nle_f32 s[68:69], s64, v153
    v_cmp_ne_u32 s[50:51], 0, v56
    v_mfma_f32_16x16x32_bf16 a[24:27], v[96:99], v[168:171], a[24:27]
    v_rcp_f32 v145, v144
    v_mfma_f32_16x16x32_bf16 a[72:75], v[104:107], v[168:171], a[72:75]
    v_rcp_f32 v147, v146
    v_mfma_f32_16x16x32_bf16 a[120:123], v[112:115], v[168:171], a[120:123]
    v_rcp_f32 v149, v148
    v_mfma_f32_16x16x32_bf16 a[168:171], v[120:123], v[168:171], a[168:171]
    v_rcp_f32 v151, v150
    v_mfma_f32_16x16x32_bf16 a[28:31], v[96:99], v[172:175], a[28:31]
    v_mfma_f32_16x16x32_bf16 a[76:79], v[104:107], v[172:175], a[76:79]
    ds_write_b32 v20, v145 offset:0
    ds_write_b32 v20, v147 offset:64
    v_mfma_f32_16x16x32_bf16 a[124:127], v[112:115], v[172:175], a[124:127]
    ds_write_b32 v20, v149 offset:128
    ds_write_b32 v20, v151 offset:192
    v_mfma_f32_16x16x32_bf16 a[172:175], v[120:123], v[172:175], a[172:175]
    s_waitcnt lgkmcnt(0)
    v_mfma_f32_16x16x32_bf16 a[32:35], v[96:99], v[176:179], a[32:35]
    v_mfma_f32_16x16x32_bf16 a[80:83], v[104:107], v[176:179], a[80:83]
    ds_read_b128 v[4:7], v21 offset:0
    ds_read_b128 v[8:11], v21 offset:64
    v_mfma_f32_16x16x32_bf16 a[128:131], v[112:115], v[176:179], a[128:131]
    ds_read_b128 v[12:15], v21 offset:128
    ds_read_b128 v[16:19], v21 offset:192
    v_mfma_f32_16x16x32_bf16 a[176:179], v[120:123], v[176:179], a[176:179]
    v_mfma_f32_16x16x32_bf16 a[36:39], v[96:99], v[180:183], a[36:39]
    v_mfma_f32_16x16x32_bf16 a[84:87], v[104:107], v[180:183], a[84:87]
    v_mfma_f32_16x16x32_bf16 a[132:135], v[112:115], v[180:183], a[132:135]
    v_mfma_f32_16x16x32_bf16 a[180:183], v[120:123], v[180:183], a[180:183]
    v_mfma_f32_16x16x32_bf16 a[40:43], v[96:99], v[184:187], a[40:43]
    v_mfma_f32_16x16x32_bf16 a[88:91], v[104:107], v[184:187], a[88:91]
    v_mfma_f32_16x16x32_bf16 a[136:139], v[112:115], v[184:187], a[136:139]
    v_mfma_f32_16x16x32_bf16 a[184:187], v[120:123], v[184:187], a[184:187]
    v_mfma_f32_16x16x32_bf16 a[44:47], v[96:99], v[188:191], a[44:47]
    v_mfma_f32_16x16x32_bf16 a[92:95], v[104:107], v[188:191], a[92:95]
    v_mfma_f32_16x16x32_bf16 a[140:143], v[112:115], v[188:191], a[140:143]
    v_mfma_f32_16x16x32_bf16 a[188:191], v[120:123], v[188:191], a[188:191]
    s_or_b64 s[66:67], s[66:67], s[68:69]
    s_or_b64 s[66:67], s[66:67], s[50:51]
    s_cbranch_scc1 SLOW
STORE:
    s_waitcnt lgkmcnt(0)
    s_nop 4
    v_accvgpr_read_b32 v24, a0
    v_accvgpr_read_b32 v25, a4
    v_accvgpr_read_b32 v26, a8
    v_accvgpr_read_b32 v27, a12
    v_accvgpr_read_b32 v28, a16
    v_accvgpr_read_b32 v29, a20
    v_accvgpr_read_b32 v30, a24
    v_accvgpr_read_b32 v31, a28
    v_accvgpr_read_b32 v32, a32
    v_accvgpr_read_b32 v33, a36
    v_accvgpr_read_b32 v34, a40
    v_accvgpr_read_b32 v35, a44
    v_pk_mul_f32 v[24:25], v[24:25], v[4:5] op_sel:[0,0] op_sel_hi:[1,0]
    v_pk_mul_f32 v[26:27], v[26:27], v[4:5] op_sel:[0,0] op_sel_hi:[1,0]
    v_pk_mul_f32 v[28:29], v[28:29], v[4:5] op_sel:[0,0] op_sel_hi:[1,0]
    v_pk_mul_f32 v[30:31], v[30:31], v[4:5] op_sel:[0,0] op_sel_hi:[1,0]
    v_pk_mul_f32 v[32:33], v[32:33], v[4:5] op_sel:[0,0] op_sel_hi:[1,0]
    v_pk_mul_f32 v[34:35], v[34:35], v[4:5] op_sel:[0,0] op_sel_hi:[1,0]
    v_cvt_pk_bf16_f32 v64, v24, v25
    v_cvt_pk_bf16_f32 v65, v26, v27
    v_cvt_pk_bf16_f32 v66, v28, v29
    v_cvt_pk_bf16_f32 v67, v30, v31
    v_cvt_pk_bf16_f32 v68, v32, v33
    v_cvt_pk_bf16_f32 v69, v34, v35
    buffer_store_dwordx2 v[64:65], v22, s[12:15], s23 offen offset:0 nt
    buffer_store_dwordx2 v[66:67], v22, s[12:15], s23 offen offset:128 nt
    buffer_store_dwordx2 v[68:69], v22, s[12:15], s23 offen offset:256 nt
    v_accvgpr_read_b32 v36, a1
    v_accvgpr_read_b32 v37, a5
    v_accvgpr_read_b32 v38, a9
    v_accvgpr_read_b32 v39, a13
    v_accvgpr_read_b32 v40, a17
    v_accvgpr_read_b32 v41, a21
    v_accvgpr_read_b32 v42, a25
    v_accvgpr_read_b32 v43, a29
    v_accvgpr_read_b32 v44, a33
    v_accvgpr_read_b32 v45, a37
    v_accvgpr_read_b32 v46, a41
    v_accvgpr_read_b32 v47, a45
    v_pk_mul_f32 v[36:37], v[36:37], v[4:5] op_sel:[0,1] op_sel_hi:[1,1]
    v_pk_mul_f32 v[38:39], v[38:39], v[4:5] op_sel:[0,1] op_sel_hi:[1,1]
    v_pk_mul_f32 v[40:41], v[40:41], v[4:5] op_sel:[0,1] op_sel_hi:[1,1]
    v_pk_mul_f32 v[42:43], v[42:43], v[4:5] op_sel:[0,1] op_sel_hi:[1,1]
    v_pk_mul_f32 v[44:45], v[44:45], v[4:5] op_sel:[0,1] op_sel_hi:[1,1]
    v_pk_mul_f32 v[46:47], v[46:47], v[4:5] op_sel:[0,1] op_sel_hi:[1,1]
    v_cvt_pk_bf16_f32 v72, v36, v37
    v_cvt_pk_bf16_f32 v73, v38, v39
    v_cvt_pk_bf16_f32 v74, v40, v41
    v_cvt_pk_bf16_f32 v75, v42, v43
    v_cvt_pk_bf16_f32 v76, v44, v45
    v_cvt_pk_bf16_f32 v77, v46, v47
    buffer_store_dwordx2 v[72:73], v22, s[12:15], s23 offen offset:384 nt
    buffer_store_dwordx2 v[74:75], v22, s[12:15], s23 offen offset:512 nt
    buffer_store_dwordx2 v[76:77], v22, s[12:15], s23 offen offset:640 nt
    v_accvgpr_read_b32 v48, a2
    v_accvgpr_read_b32 v49, a6
    v_accvgpr_read_b32 v50, a10
    v_accvgpr_read_b32 v51, a14
    v_accvgpr_read_b32 v52, a18
    v_accvgpr_read_b32 v53, a22
    v_accvgpr_read_b32 v54, a26
    v_accvgpr_read_b32 v55, a30
    v_accvgpr_read_b32 v56, a34
    v_accvgpr_read_b32 v57, a38
    v_accvgpr_read_b32 v58, a42
    v_accvgpr_read_b32 v59, a46
    v_pk_mul_f32 v[48:49], v[48:49], v[6:7] op_sel:[0,0] op_sel_hi:[1,0]
    v_pk_mul_f32 v[50:51], v[50:51], v[6:7] op_sel:[0,0] op_sel_hi:[1,0]
    v_pk_mul_f32 v[52:53], v[52:53], v[6:7] op_sel:[0,0] op_sel_hi:[1,0]
    v_pk_mul_f32 v[54:55], v[54:55], v[6:7] op_sel:[0,0] op_sel_hi:[1,0]
    v_pk_mul_f32 v[56:57], v[56:57], v[6:7] op_sel:[0,0] op_sel_hi:[1,0]
    v_pk_mul_f32 v[58:59], v[58:59], v[6:7] op_sel:[0,0] op_sel_hi:[1,0]
    v_cvt_pk_bf16_f32 v80, v48, v49
    v_cvt_pk_bf16_f32 v81, v50, v51
    v_cvt_pk_bf16_f32 v82, v52, v53
    v_cvt_pk_bf16_f32 v83, v54, v55
    v_cvt_pk_bf16_f32 v84, v56, v57
    v_cvt_pk_bf16_f32 v85, v58, v59
    buffer_store_dwordx2 v[80:81], v22, s[12:15], s23 offen offset:768 nt
    buffer_store_dwordx2 v[82:83], v22, s[12:15], s23 offen offset:896 nt
    buffer_store_dwordx2 v[84:85], v22, s[12:15], s23 offen offset:1024 nt
    v_accvgpr_read_b32 v24, a3
    v_accvgpr_read_b32 v25, a7
    v_accvgpr_read_b32 v26, a11
    v_accvgpr_read_b32 v27, a15
    v_accvgpr_read_b32 v28, a19
    v_accvgpr_read_b32 v29, a23
    v_accvgpr_read_b32 v30, a27
    v_accvgpr_read_b32 v31, a31
    v_accvgpr_read_b32 v32, a35
    v_accvgpr_read_b32 v33, a39
    v_accvgpr_read_b32 v34, a43
    v_accvgpr_read_b32 v35, a47
    v_pk_mul_f32 v[24:25], v[24:25], v[6:7] op_sel:[0,1] op_sel_hi:[1,1]
    v_pk_mul_f32 v[26:27], v[26:27], v[6:7] op_sel:[0,1] op_sel_hi:[1,1]
    v_pk_mul_f32 v[28:29], v[28:29], v[6:7] op_sel:[0,1] op_sel_hi:[1,1]
    v_pk_mul_f32 v[30:31], v[30:31], v[6:7] op_sel:[0,1] op_sel_hi:[1,1]
    v_pk_mul_f32 v[32:33], v[32:33], v[6:7] op_sel:[0,1] op_sel_hi:[1,1]
    v_pk_mul_f32 v[34:35], v[34:35], v[6:7] op_sel:[0,1] op_sel_hi:[1,1]
    v_cvt_pk_bf16_f32 v88, v24, v25
    v_cvt_pk_bf16_f32 v89, v26, v27
    v_cvt_pk_bf16_f32 v90, v28, v29
    v_cvt_pk_bf16_f32 v91, v30, v31
    v_cvt_pk_bf16_f32 v92, v32, v33
    v_cvt_pk_bf16_f32 v93, v34, v35
    buffer_store_dwordx2 v[88:89], v22, s[12:15], s23 offen offset:1152 nt
    buffer_store_dwordx2 v[90:91], v22, s[12:15], s23 offen offset:1280 nt
    buffer_store_dwordx2 v[92:93], v22, s[12:15], s23 offen offset:1408 nt
    v_accvgpr_read_b32 v36, a48
    v_accvgpr_read_b32 v37, a52
    v_accvgpr_read_b32 v38, a56
    v_accvgpr_read_b32 v39, a60
    v_accvgpr_read_b32 v40, a64
    v_accvgpr_read_b32 v41, a68
    v_accvgpr_read_b32 v42, a72
    v_accvgpr_read_b32 v43, a76
    v_accvgpr_read_b32 v44, a80
    v_accvgpr_read_b32 v45, a84
    v_accvgpr_read_b32 v46, a88
    v_accvgpr_read_b32 v47, a92
    v_pk_mul_f32 v[36:37], v[36:37], v[8:9] op_sel:[0,0] op_sel_hi:[1,0]
    v_pk_mul_f32 v[38:39], v[38:39], v[8:9] op_sel:[0,0] op_sel_hi:[1,0]
    v_pk_mul_f32 v[40:41], v[40:41], v[8:9] op_sel:[0,0] op_sel_hi:[1,0]
    v_pk_mul_f32 v[42:43], v[42:43], v[8:9] op_sel:[0,0] op_sel_hi:[1,0]
    v_pk_mul_f32 v[44:45], v[44:45], v[8:9] op_sel:[0,0] op_sel_hi:[1,0]
    v_pk_mul_f32 v[46:47], v[46:47], v[8:9] op_sel:[0,0] op_sel_hi:[1,0]
    v_cvt_pk_bf16_f32 v96, v36, v37
    v_cvt_pk_bf16_f32 v97, v38, v39
    v_cvt_pk_bf16_f32 v98, v40, v41
    v_cvt_pk_bf16_f32 v99, v42, v43
    v_cvt_pk_bf16_f32 v100, v44, v45
    v_cvt_pk_bf16_f32 v101, v46, v47
    buffer_store_dwordx2 v[96:97], v22, s[12:15], s54 offen offset:0 nt
    buffer_store_dwordx2 v[98:99], v22, s[12:15], s54 offen offset:128 nt
    buffer_store_dwordx2 v[100:101], v22, s[12:15], s54 offen offset:256 nt
    v_accvgpr_read_b32 v48, a49
    v_accvgpr_read_b32 v49, a53
    v_accvgpr_read_b32 v50, a57
    v_accvgpr_read_b32 v51, a61
    v_accvgpr_read_b32 v52, a65
    v_accvgpr_read_b32 v53, a69
    v_accvgpr_read_b32 v54, a73
    v_accvgpr_read_b32 v55, a77
    v_accvgpr_read_b32 v56, a81
    v_accvgpr_read_b32 v57, a85
    v_accvgpr_read_b32 v58, a89
    v_accvgpr_read_b32 v59, a93
    v_pk_mul_f32 v[48:49], v[48:49], v[8:9] op_sel:[0,1] op_sel_hi:[1,1]
    v_pk_mul_f32 v[50:51], v[50:51], v[8:9] op_sel:[0,1] op_sel_hi:[1,1]
    v_pk_mul_f32 v[52:53], v[52:53], v[8:9] op_sel:[0,1] op_sel_hi:[1,1]
    v_pk_mul_f32 v[54:55], v[54:55], v[8:9] op_sel:[0,1] op_sel_hi:[1,1]
    v_pk_mul_f32 v[56:57], v[56:57], v[8:9] op_sel:[0,1] op_sel_hi:[1,1]
    v_pk_mul_f32 v[58:59], v[58:59], v[8:9] op_sel:[0,1] op_sel_hi:[1,1]
    v_cvt_pk_bf16_f32 v104, v48, v49
    v_cvt_pk_bf16_f32 v105, v50, v51
    v_cvt_pk_bf16_f32 v106, v52, v53
    v_cvt_pk_bf16_f32 v107, v54, v55
    v_cvt_pk_bf16_f32 v108, v56, v57
    v_cvt_pk_bf16_f32 v109, v58, v59
    buffer_store_dwordx2 v[104:105], v22, s[12:15], s54 offen offset:384 nt
    buffer_store_dwordx2 v[106:107], v22, s[12:15], s54 offen offset:512 nt
    buffer_store_dwordx2 v[108:109], v22, s[12:15], s54 offen offset:640 nt
    v_accvgpr_read_b32 v24, a50
    v_accvgpr_read_b32 v25, a54
    v_accvgpr_read_b32 v26, a58
    v_accvgpr_read_b32 v27, a62
    v_accvgpr_read_b32 v28, a66
    v_accvgpr_read_b32 v29, a70
    v_accvgpr_read_b32 v30, a74
    v_accvgpr_read_b32 v31, a78
    v_accvgpr_read_b32 v32, a82
    v_accvgpr_read_b32 v33, a86
    v_accvgpr_read_b32 v34, a90
    v_accvgpr_read_b32 v35, a94
    v_pk_mul_f32 v[24:25], v[24:25], v[10:11] op_sel:[0,0] op_sel_hi:[1,0]
    v_pk_mul_f32 v[26:27], v[26:27], v[10:11] op_sel:[0,0] op_sel_hi:[1,0]
    v_pk_mul_f32 v[28:29], v[28:29], v[10:11] op_sel:[0,0] op_sel_hi:[1,0]
    v_pk_mul_f32 v[30:31], v[30:31], v[10:11] op_sel:[0,0] op_sel_hi:[1,0]
    v_pk_mul_f32 v[32:33], v[32:33], v[10:11] op_sel:[0,0] op_sel_hi:[1,0]
    v_pk_mul_f32 v[34:35], v[34:35], v[10:11] op_sel:[0,0] op_sel_hi:[1,0]
    v_cvt_pk_bf16_f32 v112, v24, v25
    v_cvt_pk_bf16_f32 v113, v26, v27
    v_cvt_pk_bf16_f32 v114, v28, v29
    v_cvt_pk_bf16_f32 v115, v30, v31
    v_cvt_pk_bf16_f32 v116, v32, v33
    v_cvt_pk_bf16_f32 v117, v34, v35
    buffer_store_dwordx2 v[112:113], v22, s[12:15], s54 offen offset:768 nt
    buffer_store_dwordx2 v[114:115], v22, s[12:15], s54 offen offset:896 nt
    buffer_store_dwordx2 v[116:117], v22, s[12:15], s54 offen offset:1024 nt
    v_accvgpr_read_b32 v36, a51
    v_accvgpr_read_b32 v37, a55
    v_accvgpr_read_b32 v38, a59
    v_accvgpr_read_b32 v39, a63
    v_accvgpr_read_b32 v40, a67
    v_accvgpr_read_b32 v41, a71
    v_accvgpr_read_b32 v42, a75
    v_accvgpr_read_b32 v43, a79
    v_accvgpr_read_b32 v44, a83
    v_accvgpr_read_b32 v45, a87
    v_accvgpr_read_b32 v46, a91
    v_accvgpr_read_b32 v47, a95
    v_pk_mul_f32 v[36:37], v[36:37], v[10:11] op_sel:[0,1] op_sel_hi:[1,1]
    v_pk_mul_f32 v[38:39], v[38:39], v[10:11] op_sel:[0,1] op_sel_hi:[1,1]
    v_pk_mul_f32 v[40:41], v[40:41], v[10:11] op_sel:[0,1] op_sel_hi:[1,1]
    v_pk_mul_f32 v[42:43], v[42:43], v[10:11] op_sel:[0,1] op_sel_hi:[1,1]
    v_pk_mul_f32 v[44:45], v[44:45], v[10:11] op_sel:[0,1] op_sel_hi:[1,1]
    v_pk_mul_f32 v[46:47], v[46:47], v[10:11] op_sel:[0,1] op_sel_hi:[1,1]
    v_cvt_pk_bf16_f32 v120, v36, v37
    v_cvt_pk_bf16_f32 v121, v38, v39
    v_cvt_pk_bf16_f32 v122, v40, v41
    v_cvt_pk_bf16_f32 v123, v42, v43
    v_cvt_pk_bf16_f32 v124, v44, v45
    v_cvt_pk_bf16_f32 v125, v46, v47
    buffer_store_dwordx2 v[120:121], v22, s[12:15], s54 offen offset:1152 nt
    buffer_store_dwordx2 v[122:123], v22, s[12:15], s54 offen offset:1280 nt
    buffer_store_dwordx2 v[124:125], v22, s[12:15], s54 offen offset:1408 nt
    v_accvgpr_read_b32 v48, a96
    v_accvgpr_read_b32 v49, a100
    v_accvgpr_read_b32 v50, a104
    v_accvgpr_read_b32 v51, a108
    v_accvgpr_read_b32 v52, a112
    v_accvgpr_read_b32 v53, a116
    v_accvgpr_read_b32 v54, a120
    v_accvgpr_read_b32 v55, a124
    v_accvgpr_read_b32 v56, a128
    v_accvgpr_read_b32 v57, a132
    v_accvgpr_read_b32 v58, a136
    v_accvgpr_read_b32 v59, a140
    v_pk_mul_f32 v[48:49], v[48:49], v[12:13] op_sel:[0,0] op_sel_hi:[1,0]
    v_pk_mul_f32 v[50:51], v[50:51], v[12:13] op_sel:[0,0] op_sel_hi:[1,0]
    v_pk_mul_f32 v[52:53], v[52:53], v[12:13] op_sel:[0,0] op_sel_hi:[1,0]
    v_pk_mul_f32 v[54:55], v[54:55], v[12:13] op_sel:[0,0] op_sel_hi:[1,0]
    v_pk_mul_f32 v[56:57], v[56:57], v[12:13] op_sel:[0,0] op_sel_hi:[1,0]
    v_pk_mul_f32 v[58:59], v[58:59], v[12:13] op_sel:[0,0] op_sel_hi:[1,0]
    v_cvt_pk_bf16_f32 v64, v48, v49
    v_cvt_pk_bf16_f32 v65, v50, v51
    v_cvt_pk_bf16_f32 v66, v52, v53
    v_cvt_pk_bf16_f32 v67, v54, v55
    v_cvt_pk_bf16_f32 v68, v56, v57
    v_cvt_pk_bf16_f32 v69, v58, v59
    buffer_store_dwordx2 v[64:65], v22, s[12:15], s55 offen offset:0 nt
    buffer_store_dwordx2 v[66:67], v22, s[12:15], s55 offen offset:128 nt
    buffer_store_dwordx2 v[68:69], v22, s[12:15], s55 offen offset:256 nt
    v_accvgpr_read_b32 v24, a97
    v_accvgpr_read_b32 v25, a101
    v_accvgpr_read_b32 v26, a105
    v_accvgpr_read_b32 v27, a109
    v_accvgpr_read_b32 v28, a113
    v_accvgpr_read_b32 v29, a117
    v_accvgpr_read_b32 v30, a121
    v_accvgpr_read_b32 v31, a125
    v_accvgpr_read_b32 v32, a129
    v_accvgpr_read_b32 v33, a133
    v_accvgpr_read_b32 v34, a137
    v_accvgpr_read_b32 v35, a141
    v_pk_mul_f32 v[24:25], v[24:25], v[12:13] op_sel:[0,1] op_sel_hi:[1,1]
    v_pk_mul_f32 v[26:27], v[26:27], v[12:13] op_sel:[0,1] op_sel_hi:[1,1]
    v_pk_mul_f32 v[28:29], v[28:29], v[12:13] op_sel:[0,1] op_sel_hi:[1,1]
    v_pk_mul_f32 v[30:31], v[30:31], v[12:13] op_sel:[0,1] op_sel_hi:[1,1]
    v_pk_mul_f32 v[32:33], v[32:33], v[12:13] op_sel:[0,1] op_sel_hi:[1,1]
    v_pk_mul_f32 v[34:35], v[34:35], v[12:13] op_sel:[0,1] op_sel_hi:[1,1]
    v_cvt_pk_bf16_f32 v72, v24, v25
    v_cvt_pk_bf16_f32 v73, v26, v27
    v_cvt_pk_bf16_f32 v74, v28, v29
    v_cvt_pk_bf16_f32 v75, v30, v31
    v_cvt_pk_bf16_f32 v76, v32, v33
    v_cvt_pk_bf16_f32 v77, v34, v35
    buffer_store_dwordx2 v[72:73], v22, s[12:15], s55 offen offset:384 nt
    buffer_store_dwordx2 v[74:75], v22, s[12:15], s55 offen offset:512 nt
    buffer_store_dwordx2 v[76:77], v22, s[12:15], s55 offen offset:640 nt
    v_accvgpr_read_b32 v36, a98
    v_accvgpr_read_b32 v37, a102
    v_accvgpr_read_b32 v38, a106
    v_accvgpr_read_b32 v39, a110
    v_accvgpr_read_b32 v40, a114
    v_accvgpr_read_b32 v41, a118
    v_accvgpr_read_b32 v42, a122
    v_accvgpr_read_b32 v43, a126
    v_accvgpr_read_b32 v44, a130
    v_accvgpr_read_b32 v45, a134
    v_accvgpr_read_b32 v46, a138
    v_accvgpr_read_b32 v47, a142
    v_pk_mul_f32 v[36:37], v[36:37], v[14:15] op_sel:[0,0] op_sel_hi:[1,0]
    v_pk_mul_f32 v[38:39], v[38:39], v[14:15] op_sel:[0,0] op_sel_hi:[1,0]
    v_pk_mul_f32 v[40:41], v[40:41], v[14:15] op_sel:[0,0] op_sel_hi:[1,0]
    v_pk_mul_f32 v[42:43], v[42:43], v[14:15] op_sel:[0,0] op_sel_hi:[1,0]
    v_pk_mul_f32 v[44:45], v[44:45], v[14:15] op_sel:[0,0] op_sel_hi:[1,0]
    v_pk_mul_f32 v[46:47], v[46:47], v[14:15] op_sel:[0,0] op_sel_hi:[1,0]
    v_cvt_pk_bf16_f32 v80, v36, v37
    v_cvt_pk_bf16_f32 v81, v38, v39
    v_cvt_pk_bf16_f32 v82, v40, v41
    v_cvt_pk_bf16_f32 v83, v42, v43
    v_cvt_pk_bf16_f32 v84, v44, v45
    v_cvt_pk_bf16_f32 v85, v46, v47
    buffer_store_dwordx2 v[80:81], v22, s[12:15], s55 offen offset:768 nt
    buffer_store_dwordx2 v[82:83], v22, s[12:15], s55 offen offset:896 nt
    buffer_store_dwordx2 v[84:85], v22, s[12:15], s55 offen offset:1024 nt
    v_accvgpr_read_b32 v48, a99
    v_accvgpr_read_b32 v49, a103
    v_accvgpr_read_b32 v50, a107
    v_accvgpr_read_b32 v51, a111
    v_accvgpr_read_b32 v52, a115
    v_accvgpr_read_b32 v53, a119
    v_accvgpr_read_b32 v54, a123
    v_accvgpr_read_b32 v55, a127
    v_accvgpr_read_b32 v56, a131
    v_accvgpr_read_b32 v57, a135
    v_accvgpr_read_b32 v58, a139
    v_accvgpr_read_b32 v59, a143
    v_pk_mul_f32 v[48:49], v[48:49], v[14:15] op_sel:[0,1] op_sel_hi:[1,1]
    v_pk_mul_f32 v[50:51], v[50:51], v[14:15] op_sel:[0,1] op_sel_hi:[1,1]
    v_pk_mul_f32 v[52:53], v[52:53], v[14:15] op_sel:[0,1] op_sel_hi:[1,1]
    v_pk_mul_f32 v[54:55], v[54:55], v[14:15] op_sel:[0,1] op_sel_hi:[1,1]
    v_pk_mul_f32 v[56:57], v[56:57], v[14:15] op_sel:[0,1] op_sel_hi:[1,1]
    v_pk_mul_f32 v[58:59], v[58:59], v[14:15] op_sel:[0,1] op_sel_hi:[1,1]
    v_cvt_pk_bf16_f32 v88, v48, v49
    v_cvt_pk_bf16_f32 v89, v50, v51
    v_cvt_pk_bf16_f32 v90, v52, v53
    v_cvt_pk_bf16_f32 v91, v54, v55
    v_cvt_pk_bf16_f32 v92, v56, v57
    v_cvt_pk_bf16_f32 v93, v58, v59
    buffer_store_dwordx2 v[88:89], v22, s[12:15], s55 offen offset:1152 nt
    buffer_store_dwordx2 v[90:91], v22, s[12:15], s55 offen offset:1280 nt
    buffer_store_dwordx2 v[92:93], v22, s[12:15], s55 offen offset:1408 nt
    v_accvgpr_read_b32 v24, a144
    v_accvgpr_read_b32 v25, a148
    v_accvgpr_read_b32 v26, a152
    v_accvgpr_read_b32 v27, a156
    v_accvgpr_read_b32 v28, a160
    v_accvgpr_read_b32 v29, a164
    v_accvgpr_read_b32 v30, a168
    v_accvgpr_read_b32 v31, a172
    v_accvgpr_read_b32 v32, a176
    v_accvgpr_read_b32 v33, a180
    v_accvgpr_read_b32 v34, a184
    v_accvgpr_read_b32 v35, a188
    v_pk_mul_f32 v[24:25], v[24:25], v[16:17] op_sel:[0,0] op_sel_hi:[1,0]
    v_pk_mul_f32 v[26:27], v[26:27], v[16:17] op_sel:[0,0] op_sel_hi:[1,0]
    v_pk_mul_f32 v[28:29], v[28:29], v[16:17] op_sel:[0,0] op_sel_hi:[1,0]
    v_pk_mul_f32 v[30:31], v[30:31], v[16:17] op_sel:[0,0] op_sel_hi:[1,0]
    v_pk_mul_f32 v[32:33], v[32:33], v[16:17] op_sel:[0,0] op_sel_hi:[1,0]
    v_pk_mul_f32 v[34:35], v[34:35], v[16:17] op_sel:[0,0] op_sel_hi:[1,0]
    v_cvt_pk_bf16_f32 v96, v24, v25
    v_cvt_pk_bf16_f32 v97, v26, v27
    v_cvt_pk_bf16_f32 v98, v28, v29
    v_cvt_pk_bf16_f32 v99, v30, v31
    v_cvt_pk_bf16_f32 v100, v32, v33
    v_cvt_pk_bf16_f32 v101, v34, v35
    buffer_store_dwordx2 v[96:97], v22, s[12:15], s56 offen offset:0 nt
    buffer_store_dwordx2 v[98:99], v22, s[12:15], s56 offen offset:128 nt
    buffer_store_dwordx2 v[100:101], v22, s[12:15], s56 offen offset:256 nt
    v_accvgpr_read_b32 v36, a145
    v_accvgpr_read_b32 v37, a149
    v_accvgpr_read_b32 v38, a153
    v_accvgpr_read_b32 v39, a157
    v_accvgpr_read_b32 v40, a161
    v_accvgpr_read_b32 v41, a165
    v_accvgpr_read_b32 v42, a169
    v_accvgpr_read_b32 v43, a173
    v_accvgpr_read_b32 v44, a177
    v_accvgpr_read_b32 v45, a181
    v_accvgpr_read_b32 v46, a185
    v_accvgpr_read_b32 v47, a189
    v_pk_mul_f32 v[36:37], v[36:37], v[16:17] op_sel:[0,1] op_sel_hi:[1,1]
    v_pk_mul_f32 v[38:39], v[38:39], v[16:17] op_sel:[0,1] op_sel_hi:[1,1]
    v_pk_mul_f32 v[40:41], v[40:41], v[16:17] op_sel:[0,1] op_sel_hi:[1,1]
    v_pk_mul_f32 v[42:43], v[42:43], v[16:17] op_sel:[0,1] op_sel_hi:[1,1]
    v_pk_mul_f32 v[44:45], v[44:45], v[16:17] op_sel:[0,1] op_sel_hi:[1,1]
    v_pk_mul_f32 v[46:47], v[46:47], v[16:17] op_sel:[0,1] op_sel_hi:[1,1]
    v_cvt_pk_bf16_f32 v104, v36, v37
    v_cvt_pk_bf16_f32 v105, v38, v39
    v_cvt_pk_bf16_f32 v106, v40, v41
    v_cvt_pk_bf16_f32 v107, v42, v43
    v_cvt_pk_bf16_f32 v108, v44, v45
    v_cvt_pk_bf16_f32 v109, v46, v47
    buffer_store_dwordx2 v[104:105], v22, s[12:15], s56 offen offset:384 nt
    buffer_store_dwordx2 v[106:107], v22, s[12:15], s56 offen offset:512 nt
    buffer_store_dwordx2 v[108:109], v22, s[12:15], s56 offen offset:640 nt
    v_accvgpr_read_b32 v48, a146
    v_accvgpr_read_b32 v49, a150
    v_accvgpr_read_b32 v50, a154
    v_accvgpr_read_b32 v51, a158
    v_accvgpr_read_b32 v52, a162
    v_accvgpr_read_b32 v53, a166
    v_accvgpr_read_b32 v54, a170
    v_accvgpr_read_b32 v55, a174
    v_accvgpr_read_b32 v56, a178
    v_accvgpr_read_b32 v57, a182
    v_accvgpr_read_b32 v58, a186
    v_accvgpr_read_b32 v59, a190
    v_pk_mul_f32 v[48:49], v[48:49], v[18:19] op_sel:[0,0] op_sel_hi:[1,0]
    v_pk_mul_f32 v[50:51], v[50:51], v[18:19] op_sel:[0,0] op_sel_hi:[1,0]
    v_pk_mul_f32 v[52:53], v[52:53], v[18:19] op_sel:[0,0] op_sel_hi:[1,0]
    v_pk_mul_f32 v[54:55], v[54:55], v[18:19] op_sel:[0,0] op_sel_hi:[1,0]
    v_pk_mul_f32 v[56:57], v[56:57], v[18:19] op_sel:[0,0] op_sel_hi:[1,0]
    v_pk_mul_f32 v[58:59], v[58:59], v[18:19] op_sel:[0,0] op_sel_hi:[1,0]
    v_cvt_pk_bf16_f32 v112, v48, v49
    v_cvt_pk_bf16_f32 v113, v50, v51
    v_cvt_pk_bf16_f32 v114, v52, v53
    v_cvt_pk_bf16_f32 v115, v54, v55
    v_cvt_pk_bf16_f32 v116, v56, v57
    v_cvt_pk_bf16_f32 v117, v58, v59
    buffer_store_dwordx2 v[112:113], v22, s[12:15], s56 offen offset:768 nt
    buffer_store_dwordx2 v[114:115], v22, s[12:15], s56 offen offset:896 nt
    buffer_store_dwordx2 v[116:117], v22, s[12:15], s56 offen offset:1024 nt
    v_accvgpr_read_b32 v24, a147
    v_accvgpr_read_b32 v25, a151
    v_accvgpr_read_b32 v26, a155
    v_accvgpr_read_b32 v27, a159
    v_accvgpr_read_b32 v28, a163
    v_accvgpr_read_b32 v29, a167
    v_accvgpr_read_b32 v30, a171
    v_accvgpr_read_b32 v31, a175
    v_accvgpr_read_b32 v32, a179
    v_accvgpr_read_b32 v33, a183
    v_accvgpr_read_b32 v34, a187
    v_accvgpr_read_b32 v35, a191
    v_pk_mul_f32 v[24:25], v[24:25], v[18:19] op_sel:[0,1] op_sel_hi:[1,1]
    v_pk_mul_f32 v[26:27], v[26:27], v[18:19] op_sel:[0,1] op_sel_hi:[1,1]
    v_pk_mul_f32 v[28:29], v[28:29], v[18:19] op_sel:[0,1] op_sel_hi:[1,1]
    v_pk_mul_f32 v[30:31], v[30:31], v[18:19] op_sel:[0,1] op_sel_hi:[1,1]
    v_pk_mul_f32 v[32:33], v[32:33], v[18:19] op_sel:[0,1] op_sel_hi:[1,1]
    v_pk_mul_f32 v[34:35], v[34:35], v[18:19] op_sel:[0,1] op_sel_hi:[1,1]
    v_cvt_pk_bf16_f32 v120, v24, v25
    v_cvt_pk_bf16_f32 v121, v26, v27
    v_cvt_pk_bf16_f32 v122, v28, v29
    v_cvt_pk_bf16_f32 v123, v30, v31
    v_cvt_pk_bf16_f32 v124, v32, v33
    v_cvt_pk_bf16_f32 v125, v34, v35
    buffer_store_dwordx2 v[120:121], v22, s[12:15], s56 offen offset:1152 nt
    buffer_store_dwordx2 v[122:123], v22, s[12:15], s56 offen offset:1280 nt
    buffer_store_dwordx2 v[124:125], v22, s[12:15], s56 offen offset:1408 nt
MAIN_END:
    s_endpgm
SPIN_A:
    s_cmp_lg_u32 s53, 0
    s_cbranch_scc1 RET_A
    s_mov_b32 s52, 1024
SPINL_A:
    buffer_load_dword v12, v13, s[40:43], 0 offen sc1
    s_waitcnt vmcnt(0)
    v_sub_u32 v12, v12, v11
    s_add_u32 s65, s65, 1
    v_cmp_lt_u32 vcc, 31, v12
    s_cbranch_vccz RET_A
    s_sub_u32 s52, s52, 1
    s_cmp_lg_u32 s52, 0
    s_cbranch_scc1 SPINL_A
    s_mov_b32 s10, 0
    s_mov_b32 s53, 1
    s_branch RET_A
SPIN_B:
    s_cmp_lg_u32 s53, 0
    s_cbranch_scc1 RET_B
    s_mov_b32 s52, 1024
SPINL_B:
    buffer_load_dword v12, v13, s[40:43], 0 offen sc1
    s_waitcnt vmcnt(0)
    v_sub_u32 v12, v12, v11
    s_add_u32 s65, s65, 1
    v_cmp_lt_u32 vcc, 31, v12
    s_cbranch_vccz RET_B
    s_sub_u32 s52, s52, 1
    s_cmp_lg_u32 s52, 0
    s_cbranch_scc1 SPINL_B
    s_mov_b32 s10, 0
    s_mov_b32 s53, 1
    s_branch RET_B
SPIN_T:
    s_cmp_lg_u32 s53, 0
    s_cbranch_scc1 RET_T
    s_mov_b32 s52, 1024
SPINL_T:
    buffer_load_dword v12, v13, s[40:43], 0 offen sc1
    s_waitcnt vmcnt(0)
    v_sub_u32 v12, v12, v11
    s_add_u32 s65, s65, 1
    v_cmp_lt_u32 vcc, 31, v12
    s_cbranch_vccz RET_T
    s_sub_u32 s52, s52, 1
    s_cmp_lg_u32 s52, 0
    s_cbranch_scc1 SPINL_T
    s_mov_b32 s10, 0
    s_mov_b32 s53, 1
    s_branch RET_T
SLOW:
    s_waitcnt vmcnt(0) lgkmcnt(0)
    s_load_dwordx16 s[72:87], s[0:1], 0
    s_mul_i32 s68, s17, 24576
    s_lshl_b32 s69, s17, 12
    s_lshl_b32 s71, s22, 1
    s_lshl_b32 s70, s16, 8
    s_add_u32 s70, s70, 98304
    v_and_b32 v15, 15, v0
    v_lshrrev_b32 v16, 4, v0
    v_lshrrev_b32 v17, 2, v15
    v_lshlrev_b32 v17, 2, v17
    v_add_u32 v17, v17, v15
    v_mul_u32_u24 v4, 768, v17
    v_lshl_add_u32 v4, v16, 5, v4
    v_lshlrev_b32 v5, 4, v16
    v_mul_u32_u24 v6, 6144, v16
    v_lshl_add_u32 v6, v15, 4, v6
    v_add_u32 v7, 3072, v6
    s_waitcnt lgkmcnt(0)
    s_add_u32 s24, s74, s71
    s_addc_u32 s25, s75, 0
    s_mov_b32 s26, 1572864
    s_mov_b32 s27, 0x00020000
    s_add_u32 s28, s78, s68
    s_addc_u32 s29, s79, 0
    s_mov_b32 s30, 24576
    s_mov_b32 s31, 0x00020000
    s_add_u32 s32, s80, s68
    s_addc_u32 s33, s81, 0
    s_mov_b32 s34, 24576
    s_mov_b32 s35, 0x00020000
    s_add_u32 s36, s76, s71
    s_addc_u32 s37, s77, 0
    s_mov_b32 s38, 1572864
    s_mov_b32 s39, 0x00020000
    s_add_u32 s40, s82, s69
    s_addc_u32 s41, s83, 0
    s_mov_b32 s42, 4096
    s_mov_b32 s43, 0x00020000
    s_add_u32 s44, s84, s69
    s_addc_u32 s45, s85, 0
    s_mov_b32 s46, 4096
    s_mov_b32 s47, 0x00020000
    v_mov_b32 v152, 0xff800000
    v_mov_b32 v153, 0xff800000
    v_mov_b32 v154, 0xff800000
    v_mov_b32 v155, 0xff800000
    s_mov_b32 s58, 0
    s_mov_b32 s59, 0
    s_mov_b32 s57, 64
SLOW1:
    buffer_load_dwordx4 v[24:27], v5, s[28:31], s59 offen offset:0
    buffer_load_dwordx4 v[28:31], v5, s[32:35], s59 offen offset:0
    buffer_load_dwordx4 v[224:227], v4, s[24:27], s58 offen offset:0
    buffer_load_dwordx4 v[228:231], v4, s[24:27], s58 offen offset:16
    buffer_load_dwordx4 v[232:235], v4, s[24:27], s58 offen offset:3072
    buffer_load_dwordx4 v[236:239], v4, s[24:27], s58 offen offset:3088
    s_waitcnt vmcnt(0)
    v_lshlrev_b32 v32, 16, v24
    v_and_b32 v33, s62, v24
    v_lshlrev_b32 v36, 16, v28
    v_and_b32 v37, s62, v28
    v_mul_f32 v32, s61, v32
    v_mul_f32 v33, s61, v33
    v_mul_f32 v36, -v36, v32
    v_mul_f32 v37, -v37, v33
    v_lshlrev_b32 v34, 16, v25
    v_and_b32 v35, s62, v25
    v_lshlrev_b32 v38, 16, v29
    v_and_b32 v39, s62, v29
    v_mul_f32 v34, s61, v34
    v_mul_f32 v35, s61, v35
    v_mul_f32 v38, -v38, v34
    v_mul_f32 v39, -v39, v35
    v_lshlrev_b32 v40, 16, v26
    v_and_b32 v41, s62, v26
    v_lshlrev_b32 v44, 16, v30
    v_and_b32 v45, s62, v30
    v_mul_f32 v40, s61, v40
    v_mul_f32 v41, s61, v41
    v_mul_f32 v44, -v44, v40
    v_mul_f32 v45, -v45, v41
    v_lshlrev_b32 v42, 16, v27
    v_and_b32 v43, s62, v27
    v_lshlrev_b32 v46, 16, v31
    v_and_b32 v47, s62, v31
    v_mul_f32 v42, s61, v42
    v_mul_f32 v43, s61, v43
    v_mul_f32 v46, -v46, v42
    v_mul_f32 v47, -v47, v43
    v_cvt_f32_i32 v224, v224
    v_cvt_f32_i32 v225, v225
    v_cvt_f32_i32 v226, v226
    v_cvt_f32_i32 v227, v227
    v_fma_f32 v224, v224, v32, v36
    v_fma_f32 v225, v225, v33, v37
    v_fma_f32 v226, v226, v34, v38
    v_fma_f32 v227, v227, v35, v39
    v_cvt_pk_bf16_f32 v160, v224, v225
    v_cvt_pk_bf16_f32 v161, v226, v227
    v_cvt_f32_i32 v228, v228
    v_cvt_f32_i32 v229, v229
    v_cvt_f32_i32 v230, v230
    v_cvt_f32_i32 v231, v231
    v_fma_f32 v228, v228, v40, v44
    v_fma_f32 v229, v229, v41, v45
    v_fma_f32 v230, v230, v42, v46
    v_fma_f32 v231, v231, v43, v47
    v_cvt_pk_bf16_f32 v162, v228, v229
    v_cvt_pk_bf16_f32 v163, v230, v231
    v_cvt_f32_i32 v232, v232
    v_cvt_f32_i32 v233, v233
    v_cvt_f32_i32 v234, v234
    v_cvt_f32_i32 v235, v235
    v_fma_f32 v232, v232, v32, v36
    v_fma_f32 v233, v233, v33, v37
    v_fma_f32 v234, v234, v34, v38
    v_fma_f32 v235, v235, v35, v39
    v_cvt_pk_bf16_f32 v164, v232, v233
    v_cvt_pk_bf16_f32 v165, v234, v235
    v_cvt_f32_i32 v236, v236
    v_cvt_f32_i32 v237, v237
    v_cvt_f32_i32 v238, v238
    v_cvt_f32_i32 v239, v239
    v_fma_f32 v236, v236, v40, v44
    v_fma_f32 v237, v237, v41, v45
    v_fma_f32 v238, v238, v42, v46
    v_fma_f32 v239, v239, v43, v47
    v_cvt_pk_bf16_f32 v166, v236, v237
    v_cvt_pk_bf16_f32 v167, v238, v239
    s_nop 1
    v_mfma_f32_16x16x32_bf16 v[64:67], v[160:163], v[192:195], 0
    v_mfma_f32_16x16x32_bf16 v[72:75], v[160:163], v[196:199], 0
    v_mfma_f32_16x16x32_bf16 v[80:83], v[160:163], v[200:203], 0
    v_mfma_f32_16x16x32_bf16 v[88:91], v[160:163], v[204:207], 0
    v_mfma_f32_16x16x32_bf16 v[68:71], v[164:167], v[192:195], 0
    v_mfma_f32_16x16x32_bf16 v[76:79], v[164:167], v[196:199], 0
    v_mfma_f32_16x16x32_bf16 v[84:87], v[164:167], v[200:203], 0
    v_mfma_f32_16x16x32_bf16 v[92:95], v[164:167], v[204:207], 0
    s_nop 7
    buffer_load_dwordx4 v[24:27], v5, s[28:31], s59 offen offset:64
    buffer_load_dwordx4 v[28:31], v5, s[32:35], s59 offen offset:64
    buffer_load_dwordx4 v[224:227], v4, s[24:27], s58 offen offset:128
    buffer_load_dwordx4 v[228:231], v4, s[24:27], s58 offen offset:144
    buffer_load_dwordx4 v[232:235], v4, s[24:27], s58 offen offset:3200
    buffer_load_dwordx4 v[236:239], v4, s[24:27], s58 offen offset:3216
    s_waitcnt vmcnt(0)
    v_lshlrev_b32 v32, 16, v24
    v_and_b32 v33, s62, v24
    v_lshlrev_b32 v36, 16, v28
    v_and_b32 v37, s62, v28
    v_mul_f32 v32, s61, v32
    v_mul_f32 v33, s61, v33
    v_mul_f32 v36, -v36, v32
    v_mul_f32 v37, -v37, v33
    v_lshlrev_b32 v34, 16, v25
    v_and_b32 v35, s62, v25
    v_lshlrev_b32 v38, 16, v29
    v_and_b32 v39, s62, v29
    v_mul_f32 v34, s61, v34
    v_mul_f32 v35, s61, v35
    v_mul_f32 v38, -v38, v34
    v_mul_f32 v39, -v39, v35
    v_lshlrev_b32 v40, 16, v26
    v_and_b32 v41, s62, v26
    v_lshlrev_b32 v44, 16, v30
    v_and_b32 v45, s62, v30
    v_mul_f32 v40, s61, v40
    v_mul_f32 v41, s61, v41
    v_mul_f32 v44, -v44, v40
    v_mul_f32 v45, -v45, v41
    v_lshlrev_b32 v42, 16, v27
    v_and_b32 v43, s62, v27
    v_lshlrev_b32 v46, 16, v31
    v_and_b32 v47, s62, v31
    v_mul_f32 v42, s61, v42
    v_mul_f32 v43, s61, v43
    v_mul_f32 v46, -v46, v42
    v_mul_f32 v47, -v47, v43
    v_cvt_f32_i32 v224, v224
    v_cvt_f32_i32 v225, v225
    v_cvt_f32_i32 v226, v226
    v_cvt_f32_i32 v227, v227
    v_fma_f32 v224, v224, v32, v36
    v_fma_f32 v225, v225, v33, v37
    v_fma_f32 v226, v226, v34, v38
    v_fma_f32 v227, v227, v35, v39
    v_cvt_pk_bf16_f32 v160, v224, v225
    v_cvt_pk_bf16_f32 v161, v226, v227
    v_cvt_f32_i32 v228, v228
    v_cvt_f32_i32 v229, v229
    v_cvt_f32_i32 v230, v230
    v_cvt_f32_i32 v231, v231
    v_fma_f32 v228, v228, v40, v44
    v_fma_f32 v229, v229, v41, v45
    v_fma_f32 v230, v230, v42, v46
    v_fma_f32 v231, v231, v43, v47
    v_cvt_pk_bf16_f32 v162, v228, v229
    v_cvt_pk_bf16_f32 v163, v230, v231
    v_cvt_f32_i32 v232, v232
    v_cvt_f32_i32 v233, v233
    v_cvt_f32_i32 v234, v234
    v_cvt_f32_i32 v235, v235
    v_fma_f32 v232, v232, v32, v36
    v_fma_f32 v233, v233, v33, v37
    v_fma_f32 v234, v234, v34, v38
    v_fma_f32 v235, v235, v35, v39
    v_cvt_pk_bf16_f32 v164, v232, v233
    v_cvt_pk_bf16_f32 v165, v234, v235
    v_cvt_f32_i32 v236, v236
    v_cvt_f32_i32 v237, v237
    v_cvt_f32_i32 v238, v238
    v_cvt_f32_i32 v239, v239
    v_fma_f32 v236, v236, v40, v44
    v_fma_f32 v237, v237, v41, v45
    v_fma_f32 v238, v238, v42, v46
    v_fma_f32 v239, v239, v43, v47
    v_cvt_pk_bf16_f32 v166, v236, v237
    v_cvt_pk_bf16_f32 v167, v238, v239
    s_nop 1
    v_mfma_f32_16x16x32_bf16 v[64:67], v[160:163], v[208:211], v[64:67]
    v_mfma_f32_16x16x32_bf16 v[72:75], v[160:163], v[212:215], v[72:75]
    v_mfma_f32_16x16x32_bf16 v[80:83], v[160:163], v[216:219], v[80:83]
    v_mfma_f32_16x16x32_bf16 v[88:91], v[160:163], v[220:223], v[88:91]
    v_mfma_f32_16x16x32_bf16 v[68:71], v[164:167], v[208:211], v[68:71]
    v_mfma_f32_16x16x32_bf16 v[76:79], v[164:167], v[212:215], v[76:79]
    v_mfma_f32_16x16x32_bf16 v[84:87], v[164:167], v[216:219], v[84:87]
    v_mfma_f32_16x16x32_bf16 v[92:95], v[164:167], v[220:223], v[92:95]
    s_nop 7
    buffer_load_dwordx4 v[24:27], v5, s[28:31], s59 offen offset:128
    buffer_load_dwordx4 v[28:31], v5, s[32:35], s59 offen offset:128
    buffer_load_dwordx4 v[224:227], v4, s[24:27], s58 offen offset:256
    buffer_load_dwordx4 v[228:231], v4, s[24:27], s58 offen offset:272
    buffer_load_dwordx4 v[232:235], v4, s[24:27], s58 offen offset:3328
    buffer_load_dwordx4 v[236:239], v4, s[24:27], s58 offen offset:3344
    s_waitcnt vmcnt(0)
    v_lshlrev_b32 v32, 16, v24
    v_and_b32 v33, s62, v24
    v_lshlrev_b32 v36, 16, v28
    v_and_b32 v37, s62, v28
    v_mul_f32 v32, s61, v32
    v_mul_f32 v33, s61, v33
    v_mul_f32 v36, -v36, v32
    v_mul_f32 v37, -v37, v33
    v_lshlrev_b32 v34, 16, v25
    v_and_b32 v35, s62, v25
    v_lshlrev_b32 v38, 16, v29
    v_and_b32 v39, s62, v29
    v_mul_f32 v34, s61, v34
    v_mul_f32 v35, s61, v35
    v_mul_f32 v38, -v38, v34
    v_mul_f32 v39, -v39, v35
    v_lshlrev_b32 v40, 16, v26
    v_and_b32 v41, s62, v26
    v_lshlrev_b32 v44, 16, v30
    v_and_b32 v45, s62, v30
    v_mul_f32 v40, s61, v40
    v_mul_f32 v41, s61, v41
    v_mul_f32 v44, -v44, v40
    v_mul_f32 v45, -v45, v41
    v_lshlrev_b32 v42, 16, v27
    v_and_b32 v43, s62, v27
    v_lshlrev_b32 v46, 16, v31
    v_and_b32 v47, s62, v31
    v_mul_f32 v42, s61, v42
    v_mul_f32 v43, s61, v43
    v_mul_f32 v46, -v46, v42
    v_mul_f32 v47, -v47, v43
    v_cvt_f32_i32 v224, v224
    v_cvt_f32_i32 v225, v225
    v_cvt_f32_i32 v226, v226
    v_cvt_f32_i32 v227, v227
    v_fma_f32 v224, v224, v32, v36
    v_fma_f32 v225, v225, v33, v37
    v_fma_f32 v226, v226, v34, v38
    v_fma_f32 v227, v227, v35, v39
    v_cvt_pk_bf16_f32 v160, v224, v225
    v_cvt_pk_bf16_f32 v161, v226, v227
    v_cvt_f32_i32 v228, v228
    v_cvt_f32_i32 v229, v229
    v_cvt_f32_i32 v230, v230
    v_cvt_f32_i32 v231, v231
    v_fma_f32 v228, v228, v40, v44
    v_fma_f32 v229, v229, v41, v45
    v_fma_f32 v230, v230, v42, v46
    v_fma_f32 v231, v231, v43, v47
    v_cvt_pk_bf16_f32 v162, v228, v229
    v_cvt_pk_bf16_f32 v163, v230, v231
    v_cvt_f32_i32 v232, v232
    v_cvt_f32_i32 v233, v233
    v_cvt_f32_i32 v234, v234
    v_cvt_f32_i32 v235, v235
    v_fma_f32 v232, v232, v32, v36
    v_fma_f32 v233, v233, v33, v37
    v_fma_f32 v234, v234, v34, v38
    v_fma_f32 v235, v235, v35, v39
    v_cvt_pk_bf16_f32 v164, v232, v233
    v_cvt_pk_bf16_f32 v165, v234, v235
    v_cvt_f32_i32 v236, v236
    v_cvt_f32_i32 v237, v237
    v_cvt_f32_i32 v238, v238
    v_cvt_f32_i32 v239, v239
    v_fma_f32 v236, v236, v40, v44
    v_fma_f32 v237, v237, v41, v45
    v_fma_f32 v238, v238, v42, v46
    v_fma_f32 v239, v239, v43, v47
    v_cvt_pk_bf16_f32 v166, v236, v237
    v_cvt_pk_bf16_f32 v167, v238, v239
    s_nop 1
    v_mfma_f32_16x16x32_bf16 v[64:67], v[160:163], a[192:195], v[64:67]
    v_mfma_f32_16x16x32_bf16 v[72:75], v[160:163], a[196:199], v[72:75]
    v_mfma_f32_16x16x32_bf16 v[80:83], v[160:163], a[200:203], v[80:83]
    v_mfma_f32_16x16x32_bf16 v[88:91], v[160:163], a[204:207], v[88:91]
    v_mfma_f32_16x16x32_bf16 v[68:71], v[164:167], a[192:195], v[68:71]
    v_mfma_f32_16x16x32_bf16 v[76:79], v[164:167], a[196:199], v[76:79]
    v_mfma_f32_16x16x32_bf16 v[84:87], v[164:167], a[200:203], v[84:87]
    v_mfma_f32_16x16x32_bf16 v[92:95], v[164:167], a[204:207], v[92:95]
    s_nop 7
    buffer_load_dwordx4 v[24:27], v5, s[28:31], s59 offen offset:192
    buffer_load_dwordx4 v[28:31], v5, s[32:35], s59 offen offset:192
    buffer_load_dwordx4 v[224:227], v4, s[24:27], s58 offen offset:384
    buffer_load_dwordx4 v[228:231], v4, s[24:27], s58 offen offset:400
    buffer_load_dwordx4 v[232:235], v4, s[24:27], s58 offen offset:3456
    buffer_load_dwordx4 v[236:239], v4, s[24:27], s58 offen offset:3472
    s_waitcnt vmcnt(0)
    v_lshlrev_b32 v32, 16, v24
    v_and_b32 v33, s62, v24
    v_lshlrev_b32 v36, 16, v28
    v_and_b32 v37, s62, v28
    v_mul_f32 v32, s61, v32
    v_mul_f32 v33, s61, v33
    v_mul_f32 v36, -v36, v32
    v_mul_f32 v37, -v37, v33
    v_lshlrev_b32 v34, 16, v25
    v_and_b32 v35, s62, v25
    v_lshlrev_b32 v38, 16, v29
    v_and_b32 v39, s62, v29
    v_mul_f32 v34, s61, v34
    v_mul_f32 v35, s61, v35
    v_mul_f32 v38, -v38, v34
    v_mul_f32 v39, -v39, v35
    v_lshlrev_b32 v40, 16, v26
    v_and_b32 v41, s62, v26
    v_lshlrev_b32 v44, 16, v30
    v_and_b32 v45, s62, v30
    v_mul_f32 v40, s61, v40
    v_mul_f32 v41, s61, v41
    v_mul_f32 v44, -v44, v40
    v_mul_f32 v45, -v45, v41
    v_lshlrev_b32 v42, 16, v27
    v_and_b32 v43, s62, v27
    v_lshlrev_b32 v46, 16, v31
    v_and_b32 v47, s62, v31
    v_mul_f32 v42, s61, v42
    v_mul_f32 v43, s61, v43
    v_mul_f32 v46, -v46, v42
    v_mul_f32 v47, -v47, v43
    v_cvt_f32_i32 v224, v224
    v_cvt_f32_i32 v225, v225
    v_cvt_f32_i32 v226, v226
    v_cvt_f32_i32 v227, v227
    v_fma_f32 v224, v224, v32, v36
    v_fma_f32 v225, v225, v33, v37
    v_fma_f32 v226, v226, v34, v38
    v_fma_f32 v227, v227, v35, v39
    v_cvt_pk_bf16_f32 v160, v224, v225
    v_cvt_pk_bf16_f32 v161, v226, v227
    v_cvt_f32_i32 v228, v228
    v_cvt_f32_i32 v229, v229
    v_cvt_f32_i32 v230, v230
    v_cvt_f32_i32 v231, v231
    v_fma_f32 v228, v228, v40, v44
    v_fma_f32 v229, v229, v41, v45
    v_fma_f32 v230, v230, v42, v46
    v_fma_f32 v231, v231, v43, v47
    v_cvt_pk_bf16_f32 v162, v228, v229
    v_cvt_pk_bf16_f32 v163, v230, v231
    v_cvt_f32_i32 v232, v232
    v_cvt_f32_i32 v233, v233
    v_cvt_f32_i32 v234, v234
    v_cvt_f32_i32 v235, v235
    v_fma_f32 v232, v232, v32, v36
    v_fma_f32 v233, v233, v33, v37
    v_fma_f32 v234, v234, v34, v38
    v_fma_f32 v235, v235, v35, v39
    v_cvt_pk_bf16_f32 v164, v232, v233
    v_cvt_pk_bf16_f32 v165, v234, v235
    v_cvt_f32_i32 v236, v236
    v_cvt_f32_i32 v237, v237
    v_cvt_f32_i32 v238, v238
    v_cvt_f32_i32 v239, v239
    v_fma_f32 v236, v236, v40, v44
    v_fma_f32 v237, v237, v41, v45
    v_fma_f32 v238, v238, v42, v46
    v_fma_f32 v239, v239, v43, v47
    v_cvt_pk_bf16_f32 v166, v236, v237
    v_cvt_pk_bf16_f32 v167, v238, v239
    s_nop 1
    v_mfma_f32_16x16x32_bf16 v[64:67], v[160:163], a[208:211], v[64:67]
    v_mfma_f32_16x16x32_bf16 v[72:75], v[160:163], a[212:215], v[72:75]
    v_mfma_f32_16x16x32_bf16 v[80:83], v[160:163], a[216:219], v[80:83]
    v_mfma_f32_16x16x32_bf16 v[88:91], v[160:163], a[220:223], v[88:91]
    v_mfma_f32_16x16x32_bf16 v[68:71], v[164:167], a[208:211], v[68:71]
    v_mfma_f32_16x16x32_bf16 v[76:79], v[164:167], a[212:215], v[76:79]
    v_mfma_f32_16x16x32_bf16 v[84:87], v[164:167], a[216:219], v[84:87]
    v_mfma_f32_16x16x32_bf16 v[92:95], v[164:167], a[220:223], v[92:95]
    s_nop 7
    buffer_load_dwordx4 v[24:27], v5, s[28:31], s59 offen offset:256
    buffer_load_dwordx4 v[28:31], v5, s[32:35], s59 offen offset:256
    buffer_load_dwordx4 v[224:227], v4, s[24:27], s58 offen offset:512
    buffer_load_dwordx4 v[228:231], v4, s[24:27], s58 offen offset:528
    buffer_load_dwordx4 v[232:235], v4, s[24:27], s58 offen offset:3584
    buffer_load_dwordx4 v[236:239], v4, s[24:27], s58 offen offset:3600
    s_waitcnt vmcnt(0)
    v_lshlrev_b32 v32, 16, v24
    v_and_b32 v33, s62, v24
    v_lshlrev_b32 v36, 16, v28
    v_and_b32 v37, s62, v28
    v_mul_f32 v32, s61, v32
    v_mul_f32 v33, s61, v33
    v_mul_f32 v36, -v36, v32
    v_mul_f32 v37, -v37, v33
    v_lshlrev_b32 v34, 16, v25
    v_and_b32 v35, s62, v25
    v_lshlrev_b32 v38, 16, v29
    v_and_b32 v39, s62, v29
    v_mul_f32 v34, s61, v34
    v_mul_f32 v35, s61, v35
    v_mul_f32 v38, -v38, v34
    v_mul_f32 v39, -v39, v35
    v_lshlrev_b32 v40, 16, v26
    v_and_b32 v41, s62, v26
    v_lshlrev_b32 v44, 16, v30
    v_and_b32 v45, s62, v30
    v_mul_f32 v40, s61, v40
    v_mul_f32 v41, s61, v41
    v_mul_f32 v44, -v44, v40
    v_mul_f32 v45, -v45, v41
    v_lshlrev_b32 v42, 16, v27
    v_and_b32 v43, s62, v27
    v_lshlrev_b32 v46, 16, v31
    v_and_b32 v47, s62, v31
    v_mul_f32 v42, s61, v42
    v_mul_f32 v43, s61, v43
    v_mul_f32 v46, -v46, v42
    v_mul_f32 v47, -v47, v43
    v_cvt_f32_i32 v224, v224
    v_cvt_f32_i32 v225, v225
    v_cvt_f32_i32 v226, v226
    v_cvt_f32_i32 v227, v227
    v_fma_f32 v224, v224, v32, v36
    v_fma_f32 v225, v225, v33, v37
    v_fma_f32 v226, v226, v34, v38
    v_fma_f32 v227, v227, v35, v39
    v_cvt_pk_bf16_f32 v160, v224, v225
    v_cvt_pk_bf16_f32 v161, v226, v227
    v_cvt_f32_i32 v228, v228
    v_cvt_f32_i32 v229, v229
    v_cvt_f32_i32 v230, v230
    v_cvt_f32_i32 v231, v231
    v_fma_f32 v228, v228, v40, v44
    v_fma_f32 v229, v229, v41, v45
    v_fma_f32 v230, v230, v42, v46
    v_fma_f32 v231, v231, v43, v47
    v_cvt_pk_bf16_f32 v162, v228, v229
    v_cvt_pk_bf16_f32 v163, v230, v231
    v_cvt_f32_i32 v232, v232
    v_cvt_f32_i32 v233, v233
    v_cvt_f32_i32 v234, v234
    v_cvt_f32_i32 v235, v235
    v_fma_f32 v232, v232, v32, v36
    v_fma_f32 v233, v233, v33, v37
    v_fma_f32 v234, v234, v34, v38
    v_fma_f32 v235, v235, v35, v39
    v_cvt_pk_bf16_f32 v164, v232, v233
    v_cvt_pk_bf16_f32 v165, v234, v235
    v_cvt_f32_i32 v236, v236
    v_cvt_f32_i32 v237, v237
    v_cvt_f32_i32 v238, v238
    v_cvt_f32_i32 v239, v239
    v_fma_f32 v236, v236, v40, v44
    v_fma_f32 v237, v237, v41, v45
    v_fma_f32 v238, v238, v42, v46
    v_fma_f32 v239, v239, v43, v47
    v_cvt_pk_bf16_f32 v166, v236, v237
    v_cvt_pk_bf16_f32 v167, v238, v239
    s_nop 1
    v_mfma_f32_16x16x32_bf16 v[64:67], v[160:163], a[224:227], v[64:67]
    v_mfma_f32_16x16x32_bf16 v[72:75], v[160:163], a[228:231], v[72:75]
    v_mfma_f32_16x16x32_bf16 v[80:83], v[160:163], a[232:235], v[80:83]
    v_mfma_f32_16x16x32_bf16 v[88:91], v[160:163], a[236:239], v[88:91]
    v_mfma_f32_16x16x32_bf16 v[68:71], v[164:167], a[224:227], v[68:71]
    v_mfma_f32_16x16x32_bf16 v[76:79], v[164:167], a[228:231], v[76:79]
    v_mfma_f32_16x16x32_bf16 v[84:87], v[164:167], a[232:235], v[84:87]
    v_mfma_f32_16x16x32_bf16 v[92:95], v[164:167], a[236:239], v[92:95]
    s_nop 7
    buffer_load_dwordx4 v[24:27], v5, s[28:31], s59 offen offset:320
    buffer_load_dwordx4 v[28:31], v5, s[32:35], s59 offen offset:320
    buffer_load_dwordx4 v[224:227], v4, s[24:27], s58 offen offset:640
    buffer_load_dwordx4 v[228:231], v4, s[24:27], s58 offen offset:656
    buffer_load_dwordx4 v[232:235], v4, s[24:27], s58 offen offset:3712
    buffer_load_dwordx4 v[236:239], v4, s[24:27], s58 offen offset:3728
    s_waitcnt vmcnt(0)
    v_lshlrev_b32 v32, 16, v24
    v_and_b32 v33, s62, v24
    v_lshlrev_b32 v36, 16, v28
    v_and_b32 v37, s62, v28
    v_mul_f32 v32, s61, v32
    v_mul_f32 v33, s61, v33
    v_mul_f32 v36, -v36, v32
    v_mul_f32 v37, -v37, v33
    v_lshlrev_b32 v34, 16, v25
    v_and_b32 v35, s62, v25
    v_lshlrev_b32 v38, 16, v29
    v_and_b32 v39, s62, v29
    v_mul_f32 v34, s61, v34
    v_mul_f32 v35, s61, v35
    v_mul_f32 v38, -v38, v34
    v_mul_f32 v39, -v39, v35
    v_lshlrev_b32 v40, 16, v26
    v_and_b32 v41, s62, v26
    v_lshlrev_b32 v44, 16, v30
    v_and_b32 v45, s62, v30
    v_mul_f32 v40, s61, v40
    v_mul_f32 v41, s61, v41
    v_mul_f32 v44, -v44, v40
    v_mul_f32 v45, -v45, v41
    v_lshlrev_b32 v42, 16, v27
    v_and_b32 v43, s62, v27
    v_lshlrev_b32 v46, 16, v31
    v_and_b32 v47, s62, v31
    v_mul_f32 v42, s61, v42
    v_mul_f32 v43, s61, v43
    v_mul_f32 v46, -v46, v42
    v_mul_f32 v47, -v47, v43
    v_cvt_f32_i32 v224, v224
    v_cvt_f32_i32 v225, v225
    v_cvt_f32_i32 v226, v226
    v_cvt_f32_i32 v227, v227
    v_fma_f32 v224, v224, v32, v36
    v_fma_f32 v225, v225, v33, v37
    v_fma_f32 v226, v226, v34, v38
    v_fma_f32 v227, v227, v35, v39
    v_cvt_pk_bf16_f32 v160, v224, v225
    v_cvt_pk_bf16_f32 v161, v226, v227
    v_cvt_f32_i32 v228, v228
    v_cvt_f32_i32 v229, v229
    v_cvt_f32_i32 v230, v230
    v_cvt_f32_i32 v231, v231
    v_fma_f32 v228, v228, v40, v44
    v_fma_f32 v229, v229, v41, v45
    v_fma_f32 v230, v230, v42, v46
    v_fma_f32 v231, v231, v43, v47
    v_cvt_pk_bf16_f32 v162, v228, v229
    v_cvt_pk_bf16_f32 v163, v230, v231
    v_cvt_f32_i32 v232, v232
    v_cvt_f32_i32 v233, v233
    v_cvt_f32_i32 v234, v234
    v_cvt_f32_i32 v235, v235
    v_fma_f32 v232, v232, v32, v36
    v_fma_f32 v233, v233, v33, v37
    v_fma_f32 v234, v234, v34, v38
    v_fma_f32 v235, v235, v35, v39
    v_cvt_pk_bf16_f32 v164, v232, v233
    v_cvt_pk_bf16_f32 v165, v234, v235
    v_cvt_f32_i32 v236, v236
    v_cvt_f32_i32 v237, v237
    v_cvt_f32_i32 v238, v238
    v_cvt_f32_i32 v239, v239
    v_fma_f32 v236, v236, v40, v44
    v_fma_f32 v237, v237, v41, v45
    v_fma_f32 v238, v238, v42, v46
    v_fma_f32 v239, v239, v43, v47
    v_cvt_pk_bf16_f32 v166, v236, v237
    v_cvt_pk_bf16_f32 v167, v238, v239
    s_nop 1
    v_mfma_f32_16x16x32_bf16 v[64:67], v[160:163], a[240:243], v[64:67]
    v_mfma_f32_16x16x32_bf16 v[72:75], v[160:163], a[244:247], v[72:75]
    v_mfma_f32_16x16x32_bf16 v[80:83], v[160:163], a[248:251], v[80:83]
    v_mfma_f32_16x16x32_bf16 v[88:91], v[160:163], a[252:255], v[88:91]
    v_mfma_f32_16x16x32_bf16 v[68:71], v[164:167], a[240:243], v[68:71]
    v_mfma_f32_16x16x32_bf16 v[76:79], v[164:167], a[244:247], v[76:79]
    v_mfma_f32_16x16x32_bf16 v[84:87], v[164:167], a[248:251], v[84:87]
    v_mfma_f32_16x16x32_bf16 v[92:95], v[164:167], a[252:255], v[92:95]
    s_nop 7
    v_max3_f32 v152, v152, v64, v65
    v_max3_f32 v152, v152, v66, v67
    v_max3_f32 v152, v152, v68, v69
    v_max3_f32 v152, v152, v70, v71
    v_max3_f32 v153, v153, v72, v73
    v_max3_f32 v153, v153, v74, v75
    v_max3_f32 v153, v153, v76, v77
    v_max3_f32 v153, v153, v78, v79
    v_max3_f32 v154, v154, v80, v81
    v_max3_f32 v154, v154, v82, v83
    v_max3_f32 v154, v154, v84, v85
    v_max3_f32 v154, v154, v86, v87
    v_max3_f32 v155, v155, v88, v89
    v_max3_f32 v155, v155, v90, v91
    v_max3_f32 v155, v155, v92, v93
    v_max3_f32 v155, v155, v94, v95
    s_add_u32 s58, s58, 24576
    s_add_u32 s59, s59, 384
    s_sub_u32 s57, s57, 1
    s_cmp_lg_u32 s57, 0
    s_cbranch_scc1 SLOW1
    v_mov_b32 v156, v152
    v_mov_b32 v157, v153
    v_mov_b32 v158, v154
    v_mov_b32 v159, v155
    s_nop 1
    v_permlane32_swap_b32 v152, v156
    v_permlane32_swap_b32 v153, v157
    v_permlane32_swap_b32 v154, v158
    v_permlane32_swap_b32 v155, v159
    s_nop 1
    v_max_f32 v152, v152, v156
    v_max_f32 v153, v153, v157
    v_max_f32 v154, v154, v158
    v_max_f32 v155, v155, v159
    v_mov_b32 v156, v152
    v_mov_b32 v157, v153
    v_mov_b32 v158, v154
    v_mov_b32 v159, v155
    s_nop 1
    v_permlane16_swap_b32 v152, v156
    v_permlane16_swap_b32 v153, v157
    v_permlane16_swap_b32 v154, v158
    v_permlane16_swap_b32 v155, v159
    s_nop 1
    v_max_f32 v152, v152, v156
    v_max_f32 v153, v153, v157
    v_max_f32 v154, v154, v158
    v_max_f32 v155, v155, v159
    v_sub_f32 v128, 0, v152
    v_sub_f32 v129, 0, v152
    v_sub_f32 v130, 0, v152
    v_sub_f32 v131, 0, v152
    v_sub_f32 v132, 0, v153
    v_sub_f32 v133, 0, v153
    v_sub_f32 v134, 0, v153
    v_sub_f32 v135, 0, v153
    v_sub_f32 v136, 0, v154
    v_sub_f32 v137, 0, v154
    v_sub_f32 v138, 0, v154
    v_sub_f32 v139, 0, v154
    v_sub_f32 v140, 0, v155
    v_sub_f32 v141, 0, v155
    v_sub_f32 v142, 0, v155
    v_sub_f32 v143, 0, v155
    v_accvgpr_write_b32 a0, 0
    v_accvgpr_write_b32 a1, 0
    v_accvgpr_write_b32 a2, 0
    v_accvgpr_write_b32 a3, 0
    v_accvgpr_write_b32 a4, 0
    v_accvgpr_write_b32 a5, 0
    v_accvgpr_write_b32 a6, 0
    v_accvgpr_write_b32 a7, 0
    v_accvgpr_write_b32 a8, 0
    v_accvgpr_write_b32 a9, 0
    v_accvgpr_write_b32 a10, 0
    v_accvgpr_write_b32 a11, 0
    v_accvgpr_write_b32 a12, 0
    v_accvgpr_write_b32 a13, 0
    v_accvgpr_write_b32 a14, 0
    v_accvgpr_write_b32 a15, 0
    v_accvgpr_write_b32 a16, 0
    v_accvgpr_write_b32 a17, 0
    v_accvgpr_write_b32 a18, 0
    v_accvgpr_write_b32 a19, 0
    v_accvgpr_write_b32 a20, 0
    v_accvgpr_write_b32 a21, 0
    v_accvgpr_write_b32 a22, 0
    v_accvgpr_write_b32 a23, 0
    v_accvgpr_write_b32 a24, 0
    v_accvgpr_write_b32 a25, 0
    v_accvgpr_write_b32 a26, 0
    v_accvgpr_write_b32 a27, 0
    v_accvgpr_write_b32 a28, 0
    v_accvgpr_write_b32 a29, 0
    v_accvgpr_write_b32 a30, 0
    v_accvgpr_write_b32 a31, 0
    v_accvgpr_write_b32 a32, 0
    v_accvgpr_write_b32 a33, 0
    v_accvgpr_write_b32 a34, 0
    v_accvgpr_write_b32 a35, 0
    v_accvgpr_write_b32 a36, 0
    v_accvgpr_write_b32 a37, 0
    v_accvgpr_write_b32 a38, 0
    v_accvgpr_write_b32 a39, 0
    v_accvgpr_write_b32 a40, 0
    v_accvgpr_write_b32 a41, 0
    v_accvgpr_write_b32 a42, 0
    v_accvgpr_write_b32 a43, 0
    v_accvgpr_write_b32 a44, 0
    v_accvgpr_write_b32 a45, 0
    v_accvgpr_write_b32 a46, 0
    v_accvgpr_write_b32 a47, 0
    v_accvgpr_write_b32 a48, 0
    v_accvgpr_write_b32 a49, 0
    v_accvgpr_write_b32 a50, 0
    v_accvgpr_write_b32 a51, 0
    v_accvgpr_write_b32 a52, 0
    v_accvgpr_write_b32 a53, 0
    v_accvgpr_write_b32 a54, 0
    v_accvgpr_write_b32 a55, 0
    v_accvgpr_write_b32 a56, 0
    v_accvgpr_write_b32 a57, 0
    v_accvgpr_write_b32 a58, 0
    v_accvgpr_write_b32 a59, 0
    v_accvgpr_write_b32 a60, 0
    v_accvgpr_write_b32 a61, 0
    v_accvgpr_write_b32 a62, 0
    v_accvgpr_write_b32 a63, 0
    v_accvgpr_write_b32 a64, 0
    v_accvgpr_write_b32 a65, 0
    v_accvgpr_write_b32 a66, 0
    v_accvgpr_write_b32 a67, 0
    v_accvgpr_write_b32 a68, 0
    v_accvgpr_write_b32 a69, 0
    v_accvgpr_write_b32 a70, 0
    v_accvgpr_write_b32 a71, 0
    v_accvgpr_write_b32 a72, 0
    v_accvgpr_write_b32 a73, 0
    v_accvgpr_write_b32 a74, 0
    v_accvgpr_write_b32 a75, 0
    v_accvgpr_write_b32 a76, 0
    v_accvgpr_write_b32 a77, 0
    v_accvgpr_write_b32 a78, 0
    v_accvgpr_write_b32 a79, 0
    v_accvgpr_write_b32 a80, 0
    v_accvgpr_write_b32 a81, 0
    v_accvgpr_write_b32 a82, 0
    v_accvgpr_write_b32 a83, 0
    v_accvgpr_write_b32 a84, 0
    v_accvgpr_write_b32 a85, 0
    v_accvgpr_write_b32 a86, 0
    v_accvgpr_write_b32 a87, 0
    v_accvgpr_write_b32 a88, 0
    v_accvgpr_write_b32 a89, 0
    v_accvgpr_write_b32 a90, 0
    v_accvgpr_write_b32 a91, 0
    v_accvgpr_write_b32 a92, 0
    v_accvgpr_write_b32 a93, 0
    v_accvgpr_write_b32 a94, 0
    v_accvgpr_write_b32 a95, 0
    v_accvgpr_write_b32 a96, 0
    v_accvgpr_write_b32 a97, 0
    v_accvgpr_write_b32 a98, 0
    v_accvgpr_write_b32 a99, 0
    v_accvgpr_write_b32 a100, 0
    v_accvgpr_write_b32 a101, 0
    v_accvgpr_write_b32 a102, 0
    v_accvgpr_write_b32 a103, 0
    v_accvgpr_write_b32 a104, 0
    v_accvgpr_write_b32 a105, 0
    v_accvgpr_write_b32 a106, 0
    v_accvgpr_write_b32 a107, 0
    v_accvgpr_write_b32 a108, 0
    v_accvgpr_write_b32 a109, 0
    v_accvgpr_write_b32 a110, 0
    v_accvgpr_write_b32 a111, 0
    v_accvgpr_write_b32 a112, 0
    v_accvgpr_write_b32 a113, 0
    v_accvgpr_write_b32 a114, 0
    v_accvgpr_write_b32 a115, 0
    v_accvgpr_write_b32 a116, 0
    v_accvgpr_write_b32 a117, 0
    v_accvgpr_write_b32 a118, 0
    v_accvgpr_write_b32 a119, 0
    v_accvgpr_write_b32 a120, 0
    v_accvgpr_write_b32 a121, 0
    v_accvgpr_write_b32 a122, 0
    v_accvgpr_write_b32 a123, 0
    v_accvgpr_write_b32 a124, 0
    v_accvgpr_write_b32 a125, 0
    v_accvgpr_write_b32 a126, 0
    v_accvgpr_write_b32 a127, 0
    v_accvgpr_write_b32 a128, 0
    v_accvgpr_write_b32 a129, 0
    v_accvgpr_write_b32 a130, 0
    v_accvgpr_write_b32 a131, 0
    v_accvgpr_write_b32 a132, 0
    v_accvgpr_write_b32 a133, 0
    v_accvgpr_write_b32 a134, 0
    v_accvgpr_write_b32 a135, 0
    v_accvgpr_write_b32 a136, 0
    v_accvgpr_write_b32 a137, 0
    v_accvgpr_write_b32 a138, 0
    v_accvgpr_write_b32 a139, 0
    v_accvgpr_write_b32 a140, 0
    v_accvgpr_write_b32 a141, 0
    v_accvgpr_write_b32 a142, 0
    v_accvgpr_write_b32 a143, 0
    v_accvgpr_write_b32 a144, 0
    v_accvgpr_write_b32 a145, 0
    v_accvgpr_write_b32 a146, 0
    v_accvgpr_write_b32 a147, 0
    v_accvgpr_write_b32 a148, 0
    v_accvgpr_write_b32 a149, 0
    v_accvgpr_write_b32 a150, 0
    v_accvgpr_write_b32 a151, 0
    v_accvgpr_write_b32 a152, 0
    v_accvgpr_write_b32 a153, 0
    v_accvgpr_write_b32 a154, 0
    v_accvgpr_write_b32 a155, 0
    v_accvgpr_write_b32 a156, 0
    v_accvgpr_write_b32 a157, 0
    v_accvgpr_write_b32 a158, 0
    v_accvgpr_write_b32 a159, 0
    v_accvgpr_write_b32 a160, 0
    v_accvgpr_write_b32 a161, 0
    v_accvgpr_write_b32 a162, 0
    v_accvgpr_write_b32 a163, 0
    v_accvgpr_write_b32 a164, 0
    v_accvgpr_write_b32 a165, 0
    v_accvgpr_write_b32 a166, 0
    v_accvgpr_write_b32 a167, 0
    v_accvgpr_write_b32 a168, 0
    v_accvgpr_write_b32 a169, 0
    v_accvgpr_write_b32 a170, 0
    v_accvgpr_write_b32 a171, 0
    v_accvgpr_write_b32 a172, 0
    v_accvgpr_write_b32 a173, 0
    v_accvgpr_write_b32 a174, 0
    v_accvgpr_write_b32 a175, 0
    v_accvgpr_write_b32 a176, 0
    v_accvgpr_write_b32 a177, 0
    v_accvgpr_write_b32 a178, 0
    v_accvgpr_write_b32 a179, 0
    v_accvgpr_write_b32 a180, 0
    v_accvgpr_write_b32 a181, 0
    v_accvgpr_write_b32 a182, 0
    v_accvgpr_write_b32 a183, 0
    v_accvgpr_write_b32 a184, 0
    v_accvgpr_write_b32 a185, 0
    v_accvgpr_write_b32 a186, 0
    v_accvgpr_write_b32 a187, 0
    v_accvgpr_write_b32 a188, 0
    v_accvgpr_write_b32 a189, 0
    v_accvgpr_write_b32 a190, 0
    v_accvgpr_write_b32 a191, 0
    v_mov_b32 v144, 0
    v_mov_b32 v145, 0
    v_mov_b32 v146, 0
    v_mov_b32 v147, 0
    v_mov_b32 v148, 0
    v_mov_b32 v149, 0
    v_mov_b32 v150, 0
    v_mov_b32 v151, 0
    s_mov_b32 s58, 0
    s_mov_b32 s59, 0
    s_mov_b32 s60, 0
    s_mov_b32 s57, 64
SLOW2:
    buffer_load_dwordx4 v[24:27], v5, s[28:31], s59 offen offset:0
    buffer_load_dwordx4 v[28:31], v5, s[32:35], s59 offen offset:0
    buffer_load_dwordx4 v[224:227], v4, s[24:27], s58 offen offset:0
    buffer_load_dwordx4 v[228:231], v4, s[24:27], s58 offen offset:16
    buffer_load_dwordx4 v[232:235], v4, s[24:27], s58 offen offset:3072
    buffer_load_dwordx4 v[236:239], v4, s[24:27], s58 offen offset:3088
    s_waitcnt vmcnt(0)
    v_lshlrev_b32 v32, 16, v24
    v_and_b32 v33, s62, v24
    v_lshlrev_b32 v36, 16, v28
    v_and_b32 v37, s62, v28
    v_mul_f32 v32, s61, v32
    v_mul_f32 v33, s61, v33
    v_mul_f32 v36, -v36, v32
    v_mul_f32 v37, -v37, v33
    v_lshlrev_b32 v34, 16, v25
    v_and_b32 v35, s62, v25
    v_lshlrev_b32 v38, 16, v29
    v_and_b32 v39, s62, v29
    v_mul_f32 v34, s61, v34
    v_mul_f32 v35, s61, v35
    v_mul_f32 v38, -v38, v34
    v_mul_f32 v39, -v39, v35
    v_lshlrev_b32 v40, 16, v26
    v_and_b32 v41, s62, v26
    v_lshlrev_b32 v44, 16, v30
    v_and_b32 v45, s62, v30
    v_mul_f32 v40, s61, v40
    v_mul_f32 v41, s61, v41
    v_mul_f32 v44, -v44, v40
    v_mul_f32 v45, -v45, v41
    v_lshlrev_b32 v42, 16, v27
    v_and_b32 v43, s62, v27
    v_lshlrev_b32 v46, 16, v31
    v_and_b32 v47, s62, v31
    v_mul_f32 v42, s61, v42
    v_mul_f32 v43, s61, v43
    v_mul_f32 v46, -v46, v42
    v_mul_f32 v47, -v47, v43
    v_cvt_f32_i32 v224, v224
    v_cvt_f32_i32 v225, v225
    v_cvt_f32_i32 v226, v226
    v_cvt_f32_i32 v227, v227
    v_fma_f32 v224, v224, v32, v36
    v_fma_f32 v225, v225, v33, v37
    v_fma_f32 v226, v226, v34, v38
    v_fma_f32 v227, v227, v35, v39
    v_cvt_pk_bf16_f32 v160, v224, v225
    v_cvt_pk_bf16_f32 v161, v226, v227
    v_cvt_f32_i32 v228, v228
    v_cvt_f32_i32 v229, v229
    v_cvt_f32_i32 v230, v230
    v_cvt_f32_i32 v231, v231
    v_fma_f32 v228, v228, v40, v44
    v_fma_f32 v229, v229, v41, v45
    v_fma_f32 v230, v230, v42, v46
    v_fma_f32 v231, v231, v43, v47
    v_cvt_pk_bf16_f32 v162, v228, v229
    v_cvt_pk_bf16_f32 v163, v230, v231
    v_cvt_f32_i32 v232, v232
    v_cvt_f32_i32 v233, v233
    v_cvt_f32_i32 v234, v234
    v_cvt_f32_i32 v235, v235
    v_fma_f32 v232, v232, v32, v36
    v_fma_f32 v233, v233, v33, v37
    v_fma_f32 v234, v234, v34, v38
    v_fma_f32 v235, v235, v35, v39
    v_cvt_pk_bf16_f32 v164, v232, v233
    v_cvt_pk_bf16_f32 v165, v234, v235
    v_cvt_f32_i32 v236, v236
    v_cvt_f32_i32 v237, v237
    v_cvt_f32_i32 v238, v238
    v_cvt_f32_i32 v239, v239
    v_fma_f32 v236, v236, v40, v44
    v_fma_f32 v237, v237, v41, v45
    v_fma_f32 v238, v238, v42, v46
    v_fma_f32 v239, v239, v43, v47
    v_cvt_pk_bf16_f32 v166, v236, v237
    v_cvt_pk_bf16_f32 v167, v238, v239
    s_nop 1
    v_mfma_f32_16x16x32_bf16 v[64:67], v[160:163], v[192:195], v[128:131]
    v_mfma_f32_16x16x32_bf16 v[72:75], v[160:163], v[196:199], v[132:135]
    v_mfma_f32_16x16x32_bf16 v[80:83], v[160:163], v[200:203], v[136:139]
    v_mfma_f32_16x16x32_bf16 v[88:91], v[160:163], v[204:207], v[140:143]
    v_mfma_f32_16x16x32_bf16 v[68:71], v[164:167], v[192:195], v[128:131]
    v_mfma_f32_16x16x32_bf16 v[76:79], v[164:167], v[196:199], v[132:135]
    v_mfma_f32_16x16x32_bf16 v[84:87], v[164:167], v[200:203], v[136:139]
    v_mfma_f32_16x16x32_bf16 v[92:95], v[164:167], v[204:207], v[140:143]
    s_nop 7
    buffer_load_dwordx4 v[24:27], v5, s[28:31], s59 offen offset:64
    buffer_load_dwordx4 v[28:31], v5, s[32:35], s59 offen offset:64
    buffer_load_dwordx4 v[224:227], v4, s[24:27], s58 offen offset:128
    buffer_load_dwordx4 v[228:231], v4, s[24:27], s58 offen offset:144
    buffer_load_dwordx4 v[232:235], v4, s[24:27], s58 offen offset:3200
    buffer_load_dwordx4 v[236:239], v4, s[24:27], s58 offen offset:3216
    s_waitcnt vmcnt(0)
    v_lshlrev_b32 v32, 16, v24
    v_and_b32 v33, s62, v24
    v_lshlrev_b32 v36, 16, v28
    v_and_b32 v37, s62, v28
    v_mul_f32 v32, s61, v32
    v_mul_f32 v33, s61, v33
    v_mul_f32 v36, -v36, v32
    v_mul_f32 v37, -v37, v33
    v_lshlrev_b32 v34, 16, v25
    v_and_b32 v35, s62, v25
    v_lshlrev_b32 v38, 16, v29
    v_and_b32 v39, s62, v29
    v_mul_f32 v34, s61, v34
    v_mul_f32 v35, s61, v35
    v_mul_f32 v38, -v38, v34
    v_mul_f32 v39, -v39, v35
    v_lshlrev_b32 v40, 16, v26
    v_and_b32 v41, s62, v26
    v_lshlrev_b32 v44, 16, v30
    v_and_b32 v45, s62, v30
    v_mul_f32 v40, s61, v40
    v_mul_f32 v41, s61, v41
    v_mul_f32 v44, -v44, v40
    v_mul_f32 v45, -v45, v41
    v_lshlrev_b32 v42, 16, v27
    v_and_b32 v43, s62, v27
    v_lshlrev_b32 v46, 16, v31
    v_and_b32 v47, s62, v31
    v_mul_f32 v42, s61, v42
    v_mul_f32 v43, s61, v43
    v_mul_f32 v46, -v46, v42
    v_mul_f32 v47, -v47, v43
    v_cvt_f32_i32 v224, v224
    v_cvt_f32_i32 v225, v225
    v_cvt_f32_i32 v226, v226
    v_cvt_f32_i32 v227, v227
    v_fma_f32 v224, v224, v32, v36
    v_fma_f32 v225, v225, v33, v37
    v_fma_f32 v226, v226, v34, v38
    v_fma_f32 v227, v227, v35, v39
    v_cvt_pk_bf16_f32 v160, v224, v225
    v_cvt_pk_bf16_f32 v161, v226, v227
    v_cvt_f32_i32 v228, v228
    v_cvt_f32_i32 v229, v229
    v_cvt_f32_i32 v230, v230
    v_cvt_f32_i32 v231, v231
    v_fma_f32 v228, v228, v40, v44
    v_fma_f32 v229, v229, v41, v45
    v_fma_f32 v230, v230, v42, v46
    v_fma_f32 v231, v231, v43, v47
    v_cvt_pk_bf16_f32 v162, v228, v229
    v_cvt_pk_bf16_f32 v163, v230, v231
    v_cvt_f32_i32 v232, v232
    v_cvt_f32_i32 v233, v233
    v_cvt_f32_i32 v234, v234
    v_cvt_f32_i32 v235, v235
    v_fma_f32 v232, v232, v32, v36
    v_fma_f32 v233, v233, v33, v37
    v_fma_f32 v234, v234, v34, v38
    v_fma_f32 v235, v235, v35, v39
    v_cvt_pk_bf16_f32 v164, v232, v233
    v_cvt_pk_bf16_f32 v165, v234, v235
    v_cvt_f32_i32 v236, v236
    v_cvt_f32_i32 v237, v237
    v_cvt_f32_i32 v238, v238
    v_cvt_f32_i32 v239, v239
    v_fma_f32 v236, v236, v40, v44
    v_fma_f32 v237, v237, v41, v45
    v_fma_f32 v238, v238, v42, v46
    v_fma_f32 v239, v239, v43, v47
    v_cvt_pk_bf16_f32 v166, v236, v237
    v_cvt_pk_bf16_f32 v167, v238, v239
    s_nop 1
    v_mfma_f32_16x16x32_bf16 v[64:67], v[160:163], v[208:211], v[64:67]
    v_mfma_f32_16x16x32_bf16 v[72:75], v[160:163], v[212:215], v[72:75]
    v_mfma_f32_16x16x32_bf16 v[80:83], v[160:163], v[216:219], v[80:83]
    v_mfma_f32_16x16x32_bf16 v[88:91], v[160:163], v[220:223], v[88:91]
    v_mfma_f32_16x16x32_bf16 v[68:71], v[164:167], v[208:211], v[68:71]
    v_mfma_f32_16x16x32_bf16 v[76:79], v[164:167], v[212:215], v[76:79]
    v_mfma_f32_16x16x32_bf16 v[84:87], v[164:167], v[216:219], v[84:87]
    v_mfma_f32_16x16x32_bf16 v[92:95], v[164:167], v[220:223], v[92:95]
    s_nop 7
    buffer_load_dwordx4 v[24:27], v5, s[28:31], s59 offen offset:128
    buffer_load_dwordx4 v[28:31], v5, s[32:35], s59 offen offset:128
    buffer_load_dwordx4 v[224:227], v4, s[24:27], s58 offen offset:256
    buffer_load_dwordx4 v[228:231], v4, s[24:27], s58 offen offset:272
    buffer_load_dwordx4 v[232:235], v4, s[24:27], s58 offen offset:3328
    buffer_load_dwordx4 v[236:239], v4, s[24:27], s58 offen offset:3344
    s_waitcnt vmcnt(0)
    v_lshlrev_b32 v32, 16, v24
    v_and_b32 v33, s62, v24
    v_lshlrev_b32 v36, 16, v28
    v_and_b32 v37, s62, v28
    v_mul_f32 v32, s61, v32
    v_mul_f32 v33, s61, v33
    v_mul_f32 v36, -v36, v32
    v_mul_f32 v37, -v37, v33
    v_lshlrev_b32 v34, 16, v25
    v_and_b32 v35, s62, v25
    v_lshlrev_b32 v38, 16, v29
    v_and_b32 v39, s62, v29
    v_mul_f32 v34, s61, v34
    v_mul_f32 v35, s61, v35
    v_mul_f32 v38, -v38, v34
    v_mul_f32 v39, -v39, v35
    v_lshlrev_b32 v40, 16, v26
    v_and_b32 v41, s62, v26
    v_lshlrev_b32 v44, 16, v30
    v_and_b32 v45, s62, v30
    v_mul_f32 v40, s61, v40
    v_mul_f32 v41, s61, v41
    v_mul_f32 v44, -v44, v40
    v_mul_f32 v45, -v45, v41
    v_lshlrev_b32 v42, 16, v27
    v_and_b32 v43, s62, v27
    v_lshlrev_b32 v46, 16, v31
    v_and_b32 v47, s62, v31
    v_mul_f32 v42, s61, v42
    v_mul_f32 v43, s61, v43
    v_mul_f32 v46, -v46, v42
    v_mul_f32 v47, -v47, v43
    v_cvt_f32_i32 v224, v224
    v_cvt_f32_i32 v225, v225
    v_cvt_f32_i32 v226, v226
    v_cvt_f32_i32 v227, v227
    v_fma_f32 v224, v224, v32, v36
    v_fma_f32 v225, v225, v33, v37
    v_fma_f32 v226, v226, v34, v38
    v_fma_f32 v227, v227, v35, v39
    v_cvt_pk_bf16_f32 v160, v224, v225
    v_cvt_pk_bf16_f32 v161, v226, v227
    v_cvt_f32_i32 v228, v228
    v_cvt_f32_i32 v229, v229
    v_cvt_f32_i32 v230, v230
    v_cvt_f32_i32 v231, v231
    v_fma_f32 v228, v228, v40, v44
    v_fma_f32 v229, v229, v41, v45
    v_fma_f32 v230, v230, v42, v46
    v_fma_f32 v231, v231, v43, v47
    v_cvt_pk_bf16_f32 v162, v228, v229
    v_cvt_pk_bf16_f32 v163, v230, v231
    v_cvt_f32_i32 v232, v232
    v_cvt_f32_i32 v233, v233
    v_cvt_f32_i32 v234, v234
    v_cvt_f32_i32 v235, v235
    v_fma_f32 v232, v232, v32, v36
    v_fma_f32 v233, v233, v33, v37
    v_fma_f32 v234, v234, v34, v38
    v_fma_f32 v235, v235, v35, v39
    v_cvt_pk_bf16_f32 v164, v232, v233
    v_cvt_pk_bf16_f32 v165, v234, v235
    v_cvt_f32_i32 v236, v236
    v_cvt_f32_i32 v237, v237
    v_cvt_f32_i32 v238, v238
    v_cvt_f32_i32 v239, v239
    v_fma_f32 v236, v236, v40, v44
    v_fma_f32 v237, v237, v41, v45
    v_fma_f32 v238, v238, v42, v46
    v_fma_f32 v239, v239, v43, v47
    v_cvt_pk_bf16_f32 v166, v236, v237
    v_cvt_pk_bf16_f32 v167, v238, v239
    s_nop 1
    v_mfma_f32_16x16x32_bf16 v[64:67], v[160:163], a[192:195], v[64:67]
    v_mfma_f32_16x16x32_bf16 v[72:75], v[160:163], a[196:199], v[72:75]
    v_mfma_f32_16x16x32_bf16 v[80:83], v[160:163], a[200:203], v[80:83]
    v_mfma_f32_16x16x32_bf16 v[88:91], v[160:163], a[204:207], v[88:91]
    v_mfma_f32_16x16x32_bf16 v[68:71], v[164:167], a[192:195], v[68:71]
    v_mfma_f32_16x16x32_bf16 v[76:79], v[164:167], a[196:199], v[76:79]
    v_mfma_f32_16x16x32_bf16 v[84:87], v[164:167], a[200:203], v[84:87]
    v_mfma_f32_16x16x32_bf16 v[92:95], v[164:167], a[204:207], v[92:95]
    s_nop 7
    buffer_load_dwordx4 v[24:27], v5, s[28:31], s59 offen offset:192
    buffer_load_dwordx4 v[28:31], v5, s[32:35], s59 offen offset:192
    buffer_load_dwordx4 v[224:227], v4, s[24:27], s58 offen offset:384
    buffer_load_dwordx4 v[228:231], v4, s[24:27], s58 offen offset:400
    buffer_load_dwordx4 v[232:235], v4, s[24:27], s58 offen offset:3456
    buffer_load_dwordx4 v[236:239], v4, s[24:27], s58 offen offset:3472
    s_waitcnt vmcnt(0)
    v_lshlrev_b32 v32, 16, v24
    v_and_b32 v33, s62, v24
    v_lshlrev_b32 v36, 16, v28
    v_and_b32 v37, s62, v28
    v_mul_f32 v32, s61, v32
    v_mul_f32 v33, s61, v33
    v_mul_f32 v36, -v36, v32
    v_mul_f32 v37, -v37, v33
    v_lshlrev_b32 v34, 16, v25
    v_and_b32 v35, s62, v25
    v_lshlrev_b32 v38, 16, v29
    v_and_b32 v39, s62, v29
    v_mul_f32 v34, s61, v34
    v_mul_f32 v35, s61, v35
    v_mul_f32 v38, -v38, v34
    v_mul_f32 v39, -v39, v35
    v_lshlrev_b32 v40, 16, v26
    v_and_b32 v41, s62, v26
    v_lshlrev_b32 v44, 16, v30
    v_and_b32 v45, s62, v30
    v_mul_f32 v40, s61, v40
    v_mul_f32 v41, s61, v41
    v_mul_f32 v44, -v44, v40
    v_mul_f32 v45, -v45, v41
    v_lshlrev_b32 v42, 16, v27
    v_and_b32 v43, s62, v27
    v_lshlrev_b32 v46, 16, v31
    v_and_b32 v47, s62, v31
    v_mul_f32 v42, s61, v42
    v_mul_f32 v43, s61, v43
    v_mul_f32 v46, -v46, v42
    v_mul_f32 v47, -v47, v43
    v_cvt_f32_i32 v224, v224
    v_cvt_f32_i32 v225, v225
    v_cvt_f32_i32 v226, v226
    v_cvt_f32_i32 v227, v227
    v_fma_f32 v224, v224, v32, v36
    v_fma_f32 v225, v225, v33, v37
    v_fma_f32 v226, v226, v34, v38
    v_fma_f32 v227, v227, v35, v39
    v_cvt_pk_bf16_f32 v160, v224, v225
    v_cvt_pk_bf16_f32 v161, v226, v227
    v_cvt_f32_i32 v228, v228
    v_cvt_f32_i32 v229, v229
    v_cvt_f32_i32 v230, v230
    v_cvt_f32_i32 v231, v231
    v_fma_f32 v228, v228, v40, v44
    v_fma_f32 v229, v229, v41, v45
    v_fma_f32 v230, v230, v42, v46
    v_fma_f32 v231, v231, v43, v47
    v_cvt_pk_bf16_f32 v162, v228, v229
    v_cvt_pk_bf16_f32 v163, v230, v231
    v_cvt_f32_i32 v232, v232
    v_cvt_f32_i32 v233, v233
    v_cvt_f32_i32 v234, v234
    v_cvt_f32_i32 v235, v235
    v_fma_f32 v232, v232, v32, v36
    v_fma_f32 v233, v233, v33, v37
    v_fma_f32 v234, v234, v34, v38
    v_fma_f32 v235, v235, v35, v39
    v_cvt_pk_bf16_f32 v164, v232, v233
    v_cvt_pk_bf16_f32 v165, v234, v235
    v_cvt_f32_i32 v236, v236
    v_cvt_f32_i32 v237, v237
    v_cvt_f32_i32 v238, v238
    v_cvt_f32_i32 v239, v239
    v_fma_f32 v236, v236, v40, v44
    v_fma_f32 v237, v237, v41, v45
    v_fma_f32 v238, v238, v42, v46
    v_fma_f32 v239, v239, v43, v47
    v_cvt_pk_bf16_f32 v166, v236, v237
    v_cvt_pk_bf16_f32 v167, v238, v239
    s_nop 1
    v_mfma_f32_16x16x32_bf16 v[64:67], v[160:163], a[208:211], v[64:67]
    v_mfma_f32_16x16x32_bf16 v[72:75], v[160:163], a[212:215], v[72:75]
    v_mfma_f32_16x16x32_bf16 v[80:83], v[160:163], a[216:219], v[80:83]
    v_mfma_f32_16x16x32_bf16 v[88:91], v[160:163], a[220:223], v[88:91]
    v_mfma_f32_16x16x32_bf16 v[68:71], v[164:167], a[208:211], v[68:71]
    v_mfma_f32_16x16x32_bf16 v[76:79], v[164:167], a[212:215], v[76:79]
    v_mfma_f32_16x16x32_bf16 v[84:87], v[164:167], a[216:219], v[84:87]
    v_mfma_f32_16x16x32_bf16 v[92:95], v[164:167], a[220:223], v[92:95]
    s_nop 7
    buffer_load_dwordx4 v[24:27], v5, s[28:31], s59 offen offset:256
    buffer_load_dwordx4 v[28:31], v5, s[32:35], s59 offen offset:256
    buffer_load_dwordx4 v[224:227], v4, s[24:27], s58 offen offset:512
    buffer_load_dwordx4 v[228:231], v4, s[24:27], s58 offen offset:528
    buffer_load_dwordx4 v[232:235], v4, s[24:27], s58 offen offset:3584
    buffer_load_dwordx4 v[236:239], v4, s[24:27], s58 offen offset:3600
    s_waitcnt vmcnt(0)
    v_lshlrev_b32 v32, 16, v24
    v_and_b32 v33, s62, v24
    v_lshlrev_b32 v36, 16, v28
    v_and_b32 v37, s62, v28
    v_mul_f32 v32, s61, v32
    v_mul_f32 v33, s61, v33
    v_mul_f32 v36, -v36, v32
    v_mul_f32 v37, -v37, v33
    v_lshlrev_b32 v34, 16, v25
    v_and_b32 v35, s62, v25
    v_lshlrev_b32 v38, 16, v29
    v_and_b32 v39, s62, v29
    v_mul_f32 v34, s61, v34
    v_mul_f32 v35, s61, v35
    v_mul_f32 v38, -v38, v34
    v_mul_f32 v39, -v39, v35
    v_lshlrev_b32 v40, 16, v26
    v_and_b32 v41, s62, v26
    v_lshlrev_b32 v44, 16, v30
    v_and_b32 v45, s62, v30
    v_mul_f32 v40, s61, v40
    v_mul_f32 v41, s61, v41
    v_mul_f32 v44, -v44, v40
    v_mul_f32 v45, -v45, v41
    v_lshlrev_b32 v42, 16, v27
    v_and_b32 v43, s62, v27
    v_lshlrev_b32 v46, 16, v31
    v_and_b32 v47, s62, v31
    v_mul_f32 v42, s61, v42
    v_mul_f32 v43, s61, v43
    v_mul_f32 v46, -v46, v42
    v_mul_f32 v47, -v47, v43
    v_cvt_f32_i32 v224, v224
    v_cvt_f32_i32 v225, v225
    v_cvt_f32_i32 v226, v226
    v_cvt_f32_i32 v227, v227
    v_fma_f32 v224, v224, v32, v36
    v_fma_f32 v225, v225, v33, v37
    v_fma_f32 v226, v226, v34, v38
    v_fma_f32 v227, v227, v35, v39
    v_cvt_pk_bf16_f32 v160, v224, v225
    v_cvt_pk_bf16_f32 v161, v226, v227
    v_cvt_f32_i32 v228, v228
    v_cvt_f32_i32 v229, v229
    v_cvt_f32_i32 v230, v230
    v_cvt_f32_i32 v231, v231
    v_fma_f32 v228, v228, v40, v44
    v_fma_f32 v229, v229, v41, v45
    v_fma_f32 v230, v230, v42, v46
    v_fma_f32 v231, v231, v43, v47
    v_cvt_pk_bf16_f32 v162, v228, v229
    v_cvt_pk_bf16_f32 v163, v230, v231
    v_cvt_f32_i32 v232, v232
    v_cvt_f32_i32 v233, v233
    v_cvt_f32_i32 v234, v234
    v_cvt_f32_i32 v235, v235
    v_fma_f32 v232, v232, v32, v36
    v_fma_f32 v233, v233, v33, v37
    v_fma_f32 v234, v234, v34, v38
    v_fma_f32 v235, v235, v35, v39
    v_cvt_pk_bf16_f32 v164, v232, v233
    v_cvt_pk_bf16_f32 v165, v234, v235
    v_cvt_f32_i32 v236, v236
    v_cvt_f32_i32 v237, v237
    v_cvt_f32_i32 v238, v238
    v_cvt_f32_i32 v239, v239
    v_fma_f32 v236, v236, v40, v44
    v_fma_f32 v237, v237, v41, v45
    v_fma_f32 v238, v238, v42, v46
    v_fma_f32 v239, v239, v43, v47
    v_cvt_pk_bf16_f32 v166, v236, v237
    v_cvt_pk_bf16_f32 v167, v238, v239
    s_nop 1
    v_mfma_f32_16x16x32_bf16 v[64:67], v[160:163], a[224:227], v[64:67]
    v_mfma_f32_16x16x32_bf16 v[72:75], v[160:163], a[228:231], v[72:75]
    v_mfma_f32_16x16x32_bf16 v[80:83], v[160:163], a[232:235], v[80:83]
    v_mfma_f32_16x16x32_bf16 v[88:91], v[160:163], a[236:239], v[88:91]
    v_mfma_f32_16x16x32_bf16 v[68:71], v[164:167], a[224:227], v[68:71]
    v_mfma_f32_16x16x32_bf16 v[76:79], v[164:167], a[228:231], v[76:79]
    v_mfma_f32_16x16x32_bf16 v[84:87], v[164:167], a[232:235], v[84:87]
    v_mfma_f32_16x16x32_bf16 v[92:95], v[164:167], a[236:239], v[92:95]
    s_nop 7
    buffer_load_dwordx4 v[24:27], v5, s[28:31], s59 offen offset:320
    buffer_load_dwordx4 v[28:31], v5, s[32:35], s59 offen offset:320
    buffer_load_dwordx4 v[224:227], v4, s[24:27], s58 offen offset:640
    buffer_load_dwordx4 v[228:231], v4, s[24:27], s58 offen offset:656
    buffer_load_dwordx4 v[232:235], v4, s[24:27], s58 offen offset:3712
    buffer_load_dwordx4 v[236:239], v4, s[24:27], s58 offen offset:3728
    s_waitcnt vmcnt(0)
    v_lshlrev_b32 v32, 16, v24
    v_and_b32 v33, s62, v24
    v_lshlrev_b32 v36, 16, v28
    v_and_b32 v37, s62, v28
    v_mul_f32 v32, s61, v32
    v_mul_f32 v33, s61, v33
    v_mul_f32 v36, -v36, v32
    v_mul_f32 v37, -v37, v33
    v_lshlrev_b32 v34, 16, v25
    v_and_b32 v35, s62, v25
    v_lshlrev_b32 v38, 16, v29
    v_and_b32 v39, s62, v29
    v_mul_f32 v34, s61, v34
    v_mul_f32 v35, s61, v35
    v_mul_f32 v38, -v38, v34
    v_mul_f32 v39, -v39, v35
    v_lshlrev_b32 v40, 16, v26
    v_and_b32 v41, s62, v26
    v_lshlrev_b32 v44, 16, v30
    v_and_b32 v45, s62, v30
    v_mul_f32 v40, s61, v40
    v_mul_f32 v41, s61, v41
    v_mul_f32 v44, -v44, v40
    v_mul_f32 v45, -v45, v41
    v_lshlrev_b32 v42, 16, v27
    v_and_b32 v43, s62, v27
    v_lshlrev_b32 v46, 16, v31
    v_and_b32 v47, s62, v31
    v_mul_f32 v42, s61, v42
    v_mul_f32 v43, s61, v43
    v_mul_f32 v46, -v46, v42
    v_mul_f32 v47, -v47, v43
    v_cvt_f32_i32 v224, v224
    v_cvt_f32_i32 v225, v225
    v_cvt_f32_i32 v226, v226
    v_cvt_f32_i32 v227, v227
    v_fma_f32 v224, v224, v32, v36
    v_fma_f32 v225, v225, v33, v37
    v_fma_f32 v226, v226, v34, v38
    v_fma_f32 v227, v227, v35, v39
    v_cvt_pk_bf16_f32 v160, v224, v225
    v_cvt_pk_bf16_f32 v161, v226, v227
    v_cvt_f32_i32 v228, v228
    v_cvt_f32_i32 v229, v229
    v_cvt_f32_i32 v230, v230
    v_cvt_f32_i32 v231, v231
    v_fma_f32 v228, v228, v40, v44
    v_fma_f32 v229, v229, v41, v45
    v_fma_f32 v230, v230, v42, v46
    v_fma_f32 v231, v231, v43, v47
    v_cvt_pk_bf16_f32 v162, v228, v229
    v_cvt_pk_bf16_f32 v163, v230, v231
    v_cvt_f32_i32 v232, v232
    v_cvt_f32_i32 v233, v233
    v_cvt_f32_i32 v234, v234
    v_cvt_f32_i32 v235, v235
    v_fma_f32 v232, v232, v32, v36
    v_fma_f32 v233, v233, v33, v37
    v_fma_f32 v234, v234, v34, v38
    v_fma_f32 v235, v235, v35, v39
    v_cvt_pk_bf16_f32 v164, v232, v233
    v_cvt_pk_bf16_f32 v165, v234, v235
    v_cvt_f32_i32 v236, v236
    v_cvt_f32_i32 v237, v237
    v_cvt_f32_i32 v238, v238
    v_cvt_f32_i32 v239, v239
    v_fma_f32 v236, v236, v40, v44
    v_fma_f32 v237, v237, v41, v45
    v_fma_f32 v238, v238, v42, v46
    v_fma_f32 v239, v239, v43, v47
    v_cvt_pk_bf16_f32 v166, v236, v237
    v_cvt_pk_bf16_f32 v167, v238, v239
    s_nop 1
    v_mfma_f32_16x16x32_bf16 v[64:67], v[160:163], a[240:243], v[64:67]
    v_mfma_f32_16x16x32_bf16 v[72:75], v[160:163], a[244:247], v[72:75]
    v_mfma_f32_16x16x32_bf16 v[80:83], v[160:163], a[248:251], v[80:83]
    v_mfma_f32_16x16x32_bf16 v[88:91], v[160:163], a[252:255], v[88:91]
    v_mfma_f32_16x16x32_bf16 v[68:71], v[164:167], a[240:243], v[68:71]
    v_mfma_f32_16x16x32_bf16 v[76:79], v[164:167], a[244:247], v[76:79]
    v_mfma_f32_16x16x32_bf16 v[84:87], v[164:167], a[248:251], v[84:87]
    v_mfma_f32_16x16x32_bf16 v[92:95], v[164:167], a[252:255], v[92:95]
    s_nop 7
    v_exp_f32 v64, v64
    v_exp_f32 v65, v65
    v_exp_f32 v66, v66
    v_exp_f32 v67, v67
    v_exp_f32 v68, v68
    v_exp_f32 v69, v69
    v_exp_f32 v70, v70
    v_exp_f32 v71, v71
    v_exp_f32 v72, v72
    v_exp_f32 v73, v73
    v_exp_f32 v74, v74
    v_exp_f32 v75, v75
    v_exp_f32 v76, v76
    v_exp_f32 v77, v77
    v_exp_f32 v78, v78
    v_exp_f32 v79, v79
    v_exp_f32 v80, v80
    v_exp_f32 v81, v81
    v_exp_f32 v82, v82
    v_exp_f32 v83, v83
    v_exp_f32 v84, v84
    v_exp_f32 v85, v85
    v_exp_f32 v86, v86
    v_exp_f32 v87, v87
    v_exp_f32 v88, v88
    v_exp_f32 v89, v89
    v_exp_f32 v90, v90
    v_exp_f32 v91, v91
    v_exp_f32 v92, v92
    v_exp_f32 v93, v93
    v_exp_f32 v94, v94
    v_exp_f32 v95, v95
    v_add_f32 v144, v144, v64
    v_add_f32 v145, v145, v65
    v_cvt_pk_bf16_f32 v64, v64, v65
    v_add_f32 v144, v144, v66
    v_add_f32 v145, v145, v67
    v_cvt_pk_bf16_f32 v65, v66, v67
    v_add_f32 v144, v144, v68
    v_add_f32 v145, v145, v69
    v_cvt_pk_bf16_f32 v66, v68, v69
    v_add_f32 v144, v144, v70
    v_add_f32 v145, v145, v71
    v_cvt_pk_bf16_f32 v67, v70, v71
    v_add_f32 v146, v146, v72
    v_add_f32 v147, v147, v73
    v_cvt_pk_bf16_f32 v72, v72, v73
    v_add_f32 v146, v146, v74
    v_add_f32 v147, v147, v75
    v_cvt_pk_bf16_f32 v73, v74, v75
    v_add_f32 v146, v146, v76
    v_add_f32 v147, v147, v77
    v_cvt_pk_bf16_f32 v74, v76, v77
    v_add_f32 v146, v146, v78
    v_add_f32 v147, v147, v79
    v_cvt_pk_bf16_f32 v75, v78, v79
    v_add_f32 v148, v148, v80
    v_add_f32 v149, v149, v81
    v_cvt_pk_bf16_f32 v80, v80, v81
    v_add_f32 v148, v148, v82
    v_add_f32 v149, v149, v83
    v_cvt_pk_bf16_f32 v81, v82, v83
    v_add_f32 v148, v148, v84
    v_add_f32 v149, v149, v85
    v_cvt_pk_bf16_f32 v82, v84, v85
    v_add_f32 v148, v148, v86
    v_add_f32 v149, v149, v87
    v_cvt_pk_bf16_f32 v83, v86, v87
    v_add_f32 v150, v150, v88
    v_add_f32 v151, v151, v89
    v_cvt_pk_bf16_f32 v88, v88, v89
    v_add_f32 v150, v150, v90
    v_add_f32 v151, v151, v91
    v_cvt_pk_bf16_f32 v89, v90, v91
    v_add_f32 v150, v150, v92
    v_add_f32 v151, v151, v93
    v_cvt_pk_bf16_f32 v90, v92, v93
    v_add_f32 v150, v150, v94
    v_add_f32 v151, v151, v95
    v_cvt_pk_bf16_f32 v91, v94, v95
    buffer_load_dwordx4 v[24:27], v5, s[40:43], s60 offen
    buffer_load_dwordx4 v[28:31], v5, s[44:47], s60 offen
    s_waitcnt vmcnt(0)
    v_lshlrev_b32 v32, 16, v24
    v_and_b32 v33, s62, v24
    v_lshlrev_b32 v40, 16, v28
    v_and_b32 v41, s62, v28
    v_mul_f32 v40, -v40, v32
    v_mul_f32 v41, -v41, v33
    v_lshlrev_b32 v34, 16, v25
    v_and_b32 v35, s62, v25
    v_lshlrev_b32 v42, 16, v29
    v_and_b32 v43, s62, v29
    v_mul_f32 v42, -v42, v34
    v_mul_f32 v43, -v43, v35
    v_lshlrev_b32 v36, 16, v26
    v_and_b32 v37, s62, v26
    v_lshlrev_b32 v44, 16, v30
    v_and_b32 v45, s62, v30
    v_mul_f32 v44, -v44, v36
    v_mul_f32 v45, -v45, v37
    v_lshlrev_b32 v38, 16, v27
    v_and_b32 v39, s62, v27
    v_lshlrev_b32 v46, 16, v31
    v_and_b32 v47, s62, v31
    v_mul_f32 v46, -v46, v38
    v_mul_f32 v47, -v47, v39
    buffer_load_dwordx4 v[224:227], v6, s[36:39], s58 offen offset:0
    buffer_load_dwordx4 v[228:231], v6, s[36:39], s58 offen offset:768
    buffer_load_dwordx4 v[232:235], v6, s[36:39], s58 offen offset:1536
    buffer_load_dwordx4 v[236:239], v6, s[36:39], s58 offen offset:2304
    buffer_load_dwordx4 v[240:243], v7, s[36:39], s58 offen offset:0
    buffer_load_dwordx4 v[244:247], v7, s[36:39], s58 offen offset:768
    buffer_load_dwordx4 v[248:251], v7, s[36:39], s58 offen offset:1536
    buffer_load_dwordx4 v[252:255], v7, s[36:39], s58 offen offset:2304
    s_waitcnt vmcnt(0)
    v_cvt_f32_i32 v224, v224
    v_cvt_f32_i32 v225, v225
    v_cvt_f32_i32 v226, v226
    v_cvt_f32_i32 v227, v227
    v_fma_f32 v224, v224, v32, v40
    v_fma_f32 v225, v225, v32, v40
    v_fma_f32 v226, v226, v32, v40
    v_fma_f32 v227, v227, v32, v40
    v_cvt_f32_i32 v228, v228
    v_cvt_f32_i32 v229, v229
    v_cvt_f32_i32 v230, v230
    v_cvt_f32_i32 v231, v231
    v_fma_f32 v228, v228, v33, v41
    v_fma_f32 v229, v229, v33, v41
    v_fma_f32 v230, v230, v33, v41
    v_fma_f32 v231, v231, v33, v41
    v_cvt_f32_i32 v232, v232
    v_cvt_f32_i32 v233, v233
    v_cvt_f32_i32 v234, v234
    v_cvt_f32_i32 v235, v235
    v_fma_f32 v232, v232, v34, v42
    v_fma_f32 v233, v233, v34, v42
    v_fma_f32 v234, v234, v34, v42
    v_fma_f32 v235, v235, v34, v42
    v_cvt_f32_i32 v236, v236
    v_cvt_f32_i32 v237, v237
    v_cvt_f32_i32 v238, v238
    v_cvt_f32_i32 v239, v239
    v_fma_f32 v236, v236, v35, v43
    v_fma_f32 v237, v237, v35, v43
    v_fma_f32 v238, v238, v35, v43
    v_fma_f32 v239, v239, v35, v43
    v_cvt_f32_i32 v240, v240
    v_cvt_f32_i32 v241, v241
    v_cvt_f32_i32 v242, v242
    v_cvt_f32_i32 v243, v243
    v_fma_f32 v240, v240, v36, v44
    v_fma_f32 v241, v241, v36, v44
    v_fma_f32 v242, v242, v36, v44
    v_fma_f32 v243, v243, v36, v44
    v_cvt_f32_i32 v244, v244
    v_cvt_f32_i32 v245, v245
    v_cvt_f32_i32 v246, v246
    v_cvt_f32_i32 v247, v247
    v_fma_f32 v244, v244, v37, v45
    v_fma_f32 v245, v245, v37, v45
    v_fma_f32 v246, v246, v37, v45
    v_fma_f32 v247, v247, v37, v45
    v_cvt_f32_i32 v248, v248
    v_cvt_f32_i32 v249, v249
    v_cvt_f32_i32 v250, v250
    v_cvt_f32_i32 v251, v251
    v_fma_f32 v248, v248, v38, v46
    v_fma_f32 v249, v249, v38, v46
    v_fma_f32 v250, v250, v38, v46
    v_fma_f32 v251, v251, v38, v46
    v_cvt_f32_i32 v252, v252
    v_cvt_f32_i32 v253, v253
    v_cvt_f32_i32 v254, v254
    v_cvt_f32_i32 v255, v255
    v_fma_f32 v252, v252, v39, v47
    v_fma_f32 v253, v253, v39, v47
    v_fma_f32 v254, v254, v39, v47
    v_fma_f32 v255, v255, v39, v47
    v_cvt_pk_bf16_f32 v160, v224, v228
    v_cvt_pk_bf16_f32 v161, v232, v236
    v_cvt_pk_bf16_f32 v162, v240, v244
    v_cvt_pk_bf16_f32 v163, v248, v252
    v_cvt_pk_bf16_f32 v164, v225, v229
    v_cvt_pk_bf16_f32 v165, v233, v237
    v_cvt_pk_bf16_f32 v166, v241, v245
    v_cvt_pk_bf16_f32 v167, v249, v253
    v_cvt_pk_bf16_f32 v168, v226, v230
    v_cvt_pk_bf16_f32 v169, v234, v238
    v_cvt_pk_bf16_f32 v170, v242, v246
    v_cvt_pk_bf16_f32 v171, v250, v254
    v_cvt_pk_bf16_f32 v172, v227, v231
    v_cvt_pk_bf16_f32 v173, v235, v239
    v_cvt_pk_bf16_f32 v174, v243, v247
    v_cvt_pk_bf16_f32 v175, v251, v255
    s_nop 1
    v_mfma_f32_16x16x32_bf16 a[0:3], v[64:67], v[160:163], a[0:3]
    v_mfma_f32_16x16x32_bf16 a[48:51], v[72:75], v[160:163], a[48:51]
    v_mfma_f32_16x16x32_bf16 a[96:99], v[80:83], v[160:163], a[96:99]
    v_mfma_f32_16x16x32_bf16 a[144:147], v[88:91], v[160:163], a[144:147]
    v_mfma_f32_16x16x32_bf16 a[4:7], v[64:67], v[164:167], a[4:7]
    v_mfma_f32_16x16x32_bf16 a[52:55], v[72:75], v[164:167], a[52:55]
    v_mfma_f32_16x16x32_bf16 a[100:103], v[80:83], v[164:167], a[100:103]
    v_mfma_f32_16x16x32_bf16 a[148:151], v[88:91], v[164:167], a[148:151]
    v_mfma_f32_16x16x32_bf16 a[8:11], v[64:67], v[168:171], a[8:11]
    v_mfma_f32_16x16x32_bf16 a[56:59], v[72:75], v[168:171], a[56:59]
    v_mfma_f32_16x16x32_bf16 a[104:107], v[80:83], v[168:171], a[104:107]
    v_mfma_f32_16x16x32_bf16 a[152:155], v[88:91], v[168:171], a[152:155]
    v_mfma_f32_16x16x32_bf16 a[12:15], v[64:67], v[172:175], a[12:15]
    v_mfma_f32_16x16x32_bf16 a[60:63], v[72:75], v[172:175], a[60:63]
    v_mfma_f32_16x16x32_bf16 a[108:111], v[80:83], v[172:175], a[108:111]
    v_mfma_f32_16x16x32_bf16 a[156:159], v[88:91], v[172:175], a[156:159]
    s_nop 7
    buffer_load_dwordx4 v[224:227], v6, s[36:39], s58 offen offset:256
    buffer_load_dwordx4 v[228:231], v6, s[36:39], s58 offen offset:1024
    buffer_load_dwordx4 v[232:235], v6, s[36:39], s58 offen offset:1792
    buffer_load_dwordx4 v[236:239], v6, s[36:39], s58 offen offset:2560
    buffer_load_dwordx4 v[240:243], v7, s[36:39], s58 offen offset:256
    buffer_load_dwordx4 v[244:247], v7, s[36:39], s58 offen offset:1024
    buffer_load_dwordx4 v[248:251], v7, s[36:39], s58 offen offset:1792
    buffer_load_dwordx4 v[252:255], v7, s[36:39], s58 offen offset:2560
    s_waitcnt vmcnt(0)
    v_cvt_f32_i32 v224, v224
    v_cvt_f32_i32 v225, v225
    v_cvt_f32_i32 v226, v226
    v_cvt_f32_i32 v227, v227
    v_fma_f32 v224, v224, v32, v40
    v_fma_f32 v225, v225, v32, v40
    v_fma_f32 v226, v226, v32, v40
    v_fma_f32 v227, v227, v32, v40
    v_cvt_f32_i32 v228, v228
    v_cvt_f32_i32 v229, v229
    v_cvt_f32_i32 v230, v230
    v_cvt_f32_i32 v231, v231
    v_fma_f32 v228, v228, v33, v41
    v_fma_f32 v229, v229, v33, v41
    v_fma_f32 v230, v230, v33, v41
    v_fma_f32 v231, v231, v33, v41
    v_cvt_f32_i32 v232, v232
    v_cvt_f32_i32 v233, v233
    v_cvt_f32_i32 v234, v234
    v_cvt_f32_i32 v235, v235
    v_fma_f32 v232, v232, v34, v42
    v_fma_f32 v233, v233, v34, v42
    v_fma_f32 v234, v234, v34, v42
    v_fma_f32 v235, v235, v34, v42
    v_cvt_f32_i32 v236, v236
    v_cvt_f32_i32 v237, v237
    v_cvt_f32_i32 v238, v238
    v_cvt_f32_i32 v239, v239
    v_fma_f32 v236, v236, v35, v43
    v_fma_f32 v237, v237, v35, v43
    v_fma_f32 v238, v238, v35, v43
    v_fma_f32 v239, v239, v35, v43
    v_cvt_f32_i32 v240, v240
    v_cvt_f32_i32 v241, v241
    v_cvt_f32_i32 v242, v242
    v_cvt_f32_i32 v243, v243
    v_fma_f32 v240, v240, v36, v44
    v_fma_f32 v241, v241, v36, v44
    v_fma_f32 v242, v242, v36, v44
    v_fma_f32 v243, v243, v36, v44
    v_cvt_f32_i32 v244, v244
    v_cvt_f32_i32 v245, v245
    v_cvt_f32_i32 v246, v246
    v_cvt_f32_i32 v247, v247
    v_fma_f32 v244, v244, v37, v45
    v_fma_f32 v245, v245, v37, v45
    v_fma_f32 v246, v246, v37, v45
    v_fma_f32 v247, v247, v37, v45
    v_cvt_f32_i32 v248, v248
    v_cvt_f32_i32 v249, v249
    v_cvt_f32_i32 v250, v250
    v_cvt_f32_i32 v251, v251
    v_fma_f32 v248, v248, v38, v46
    v_fma_f32 v249, v249, v38, v46
    v_fma_f32 v250, v250, v38, v46
    v_fma_f32 v251, v251, v38, v46
    v_cvt_f32_i32 v252, v252
    v_cvt_f32_i32 v253, v253
    v_cvt_f32_i32 v254, v254
    v_cvt_f32_i32 v255, v255
    v_fma_f32 v252, v252, v39, v47
    v_fma_f32 v253, v253, v39, v47
    v_fma_f32 v254, v254, v39, v47
    v_fma_f32 v255, v255, v39, v47
    v_cvt_pk_bf16_f32 v160, v224, v228
    v_cvt_pk_bf16_f32 v161, v232, v236
    v_cvt_pk_bf16_f32 v162, v240, v244
    v_cvt_pk_bf16_f32 v163, v248, v252
    v_cvt_pk_bf16_f32 v164, v225, v229
    v_cvt_pk_bf16_f32 v165, v233, v237
    v_cvt_pk_bf16_f32 v166, v241, v245
    v_cvt_pk_bf16_f32 v167, v249, v253
    v_cvt_pk_bf16_f32 v168, v226, v230
    v_cvt_pk_bf16_f32 v169, v234, v238
    v_cvt_pk_bf16_f32 v170, v242, v246
    v_cvt_pk_bf16_f32 v171, v250, v254
    v_cvt_pk_bf16_f32 v172, v227, v231
    v_cvt_pk_bf16_f32 v173, v235, v239
    v_cvt_pk_bf16_f32 v174, v243, v247
    v_cvt_pk_bf16_f32 v175, v251, v255
    s_nop 1
    v_mfma_f32_16x16x32_bf16 a[16:19], v[64:67], v[160:163], a[16:19]
    v_mfma_f32_16x16x32_bf16 a[64:67], v[72:75], v[160:163], a[64:67]
    v_mfma_f32_16x16x32_bf16 a[112:115], v[80:83], v[160:163], a[112:115]
    v_mfma_f32_16x16x32_bf16 a[160:163], v[88:91], v[160:163], a[160:163]
    v_mfma_f32_16x16x32_bf16 a[20:23], v[64:67], v[164:167], a[20:23]
    v_mfma_f32_16x16x32_bf16 a[68:71], v[72:75], v[164:167], a[68:71]
    v_mfma_f32_16x16x32_bf16 a[116:119], v[80:83], v[164:167], a[116:119]
    v_mfma_f32_16x16x32_bf16 a[164:167], v[88:91], v[164:167], a[164:167]
    v_mfma_f32_16x16x32_bf16 a[24:27], v[64:67], v[168:171], a[24:27]
    v_mfma_f32_16x16x32_bf16 a[72:75], v[72:75], v[168:171], a[72:75]
    v_mfma_f32_16x16x32_bf16 a[120:123], v[80:83], v[168:171], a[120:123]
    v_mfma_f32_16x16x32_bf16 a[168:171], v[88:91], v[168:171], a[168:171]
    v_mfma_f32_16x16x32_bf16 a[28:31], v[64:67], v[172:175], a[28:31]
    v_mfma_f32_16x16x32_bf16 a[76:79], v[72:75], v[172:175], a[76:79]
    v_mfma_f32_16x16x32_bf16 a[124:127], v[80:83], v[172:175], a[124:127]
    v_mfma_f32_16x16x32_bf16 a[172:175], v[88:91], v[172:175], a[172:175]
    s_nop 7
    buffer_load_dwordx4 v[224:227], v6, s[36:39], s58 offen offset:512
    buffer_load_dwordx4 v[228:231], v6, s[36:39], s58 offen offset:1280
    buffer_load_dwordx4 v[232:235], v6, s[36:39], s58 offen offset:2048
    buffer_load_dwordx4 v[236:239], v6, s[36:39], s58 offen offset:2816
    buffer_load_dwordx4 v[240:243], v7, s[36:39], s58 offen offset:512
    buffer_load_dwordx4 v[244:247], v7, s[36:39], s58 offen offset:1280
    buffer_load_dwordx4 v[248:251], v7, s[36:39], s58 offen offset:2048
    buffer_load_dwordx4 v[252:255], v7, s[36:39], s58 offen offset:2816
    s_waitcnt vmcnt(0)
    v_cvt_f32_i32 v224, v224
    v_cvt_f32_i32 v225, v225
    v_cvt_f32_i32 v226, v226
    v_cvt_f32_i32 v227, v227
    v_fma_f32 v224, v224, v32, v40
    v_fma_f32 v225, v225, v32, v40
    v_fma_f32 v226, v226, v32, v40
    v_fma_f32 v227, v227, v32, v40
    v_cvt_f32_i32 v228, v228
    v_cvt_f32_i32 v229, v229
    v_cvt_f32_i32 v230, v230
    v_cvt_f32_i32 v231, v231
    v_fma_f32 v228, v228, v33, v41
    v_fma_f32 v229, v229, v33, v41
    v_fma_f32 v230, v230, v33, v41
    v_fma_f32 v231, v231, v33, v41
    v_cvt_f32_i32 v232, v232
    v_cvt_f32_i32 v233, v233
    v_cvt_f32_i32 v234, v234
    v_cvt_f32_i32 v235, v235
    v_fma_f32 v232, v232, v34, v42
    v_fma_f32 v233, v233, v34, v42
    v_fma_f32 v234, v234, v34, v42
    v_fma_f32 v235, v235, v34, v42
    v_cvt_f32_i32 v236, v236
    v_cvt_f32_i32 v237, v237
    v_cvt_f32_i32 v238, v238
    v_cvt_f32_i32 v239, v239
    v_fma_f32 v236, v236, v35, v43
    v_fma_f32 v237, v237, v35, v43
    v_fma_f32 v238, v238, v35, v43
    v_fma_f32 v239, v239, v35, v43
    v_cvt_f32_i32 v240, v240
    v_cvt_f32_i32 v241, v241
    v_cvt_f32_i32 v242, v242
    v_cvt_f32_i32 v243, v243
    v_fma_f32 v240, v240, v36, v44
    v_fma_f32 v241, v241, v36, v44
    v_fma_f32 v242, v242, v36, v44
    v_fma_f32 v243, v243, v36, v44
    v_cvt_f32_i32 v244, v244
    v_cvt_f32_i32 v245, v245
    v_cvt_f32_i32 v246, v246
    v_cvt_f32_i32 v247, v247
    v_fma_f32 v244, v244, v37, v45
    v_fma_f32 v245, v245, v37, v45
    v_fma_f32 v246, v246, v37, v45
    v_fma_f32 v247, v247, v37, v45
    v_cvt_f32_i32 v248, v248
    v_cvt_f32_i32 v249, v249
    v_cvt_f32_i32 v250, v250
    v_cvt_f32_i32 v251, v251
    v_fma_f32 v248, v248, v38, v46
    v_fma_f32 v249, v249, v38, v46
    v_fma_f32 v250, v250, v38, v46
    v_fma_f32 v251, v251, v38, v46
    v_cvt_f32_i32 v252, v252
    v_cvt_f32_i32 v253, v253
    v_cvt_f32_i32 v254, v254
    v_cvt_f32_i32 v255, v255
    v_fma_f32 v252, v252, v39, v47
    v_fma_f32 v253, v253, v39, v47
    v_fma_f32 v254, v254, v39, v47
    v_fma_f32 v255, v255, v39, v47
    v_cvt_pk_bf16_f32 v160, v224, v228
    v_cvt_pk_bf16_f32 v161, v232, v236
    v_cvt_pk_bf16_f32 v162, v240, v244
    v_cvt_pk_bf16_f32 v163, v248, v252
    v_cvt_pk_bf16_f32 v164, v225, v229
    v_cvt_pk_bf16_f32 v165, v233, v237
    v_cvt_pk_bf16_f32 v166, v241, v245
    v_cvt_pk_bf16_f32 v167, v249, v253
    v_cvt_pk_bf16_f32 v168, v226, v230
    v_cvt_pk_bf16_f32 v169, v234, v238
    v_cvt_pk_bf16_f32 v170, v242, v246
    v_cvt_pk_bf16_f32 v171, v250, v254
    v_cvt_pk_bf16_f32 v172, v227, v231
    v_cvt_pk_bf16_f32 v173, v235, v239
    v_cvt_pk_bf16_f32 v174, v243, v247
    v_cvt_pk_bf16_f32 v175, v251, v255
    s_nop 1
    v_mfma_f32_16x16x32_bf16 a[32:35], v[64:67], v[160:163], a[32:35]
    v_mfma_f32_16x16x32_bf16 a[80:83], v[72:75], v[160:163], a[80:83]
    v_mfma_f32_16x16x32_bf16 a[128:131], v[80:83], v[160:163], a[128:131]
    v_mfma_f32_16x16x32_bf16 a[176:179], v[88:91], v[160:163], a[176:179]
    v_mfma_f32_16x16x32_bf16 a[36:39], v[64:67], v[164:167], a[36:39]
    v_mfma_f32_16x16x32_bf16 a[84:87], v[72:75], v[164:167], a[84:87]
    v_mfma_f32_16x16x32_bf16 a[132:135], v[80:83], v[164:167], a[132:135]
    v_mfma_f32_16x16x32_bf16 a[180:183], v[88:91], v[164:167], a[180:183]
    v_mfma_f32_16x16x32_bf16 a[40:43], v[64:67], v[168:171], a[40:43]
    v_mfma_f32_16x16x32_bf16 a[88:91], v[72:75], v[168:171], a[88:91]
    v_mfma_f32_16x16x32_bf16 a[136:139], v[80:83], v[168:171], a[136:139]
    v_mfma_f32_16x16x32_bf16 a[184:187], v[88:91], v[168:171], a[184:187]
    v_mfma_f32_16x16x32_bf16 a[44:47], v[64:67], v[172:175], a[44:47]
    v_mfma_f32_16x16x32_bf16 a[92:95], v[72:75], v[172:175], a[92:95]
    v_mfma_f32_16x16x32_bf16 a[140:143], v[80:83], v[172:175], a[140:143]
    v_mfma_f32_16x16x32_bf16 a[188:191], v[88:91], v[172:175], a[188:191]
    s_nop 7
    s_add_u32 s58, s58, 24576
    s_add_u32 s59, s59, 384
    s_add_u32 s60, s60, 64
    s_sub_u32 s57, s57, 1
    s_cmp_lg_u32 s57, 0
    s_cbranch_scc1 SLOW2
    v_and_b32 v15, 15, v0
    v_lshrrev_b32 v16, 4, v0
    v_mul_u32_u24 v22, 1536, v16
    v_lshl_add_u32 v22, v15, 3, v22
    v_lshl_add_u32 v20, v15, 2, s70
    v_lshl_add_u32 v21, v16, 4, s70
    v_add_f32 v144, v144, v145
    v_add_f32 v146, v146, v147
    v_add_f32 v148, v148, v149
    v_add_f32 v150, v150, v151
    v_mov_b32 v145, v144
    v_mov_b32 v147, v146
    v_mov_b32 v149, v148
    v_mov_b32 v151, v150
    s_nop 1
    v_permlane32_swap_b32 v144, v145
    v_permlane32_swap_b32 v146, v147
    v_permlane32_swap_b32 v148, v149
    v_permlane32_swap_b32 v150, v151
    s_nop 1
    v_add_f32 v144, v144, v145
    v_add_f32 v146, v146, v147
    v_add_f32 v148, v148, v149
    v_add_f32 v150, v150, v151
    v_mov_b32 v145, v144
    v_mov_b32 v147, v146
    v_mov_b32 v149, v148
    v_mov_b32 v151, v150
    s_nop 1
    v_permlane16_swap_b32 v144, v145
    v_permlane16_swap_b32 v146, v147
    v_permlane16_swap_b32 v148, v149
    v_permlane16_swap_b32 v150, v151
    s_nop 1
    v_add_f32 v144, v144, v145
    v_add_f32 v146, v146, v147
    v_add_f32 v148, v148, v149
    v_add_f32 v150, v150, v151
    v_rcp_f32 v145, v144
    v_rcp_f32 v147, v146
    v_rcp_f32 v149, v148
    v_rcp_f32 v151, v150
    s_nop 0
    ds_write_b32 v20, v145 offset:0
    ds_write_b32 v20, v147 offset:64
    ds_write_b32 v20, v149 offset:128
    ds_write_b32 v20, v151 offset:192
    s_waitcnt lgkmcnt(0)
    ds_read_b128 v[4:7], v21 offset:0
    ds_read_b128 v[8:11], v21 offset:64
    ds_read_b128 v[12:15], v21 offset:128
    ds_read_b128 v[16:19], v21 offset:192
    s_branch STORE
.section .rodata,"a"
.p2align 6
.amdhsa_kernel standalone__kv_cache_quant_int4_int2_kv_with_per_channel_or_per_token_scales__prompt_kernel
  .amdhsa_next_free_vgpr 512
  .amdhsa_next_free_sgpr 102
  .amdhsa_accum_offset 256
  .amdhsa_group_segment_fixed_size 0
  .amdhsa_kernarg_size 80
  .amdhsa_user_sgpr_count 2
  .amdhsa_user_sgpr_kernarg_segment_ptr 1
  .amdhsa_system_sgpr_workgroup_id_x 1
.end_amdhsa_kernel
```
